```python
import torch

def _softmax(x, axis=-1):
    return torch.softmax(x, dim=axis)
def _gelu(x):
    return torch.nn.functional.gelu(x, approximate="tanh")
def _silu(x):
    return torch.nn.functional.silu(x)
def _sigmoid(x):
    return torch.sigmoid(x)
def _layernorm(x, axis=-1, eps=1e-5):
    m = x.mean(dim=axis, keepdim=True)
    v = x.var(dim=axis, keepdim=True, unbiased=False)
    return (x - m) / torch.sqrt(v + eps)
def _scatter_add(tgt, idx, src, axis=0):
    return tgt.clone().index_add_(axis, idx, src)
def _segment_sum(src, seg, n):
    out = torch.zeros((n,) + src.shape[1:], dtype=src.dtype)
    return out.index_add_(0, seg, src)
def _pad(x, pw):
    flat = tuple(v for pair in reversed(pw) for v in pair)
    return torch.nn.functional.pad(x, flat)

kernel_name = 'sequential_preLN__sliding_block__dense_activation_silu__prompt'

def setup_inputs():

    _w = (lambda a: (lambda t: t.to(torch.bfloat16) if t.is_floating_point() else t)(torch.as_tensor(a)))
    def _A_setup():
        B, S, D = 1, 2048, 640
        return {
            "x": _w((lambda *s: torch.randn(*s, dtype=torch.bfloat16) * 0.05)(B, S, D)),
            "wqkv": _w((lambda *s: torch.randn(*s, dtype=torch.bfloat16) * 0.05)(D, 3 * D)),
            "wo": _w((lambda *s: torch.randn(*s, dtype=torch.bfloat16) * 0.05)(D, D)),
        }
    _A_in = _A_setup()

    def _B_setup():
        B, S, D, F = 1, 2048, 640, 1728
        return {
            "x": _w((lambda *s: torch.randn(*s, dtype=torch.bfloat16) * 0.05)(B, S, D)),
            "w1": _w((lambda *s: torch.randn(*s, dtype=torch.bfloat16) * 3.2)(D, F) * (D ** -0.5)),
            "w2": _w((lambda *s: torch.randn(*s, dtype=torch.bfloat16) * 0.4)(F, D) * (F ** -0.5)),
        }
    _B_in = _B_setup()

    return {
        "A_x": _A_in["x"],
        "A_wqkv": _A_in["wqkv"],
        "A_wo": _A_in["wo"],
        "B_x": _B_in["x"],
        "B_w1": _B_in["w1"],
        "B_w2": _B_in["w2"],
    }

def reference(A_x, A_wqkv, A_wo, B_x, B_w1, B_w2):
    def _A_ref(x, wqkv, wo):
        B, S, D = x.shape
        H = 32; Dh = D // H; W = 256
        qkv = (lambda x, *d: x.permute(*d))((x @ wqkv).reshape(B, S, 3, H, Dh), 2, 0, 3, 1, 4)
        q, k, v = qkv[0], qkv[1], qkv[2]
        scores = torch.einsum("bhqd,bhkd->bhqk", q, k) * (Dh ** -0.5)
        idx = torch.arange(S)
        mask = (idx[:, None] - idx[None, :] >= 0) & (idx[:, None] - idx[None, :] < W)
        scores = torch.where(mask[None, None], scores, -1e9)
        p = _softmax(scores, axis=-1)
        o = torch.einsum("bhqk,bhkd->bhqd", p, v)
        return (lambda x, *d: x.permute(*d))(o, 0, 2, 1, 3).reshape(B, S, D) @ wo

    def _B_ref(x, w1, w2):
        h = torch.einsum("bsd,df->bsf", x, w1)
        h = _silu(h)
        out = torch.einsum("bsf,fd->bsd", h, w2)
        return out

    x = A_x
    h = x + _A_ref(_layernorm(x, axis=-1), A_wqkv, A_wo)
    h2 = h + _B_ref(_layernorm(h, axis=-1), B_w1, B_w2)
    return h2
```

```asm
; @launch grid=(256,1,1) block=(256,1,1) lds=163840
.amdgcn_target "amdgcn-amd-amdhsa--gfx950"
.text
.globl sequential_preLN__sliding_block__dense_activation_silu__prompt_kernel
.p2align 8
.type sequential_preLN__sliding_block__dense_activation_silu__prompt_kernel,@function
sequential_preLN__sliding_block__dense_activation_silu__prompt_kernel:
  s_cmp_ge_u32 s2, 256
  s_cbranch_scc1 L_end
  s_load_dwordx2 s[24:25], s[0:1], 0
  s_load_dwordx2 s[28:29], s[0:1], 8
  s_load_dwordx16 s[4:19], s[0:1], 0
  s_load_dwordx2 s[20:21], s[0:1], 64
  v_lshrrev_b32 v3, 6, v0
  v_and_b32 v1, 63, v0
  v_readfirstlane_b32 s50, v3
  v_lshlrev_b32 v2, 4, v1
  s_and_b32 s48, s2, 7
  s_lshr_b32 s49, s2, 3
  s_getpc_b64 s[100:101]
L_pc:
  s_lshl_b32 s72, s49, 11
  v_lshlrev_b32 v62, 3, v0
  v_add_u32 v62, s72, v62
  v_min_u32 v62, L_codeend-L_pc-4, v62
  v_mov_b32 v249, s101
  v_add_co_u32 v248, vcc, s100, v62
  s_nop 1
  v_addc_co_u32 v249, vcc, 0, v249, vcc
  global_load_dword v248, v[248:249], off
  s_lshl_b32 s79, s50, 12
  s_lshr_b32 s72, s48, 1
  s_lshl_b32 s72, s72, 2
  s_lshr_b32 s73, s49, 3
  s_add_u32 s22, s72, s73
  s_and_b32 s72, s48, 1
  s_lshl_b32 s72, s72, 3
  s_and_b32 s73, s49, 7
  s_add_u32 s23, s72, s73
  s_lshr_b32 s72, s49, 4
  s_lshr_b32 s73, s48, 1
  s_add_u32 s72, s72, s73
  s_lshr_b32 s73, s23, 1
  s_add_u32 s77, s72, s73
  s_mul_i32 s72, s77, 52
  s_lshr_b32 s72, s72, 8
  s_mul_i32 s72, s72, 5
  s_sub_u32 s77, s77, s72
  s_lshl_b32 s80, s77, 11
  s_lshl_b32 s77, s77, 1
  s_mov_b32 s47, 0
  v_lshrrev_b32 v60, 3, v1
  s_lshl_b32 s72, s22, 7
  s_lshl_b32 s73, s50, 5
  s_add_u32 s72, s72, s73
  v_add_u32 v60, s72, v60
  v_mul_u32_u24 v60, 1280, v60
  v_lshrrev_b32 v61, 4, v1
  v_xor_b32 v62, v1, v61
  v_and_b32 v62, 7, v62
  v_lshl_add_u32 v14, v62, 4, v60
  v_xor_b32 v62, 4, v62
  v_lshl_add_u32 v15, v62, 4, v60
  v_add_u32 v15, 9216, v15
  v_add_u32 v16, 18432, v14
  v_add_u32 v17, 18432, v15
  s_lshl_b32 s72, s50, 4
  v_add_u32 v60, s72, v61
  v_mul_u32_u24 v60, 3840, v60
  v_lshlrev_b32 v61, 1, v61
  v_xor_b32 v61, v1, v61
  v_and_b32 v61, 15, v61
  v_lshl_add_u32 v60, v61, 4, v60
  s_lshl_b32 s72, s23, 8
  v_add_u32 v18, s72, v60
  v_add_u32 v19, 14336, v18
  v_xor_b32 v60, 128, v18
  v_add_u32 v20, 28672, v60
  v_add_u32 v21, 43008, v60
  s_xor_b32 s52, s77, s47
  s_mul_i32 s53, s52, 245760
  s_lshl_b32 s52, s52, 7
  s_add_u32 s77, s77, 1
  s_cmp_eq_u32 s77, 10
  s_cselect_b32 s77, 0, s77
  s_xor_b32 s54, s77, s47
  s_mul_i32 s55, s54, 245760
  s_lshl_b32 s54, s54, 7
  s_add_u32 s77, s77, 1
  s_cmp_eq_u32 s77, 10
  s_cselect_b32 s77, 0, s77
  s_mov_b32 s26, 2621440
  s_mov_b32 s27, 131072
  s_mov_b32 s30, 2457600
  s_mov_b32 s31, 131072
  s_cmp_eq_u32 s23, 15
  s_waitcnt lgkmcnt(0)
  s_cbranch_scc1 L_nold_1
  s_add_u32 m0, s79, 0
  s_nop 0
  buffer_load_dwordx4 v14, s[24:27], s52 offen offset:0 lds
  buffer_load_dwordx4 v15, s[24:27], s52 offen offset:1024 lds
  buffer_load_dwordx4 v16, s[24:27], s52 offen offset:2048 lds
  buffer_load_dwordx4 v17, s[24:27], s52 offen offset:3072 lds
  s_add_u32 m0, s79, 16384
  s_nop 0
  buffer_load_dwordx4 v18, s[28:31], s53 offen offset:0 lds
  buffer_load_dwordx4 v19, s[28:31], s53 offen offset:1024 lds
  buffer_load_dwordx4 v20, s[28:31], s53 offen offset:2048 lds
  buffer_load_dwordx4 v21, s[28:31], s53 offen offset:3072 lds
L_nold_1:
  s_mov_b32 s36, s20
  s_mov_b32 s37, s21
  s_mov_b32 s38, 33554432
  s_mov_b32 s39, 131072
  v_mov_b32 v63, 25853952
  s_lshl_b32 s72, s2, 7
  s_add_u32 s72, s72, 25657344
  v_cmp_eq_u32 vcc, 0, v1
  v_min_u32 v62, 5, v1
  v_lshlrev_b32 v62, 15, v62
  v_add_u32 v62, s72, v62
  v_cndmask_b32 v63, v62, v63, vcc
  buffer_load_dwordx2 v[254:255], v63, s[36:39], 0 offen sc1
  s_mov_b32 s40, s16
  s_mov_b32 s41, s17
  s_mov_b32 s42, 2621440
  s_mov_b32 s43, 131072
  s_mov_b32 s78, 4294901760
  s_lshl_b32 s73, s2, 7
  s_add_u32 s73, s73, 25690112
  v_mov_b32 v60, s73
  v_mov_b32 v61, 2147483648
  v_cmp_eq_u32 vcc, 0, v0
  s_nop 1
  v_cndmask_b32 v29, v61, v60, vcc
  v_add_u32 v28, 4096, v2
  s_mul_i32 s46, s50, 5120
  s_cmp_eq_u32 s23, 15
  s_cbranch_scc1 L_helper
  s_xor_b32 s56, s77, s47
  s_mul_i32 s57, s56, 245760
  s_lshl_b32 s56, s56, 7
  s_add_u32 s77, s77, 1
  s_cmp_eq_u32 s77, 10
  s_cselect_b32 s77, 0, s77
  s_xor_b32 s58, s77, s47
  s_mul_i32 s59, s58, 245760
  s_lshl_b32 s58, s58, 7
  s_add_u32 s77, s77, 1
  s_cmp_eq_u32 s77, 10
  s_cselect_b32 s77, 0, s77
  s_cmp_ge_u32 s23, 10
  s_cselect_b32 s32, s12, s14
  s_cselect_b32 s33, s13, s15
  s_mov_b32 s34, 2211840
  s_mov_b32 s35, 131072
  v_lshrrev_b32 v62, 4, v1
  v_and_b32 v63, 15, v1
  v_lshrrev_b32 v60, 1, v63
  v_xor_b32 v60, v60, v62
  v_lshlrev_b32 v60, 4, v60
  v_lshl_add_u32 v60, v63, 7, v60
  v_add_u32 v192, s79, v60
  v_xor_b32 v193, 64, v192
  v_xor_b32 v194, 4096, v192
  v_xor_b32 v195, 4096, v193
  s_and_b32 s72, s50, 1
  s_lshl_b32 s72, s72, 1
  s_lshr_b32 s73, s50, 1
  s_add_u32 s76, s72, s73
  v_bfe_u32 v60, v1, 2, 3
  s_lshl_b32 s72, s76, 1
  v_xor_b32 v61, s72, v60
  v_lshlrev_b32 v61, 5, v61
  v_and_b32 v60, 3, v60
  v_lshl_add_u32 v60, v62, 3, v60
  v_lshl_add_u32 v61, v60, 8, v61
  v_and_b32 v60, 3, v1
  v_lshl_add_u32 v200, v60, 3, v61
  v_xor_b32 v201, 32, v200
  v_xor_b32 v202, 64, v200
  v_xor_b32 v203, 96, v200
  v_mov_b32 v64, 1065369472
  v_mov_b32 v65, 1065369472
  v_mov_b32 v66, 1065369472
  v_mov_b32 v67, 1065369472
  s_mov_b32 s8, -1
  s_mov_b32 s9, 0
  s_sub_u32 s72, s23, 4
  s_cmp_lt_u32 s72, 10
  s_cselect_b32 s72, 1, 0
  s_lshr_b32 s73, 52431, s22
  s_and_b32 s73, s73, 1
  s_lshl_b32 s73, s73, 1
  s_xor_b32 s74, s22, s23
  s_bitcmp1_b32 s74, 0
  s_cselect_b32 s5, s73, s72
  s_add_u32 m0, s79, 32768
  s_nop 0
  buffer_load_dwordx4 v14, s[24:27], s54 offen offset:0 lds
  buffer_load_dwordx4 v15, s[24:27], s54 offen offset:1024 lds
  buffer_load_dwordx4 v16, s[24:27], s54 offen offset:2048 lds
  buffer_load_dwordx4 v17, s[24:27], s54 offen offset:3072 lds
  s_add_u32 m0, s79, 49152
  s_nop 0
  buffer_load_dwordx4 v18, s[28:31], s55 offen offset:0 lds
  buffer_load_dwordx4 v19, s[28:31], s55 offen offset:1024 lds
  buffer_load_dwordx4 v20, s[28:31], s55 offen offset:2048 lds
  buffer_load_dwordx4 v21, s[28:31], s55 offen offset:3072 lds
  v_add_u32 v196, 65536, v192
  v_add_u32 v204, 65536, v200
  v_add_u32 v197, 65536, v193
  v_add_u32 v205, 65536, v201
  v_add_u32 v198, 65536, v194
  v_add_u32 v206, 65536, v202
  v_add_u32 v199, 65536, v195
  v_add_u32 v207, 65536, v203
  v_lshrrev_b32 v33, 5, v1
  v_and_b32 v60, 31, v1
  v_lshlrev_b32 v32, 2, v60
  s_mul_i32 s72, s22, 10240
  s_lshl_b32 s73, s50, 9
  s_add_u32 s72, s72, s73
  s_add_u32 s72, s72, 26214400
  s_mul_i32 s73, s23, 10240
  s_lshl_b32 s74, s76, 9
  s_add_u32 s73, s73, s74
  s_add_u32 s73, s73, 26541568
  v_add_u32 v60, s72, v2
  v_add_u32 v61, s73, v2
  v_cndmask_b32 v56, v61, v60, s[8:9]
  v_lshrrev_b32 v60, 2, v63
  v_lshl_add_u32 v60, v60, 4, v63
  v_lshlrev_b32 v53, 2, v60
  v_lshlrev_b32 v60, 1, v32
  s_lshl_b32 s72, s50, 8
  s_add_u32 s72, s72, 152064
  v_add_u32 v34, s72, v60
  s_lshl_b32 s73, s76, 8
  s_add_u32 s73, s73, 153088
  v_add_u32 v36, s73, v60
  v_cndmask_b32 v30, v36, v34, s[8:9]
  v_and_b32 v60, 15, v1
  v_lshlrev_b32 v60, 3, v60
  v_add_u32 v36, s73, v60
  v_xor_b32 v37, 256, v36
  v_cmp_gt_u32 vcc, 16, v1
  v_xor_b32 v35, 256, v34
  v_mov_b32 v61, 154112
  v_cndmask_b32 v34, v61, v34, vcc
  v_cndmask_b32 v35, v61, v35, vcc
  v_lshl_add_u32 v61, v1, 2, v61
  v_mov_b32 v60, 0
  ds_write_b32 v61, v60
  s_lshl_b32 s72, s50, 7
  s_add_u32 s72, s72, 151552
  v_add_u32 v31, s72, v32
  s_cmp_ge_u32 s23, 10
  s_cbranch_scc1 L_tp1_2
  v_add_u32 v60, 0, v1
  v_mul_u32_u24 v61, 1639, v60
  v_lshrrev_b32 v61, 16, v61
  v_mul_u32_u24 v61, 640, v61
  v_add_u32 v22, v61, v2
  v_add_u32 v60, 64, v1
  v_mul_u32_u24 v61, 1639, v60
  v_lshrrev_b32 v61, 16, v61
  v_mul_u32_u24 v61, 640, v61
  v_add_u32 v23, v61, v2
  v_add_u32 v60, 128, v1
  v_mul_u32_u24 v61, 1639, v60
  v_lshrrev_b32 v61, 16, v61
  v_mul_u32_u24 v61, 640, v61
  v_add_u32 v24, v61, v2
  v_add_u32 v60, 192, v1
  v_mul_u32_u24 v61, 1639, v60
  v_lshrrev_b32 v61, 16, v61
  v_mul_u32_u24 v61, 640, v61
  v_add_u32 v25, v61, v2
  v_add_u32 v60, 256, v1
  v_mul_u32_u24 v61, 1639, v60
  v_lshrrev_b32 v61, 16, v61
  v_mul_u32_u24 v61, 640, v61
  v_add_u32 v26, v61, v2
  v_add_u32 v26, 4096, v26
  v_lshrrev_b32 v60, 4, v1
  v_lshlrev_b32 v60, 3, v60
  v_bfe_u32 v61, v1, 2, 2
  v_add_u32 v60, v60, v61
  v_mul_u32_u24 v60, 640, v60
  s_mul_i32 s73, s50, 160
  s_add_u32 s73, s73, 131072
  v_add_u32 v60, s73, v60
  v_and_b32 v61, 3, v1
  v_lshl_add_u32 v220, v61, 4, v60
  v_lshl_add_u32 v221, v61, 3, v60
  s_cmp_ge_u32 s23, 10
  s_cselect_b32 s72, -10, 0
  s_add_u32 s72, s72, s23
  s_lshl_b32 s72, s72, 4
  s_add_u32 s72, s72, s22
  s_and_b32 s73, s72, 1
  s_lshr_b32 s74, s72, 1
  s_mul_i32 s6, s74, 40960
  s_mul_i32 s81, s73, 640
  s_add_u32 s6, s6, s81
  s_mul_i32 s81, s50, 10240
  s_add_u32 s6, s6, s81
  s_lshl_b32 s73, s73, 2
  s_add_u32 s73, s73, s50
  s_mul_i32 s73, s73, 54
  s_add_u32 s73, s73, s74
  s_mul_i32 s73, s73, 5120
  s_add_u32 s81, s73, 21004288
  s_cmp_lt_u32 s72, 108
  s_cselect_b32 s6, s6, 2147483648
  s_cselect_b32 s81, s81, 2147483648
  v_mov_b32 v27, 2147483648
  s_branch L_tp2_3
L_tp1_2:
  s_and_b32 s7, s22, 1
  s_add_u32 s7, s7, 2
  v_lshrrev_b32 v60, 3, v1
  v_mul_u32_u24 v60, 3456, v60
  v_and_b32 v61, 7, v1
  v_lshl_add_u32 v22, v61, 4, v60
  v_add_u32 v23, 26624, v22
  v_add_u32 v24, 53248, v22
  v_add_u32 v25, 79872, v22
  v_add_u32 v26, 110592, v22
  v_lshrrev_b32 v60, 4, v1
  v_lshlrev_b32 v60, 3, v60
  v_bfe_u32 v61, v1, 2, 2
  v_add_u32 v60, v60, v61
  v_lshlrev_b32 v60, 7, v60
  s_lshl_b32 s73, s50, 5
  s_add_u32 s73, s73, 131072
  v_add_u32 v60, s73, v60
  v_and_b32 v61, 3, v1
  v_lshl_add_u32 v220, v61, 3, v60
  s_mul_i32 s73, s7, -4864
  s_add_u32 s73, s73, 20480
  v_add_u32 v60, s73, v2
  v_mov_b32 v61, 2147483648
  v_cmp_gt_u32 vcc, 16, v1
  s_nop 1
  v_cndmask_b32 v27, v61, v60, vcc
  s_sub_u32 s72, s23, 10
  s_lshl_b32 s72, s72, 4
  s_add_u32 s72, s72, s22
  s_lshr_b32 s73, s72, 1
  s_lshl_b32 s74, s7, 2
  s_add_u32 s74, s74, s50
  s_mul_i32 s74, s74, 138240
  s_lshl_b32 s6, s73, 7
  s_add_u32 s6, s6, s74
  s_lshl_b32 s73, s73, 2
  s_add_u32 s73, s73, s50
  s_mul_i32 s73, s73, 21504
  s_mul_i32 s74, s7, 5120
  s_add_u32 s73, s73, s74
  s_add_u32 s81, s73, 23216128
  s_cmp_lt_u32 s72, 54
  s_cselect_b32 s6, s6, 2147483648
  s_cselect_b32 s81, s81, 2147483648
L_tp2_3:
  s_cmp_ge_u32 s23, 10
  s_cselect_b32 s72, 4, 0
  s_add_u32 s72, s72, s50
  s_mov_b64 exec, 0
  s_cmp_eq_u32 s72, 0
  s_cbranch_scc1 L_tc0_0
  s_cmp_eq_u32 s72, 1
  s_cbranch_scc1 L_tc0_1
  s_cmp_eq_u32 s72, 2
  s_cbranch_scc1 L_tc0_2
  s_cmp_eq_u32 s72, 3
  s_cbranch_scc1 L_tc0_3
  s_cmp_eq_u32 s72, 4
  s_cbranch_scc1 L_tc0_4
  s_cmp_eq_u32 s72, 5
  s_cbranch_scc1 L_tc0_5
  s_cmp_eq_u32 s72, 6
  s_cbranch_scc1 L_tc0_6
  s_branch L_tc0_7
L_tc0_7:
L_tr0:
  s_mov_b64 exec, -1
  s_waitcnt vmcnt(9)
  s_barrier
  ds_read_b128 a[132:135], v192 offset:0
  ds_read_b64_tr_b16 a[148:149], v200 offset:16384
  ds_read_b64_tr_b16 a[150:151], v200 offset:17408
  ds_read_b128 a[136:139], v192 offset:2048
  ds_read_b64_tr_b16 a[152:153], v201 offset:16384
  ds_read_b64_tr_b16 a[154:155], v201 offset:17408
  ds_read_b128 a[140:143], v194 offset:0
  ds_read_b64_tr_b16 a[156:157], v202 offset:16384
  ds_read_b64_tr_b16 a[158:159], v202 offset:17408
  ds_read_b128 a[144:147], v194 offset:2048
  ds_read_b64_tr_b16 a[160:161], v203 offset:16384
  ds_read_b64_tr_b16 a[162:163], v203 offset:17408
  s_cmp_ge_u32 s23, 10
  s_cbranch_scc1 L_p1v
  s_branch L_p1qk
.p2align 12
L_p1qk:
L_tc0_0:
  s_cbranch_execz L_tr0
  s_waitcnt lgkmcnt(0)
  v_mfma_f32_16x16x32_bf16 v[96:99], a[148:151], a[132:135], 0
  ds_read_b128 a[164:167], v193 offset:0
  ds_read_b64_tr_b16 a[180:181], v200 offset:24576
  s_and_b32 s83, s49, 7
  s_mul_i32 s72, s83, 102400
  v_mfma_f32_16x16x32_bf16 v[100:103], a[148:151], a[136:139], 0
  s_add_u32 m0, s79, 65536
  s_nop 0
  buffer_load_dwordx4 v14, s[24:27], s56 offen offset:0 lds
  s_mul_i32 s73, s50, 25600
  s_add_u32 s72, s72, s73
  v_mfma_f32_16x16x32_bf16 v[104:107], a[148:151], a[140:143], 0
  ds_read_b64_tr_b16 a[182:183], v200 offset:25600
  ds_read_b128 a[168:171], v193 offset:2048
  s_add_u32 s62, s72, 20185088
  s_and_b32 s72, s49, 15
  v_mfma_f32_16x16x32_bf16 v[108:111], a[148:151], a[144:147], 0
  ds_read_b64_tr_b16 a[184:185], v201 offset:24576
  s_mul_i32 s72, s72, 7
  s_min_u32 s66, s72, 101
  v_mfma_f32_16x16x32_bf16 v[124:127], a[152:155], a[144:147], 0
  ds_read_b64_tr_b16 a[186:187], v201 offset:25600
  ds_read_b128 a[172:175], v195 offset:0
  v_mfma_f32_16x16x32_bf16 v[120:123], a[152:155], a[140:143], 0
  buffer_load_dwordx4 v15, s[24:27], s56 offen offset:1024 lds
  s_bitcmp1_b32 s66, 0
  s_cselect_b32 s72, 3, 0
  s_cselect_b32 s73, 0, 4
  v_mfma_f32_16x16x32_bf16 v[116:119], a[152:155], a[136:139], 0
  ds_read_b64_tr_b16 a[188:189], v202 offset:24576
  ds_read_b64_tr_b16 a[190:191], v202 offset:25600
  s_add_u32 s63, s66, s72
  s_add_u32 s69, s66, s73
  v_mfma_f32_16x16x32_bf16 v[112:115], a[152:155], a[132:135], 0
  ds_read_b128 a[176:179], v195 offset:2048
  s_mul_i32 s72, s50, 3072
  s_min_u32 s45, s72, 8192
  s_mul_i32 s72, s69, 21504
  v_mfma_f32_16x16x32_bf16 v[128:131], a[156:159], a[132:135], 0
  ds_read_b64_tr_b16 a[192:193], v203 offset:24576
  buffer_load_dwordx4 v16, s[24:27], s56 offen offset:2048 lds
  s_add_u32 s72, s72, s45
  s_add_u32 s44, s72, 23226368
  v_mfma_f32_16x16x32_bf16 v[132:135], a[156:159], a[136:139], 0
  buffer_load_dwordx4 v17, s[24:27], s56 offen offset:3072 lds
  s_mul_i32 s67, s50, 14
  s_mul_i32 s72, s83, 54
  s_add_u32 s72, s72, s67
  v_mfma_f32_16x16x32_bf16 v[136:139], a[156:159], a[140:143], 0
  ds_read_b64_tr_b16 a[194:195], v203 offset:25600
  s_mul_i32 s72, s72, 5120
  s_add_u32 s64, s72, 21004288
  v_mfma_f32_16x16x32_bf16 v[140:143], a[156:159], a[144:147], 0
  s_add_u32 m0, s79, 81920
  s_nop 0
  buffer_load_dwordx4 v18, s[28:31], s57 offen offset:0 lds
  s_cmp_eq_u32 s50, 3
  s_cselect_b32 s65, 2147483648, s64
  v_mfma_f32_16x16x32_bf16 v[156:159], a[160:163], a[144:147], 0
  buffer_load_dwordx4 v19, s[28:31], s57 offen offset:1024 lds
  v_add_u32 v216, 32768, v29
  s_lshr_b32 s72, s49, 3
  s_lshl_b32 s72, s72, 1
  v_mfma_f32_16x16x32_bf16 v[152:155], a[160:163], a[140:143], 0
  s_lshl_b32 s73, s48, 3
  s_add_u32 s72, s72, s73
  s_mul_i32 s82, s72, 274432
  s_lshl_b32 s73, s50, 7
  v_mfma_f32_16x16x32_bf16 v[148:151], a[160:163], a[136:139], 0
  buffer_load_dwordx4 v20, s[28:31], s57 offen offset:2048 lds
  s_add_u32 s73, s73, 151552
  v_and_b32 v60, 15, v1
  v_lshlrev_b32 v60, 2, v60
  v_mfma_f32_16x16x32_bf16 v[144:147], a[160:163], a[132:135], 0
  buffer_load_dwordx4 v21, s[28:31], s57 offen offset:3072 lds
  v_add_u32 v60, s73, v60
  v_xor_b32 v61, 128, v60
  s_lshl_b32 s72, s48, 11
  s_bitcmp1_b32 s5, 0
  s_cbranch_scc0 L_du_4
  v_mfma_f32_16x16x32_bf16 v[68:71], v[64:67], a[132:135], 0
  v_mfma_f32_16x16x32_bf16 v[76:79], a[132:135], a[132:135], 0
  v_mfma_f32_16x16x32_bf16 v[72:75], v[64:67], a[136:139], 0
  v_mfma_f32_16x16x32_bf16 v[80:83], a[136:139], a[136:139], 0
L_du_4:
  s_bitcmp1_b32 s5, 1
  s_cbranch_scc0 L_du_5
  v_mfma_f32_16x16x32_bf16 v[84:87], v[64:67], a[148:151], 0
  v_mfma_f32_16x16x32_bf16 v[88:91], v[64:67], a[152:155], 0
L_du_5:
  s_waitcnt lgkmcnt(0)
  s_waitcnt vmcnt(8)
  s_barrier
  v_mfma_f32_16x16x32_bf16 v[96:99], a[180:183], a[164:167], v[96:99]
  ds_read_b128 a[132:135], v192 offset:32768
  ds_read_b64_tr_b16 a[148:149], v200 offset:49152
  s_add_u32 s72, s72, 25821184
  v_and_b32 v57, 15, v1
  v_mfma_f32_16x16x32_bf16 v[100:103], a[180:183], a[168:171], v[100:103]
  s_add_u32 m0, s79, 98304
  s_nop 0
  buffer_load_dwordx4 v14, s[24:27], s58 offen offset:0 lds
  v_lshlrev_b32 v57, 5, v57
  v_add_u32 v57, s72, v57
  v_mfma_f32_16x16x32_bf16 v[104:107], a[180:183], a[172:175], v[104:107]
  ds_read_b64_tr_b16 a[150:151], v200 offset:50176
  ds_read_b128 a[136:139], v192 offset:34816
  s_xor_b32 s73, s50, 0
  s_lshl_b32 s74, s22, 2
  v_mfma_f32_16x16x32_bf16 v[108:111], a[180:183], a[176:179], v[108:111]
  ds_read_b64_tr_b16 a[152:153], v201 offset:49152
  s_add_u32 s73, s73, s74
  s_mul_i32 s73, s73, 274432
  s_xor_b32 s74, s76, 0
  v_mfma_f32_16x16x32_bf16 v[124:127], a[184:187], a[176:179], v[124:127]
  ds_read_b64_tr_b16 a[154:155], v201 offset:50176
  ds_read_b128 a[140:143], v194 offset:32768
  s_lshl_b32 s74, s74, 11
  s_lshl_b32 s72, s23, 13
  v_mfma_f32_16x16x32_bf16 v[120:123], a[184:187], a[172:175], v[120:123]
  buffer_load_dwordx4 v15, s[24:27], s58 offen offset:1024 lds
  s_add_u32 s74, s74, s72
  s_add_u32 s0, s73, s74
  s_xor_b32 s74, s76, 1
  v_mfma_f32_16x16x32_bf16 v[116:119], a[184:187], a[168:171], v[116:119]
  ds_read_b64_tr_b16 a[156:157], v202 offset:49152
  ds_read_b64_tr_b16 a[158:159], v202 offset:50176
  s_lshl_b32 s74, s74, 11
  s_lshl_b32 s72, s23, 13
  v_mfma_f32_16x16x32_bf16 v[112:115], a[184:187], a[164:167], v[112:115]
  ds_read_b128 a[144:147], v194 offset:34816
  s_add_u32 s74, s74, s72
  s_add_u32 s20, s73, s74
  s_xor_b32 s73, s50, 1
  v_mfma_f32_16x16x32_bf16 v[128:131], a[188:191], a[164:167], v[128:131]
  ds_read_b64_tr_b16 a[160:161], v203 offset:49152
  s_lshl_b32 s74, s22, 2
  s_add_u32 s73, s73, s74
  s_mul_i32 s73, s73, 274432
  v_mfma_f32_16x16x32_bf16 v[132:135], a[188:191], a[168:171], v[132:135]
  buffer_load_dwordx4 v16, s[24:27], s58 offen offset:2048 lds
  s_xor_b32 s74, s76, 0
  s_lshl_b32 s74, s74, 11
  s_lshl_b32 s72, s23, 13
  v_mfma_f32_16x16x32_bf16 v[136:139], a[188:191], a[172:175], v[136:139]
  ds_read_b64_tr_b16 a[162:163], v203 offset:50176
  s_add_u32 s74, s74, s72
  s_add_u32 s1, s73, s74
  s_xor_b32 s74, s76, 1
  v_mfma_f32_16x16x32_bf16 v[140:143], a[188:191], a[176:179], v[140:143]
  s_lshl_b32 s74, s74, 11
  s_lshl_b32 s72, s23, 13
  s_add_u32 s74, s74, s72
  s_add_u32 s21, s73, s74
  v_mfma_f32_16x16x32_bf16 v[156:159], a[192:195], a[176:179], v[156:159]
  v_mfma_f32_16x16x32_bf16 v[152:155], a[192:195], a[172:175], v[152:155]
  buffer_load_dwordx4 v17, s[24:27], s58 offen offset:3072 lds
  v_mfma_f32_16x16x32_bf16 v[148:151], a[192:195], a[168:171], v[148:151]
  v_mfma_f32_16x16x32_bf16 v[144:147], a[192:195], a[164:167], v[144:147]
  s_bitcmp1_b32 s5, 0
  s_cbranch_scc0 L_du_6
  v_mfma_f32_16x16x32_bf16 v[68:71], v[64:67], a[164:167], v[68:71]
  v_mfma_f32_16x16x32_bf16 v[76:79], a[164:167], a[164:167], v[76:79]
  v_mfma_f32_16x16x32_bf16 v[72:75], v[64:67], a[168:171], v[72:75]
  v_mfma_f32_16x16x32_bf16 v[80:83], a[168:171], a[168:171], v[80:83]
L_du_6:
  s_bitcmp1_b32 s5, 1
  s_cbranch_scc0 L_du_7
  v_mfma_f32_16x16x32_bf16 v[84:87], v[64:67], a[180:183], v[84:87]
  v_mfma_f32_16x16x32_bf16 v[88:91], v[64:67], a[184:187], v[88:91]
L_du_7:
  v_readfirstlane_b32 s10, v254
  v_readfirstlane_b32 s11, v255
  s_getreg_b32 s4, hwreg(HW_REG_XCC_ID, 0, 4)
  s_add_u32 s10, s10, 2135587861
  s_addc_u32 s11, s11, 2654435769
  v_mov_b32 v250, s10
  v_mov_b32 v251, s11
  v_mov_b32 v252, s4
  s_waitcnt lgkmcnt(0)
  v_mfma_f32_16x16x32_bf16 v[96:99], a[148:151], a[132:135], v[96:99]
  ds_read_b128 a[164:167], v193 offset:32768
  ds_read_b64_tr_b16 a[180:181], v200 offset:57344
  v_mfma_f32_16x16x32_bf16 v[100:103], a[148:151], a[136:139], v[100:103]
  s_add_u32 m0, s79, 114688
  s_nop 0
  buffer_load_dwordx4 v18, s[28:31], s59 offen offset:0 lds
  v_mfma_f32_16x16x32_bf16 v[104:107], a[148:151], a[140:143], v[104:107]
  ds_read_b64_tr_b16 a[182:183], v200 offset:58368
  ds_read_b128 a[168:171], v193 offset:34816
  v_mfma_f32_16x16x32_bf16 v[108:111], a[148:151], a[144:147], v[108:111]
  ds_read_b64_tr_b16 a[184:185], v201 offset:57344
  s_xor_b32 s52, s77, s47
  v_mfma_f32_16x16x32_bf16 v[124:127], a[152:155], a[144:147], v[124:127]
  ds_read_b64_tr_b16 a[186:187], v201 offset:58368
  ds_read_b128 a[172:175], v195 offset:32768
  v_mfma_f32_16x16x32_bf16 v[120:123], a[152:155], a[140:143], v[120:123]
  buffer_load_dwordx4 v19, s[28:31], s59 offen offset:1024 lds
  s_mul_i32 s53, s52, 245760
  v_mfma_f32_16x16x32_bf16 v[116:119], a[152:155], a[136:139], v[116:119]
  ds_read_b64_tr_b16 a[188:189], v202 offset:57344
  ds_read_b64_tr_b16 a[190:191], v202 offset:58368
  v_mfma_f32_16x16x32_bf16 v[112:115], a[152:155], a[132:135], v[112:115]
  ds_read_b128 a[176:179], v195 offset:34816
  s_lshl_b32 s52, s52, 7
  v_mfma_f32_16x16x32_bf16 v[128:131], a[156:159], a[132:135], v[128:131]
  ds_read_b64_tr_b16 a[192:193], v203 offset:57344
  s_add_u32 s77, s77, 1
  v_mfma_f32_16x16x32_bf16 v[132:135], a[156:159], a[136:139], v[132:135]
  buffer_load_dwordx4 v20, s[28:31], s59 offen offset:2048 lds
  v_mfma_f32_16x16x32_bf16 v[136:139], a[156:159], a[140:143], v[136:139]
  ds_read_b64_tr_b16 a[194:195], v203 offset:58368
  v_mfma_f32_16x16x32_bf16 v[140:143], a[156:159], a[144:147], v[140:143]
  s_cmp_eq_u32 s77, 10
  s_cselect_b32 s77, 0, s77
  v_mfma_f32_16x16x32_bf16 v[156:159], a[160:163], a[144:147], v[156:159]
  v_mfma_f32_16x16x32_bf16 v[152:155], a[160:163], a[140:143], v[152:155]
  buffer_load_dwordx4 v21, s[28:31], s59 offen offset:3072 lds
  v_mfma_f32_16x16x32_bf16 v[148:151], a[160:163], a[136:139], v[148:151]
  v_mfma_f32_16x16x32_bf16 v[144:147], a[160:163], a[132:135], v[144:147]
  s_bitcmp1_b32 s5, 0
  s_cbranch_scc0 L_du_8
  v_mfma_f32_16x16x32_bf16 v[68:71], v[64:67], a[132:135], v[68:71]
  v_mfma_f32_16x16x32_bf16 v[76:79], a[132:135], a[132:135], v[76:79]
  v_mfma_f32_16x16x32_bf16 v[72:75], v[64:67], a[136:139], v[72:75]
  v_mfma_f32_16x16x32_bf16 v[80:83], a[136:139], a[136:139], v[80:83]
L_du_8:
  s_bitcmp1_b32 s5, 1
  s_cbranch_scc0 L_du_9
  v_mfma_f32_16x16x32_bf16 v[84:87], v[64:67], a[148:151], v[84:87]
  v_mfma_f32_16x16x32_bf16 v[88:91], v[64:67], a[152:155], v[88:91]
L_du_9:
  v_mov_b32 v253, 0
  v_mov_b32 v254, s10
  v_mov_b32 v255, s11
  v_mov_b32 v246, s10
  v_mov_b32 v247, s11
  s_mov_b32 s12, 2863311530
  s_mov_b32 s13, 2863311530
  s_waitcnt lgkmcnt(0)
  s_waitcnt vmcnt(8)
  s_barrier
  v_mfma_f32_16x16x32_bf16 v[96:99], a[180:183], a[164:167], v[96:99]
  ds_read_b128 a[132:135], v196 offset:0
  ds_read_b64_tr_b16 a[148:149], v204 offset:16384
  v_mfma_f32_16x16x32_bf16 v[100:103], a[180:183], a[168:171], v[100:103]
  s_add_u32 m0, s79, 0
  s_nop 0
  buffer_load_dwordx4 v14, s[24:27], s52 offen offset:0 lds
  v_mfma_f32_16x16x32_bf16 v[104:107], a[180:183], a[172:175], v[104:107]
  ds_read_b64_tr_b16 a[150:151], v204 offset:17408
  ds_read_b128 a[136:139], v196 offset:2048
  v_mfma_f32_16x16x32_bf16 v[108:111], a[180:183], a[176:179], v[108:111]
  ds_read_b64_tr_b16 a[152:153], v205 offset:16384
  v_mfma_f32_16x16x32_bf16 v[124:127], a[184:187], a[176:179], v[124:127]
  ds_read_b64_tr_b16 a[154:155], v205 offset:17408
  ds_read_b128 a[140:143], v198 offset:0
  v_mfma_f32_16x16x32_bf16 v[120:123], a[184:187], a[172:175], v[120:123]
  buffer_load_dwordx4 v15, s[24:27], s52 offen offset:1024 lds
  v_mfma_f32_16x16x32_bf16 v[116:119], a[184:187], a[168:171], v[116:119]
  ds_read_b64_tr_b16 a[156:157], v206 offset:16384
  ds_read_b64_tr_b16 a[158:159], v206 offset:17408
  v_mfma_f32_16x16x32_bf16 v[112:115], a[184:187], a[164:167], v[112:115]
  ds_read_b128 a[144:147], v198 offset:2048
  v_mfma_f32_16x16x32_bf16 v[128:131], a[188:191], a[164:167], v[128:131]
  ds_read_b64_tr_b16 a[160:161], v207 offset:16384
  v_mfma_f32_16x16x32_bf16 v[132:135], a[188:191], a[168:171], v[132:135]
  buffer_load_dwordx4 v16, s[24:27], s52 offen offset:2048 lds
  v_mfma_f32_16x16x32_bf16 v[136:139], a[188:191], a[172:175], v[136:139]
  ds_read_b64_tr_b16 a[162:163], v207 offset:17408
  v_mfma_f32_16x16x32_bf16 v[140:143], a[188:191], a[176:179], v[140:143]
  v_mfma_f32_16x16x32_bf16 v[156:159], a[192:195], a[176:179], v[156:159]
  buffer_load_dwordx4 v17, s[24:27], s52 offen offset:3072 lds
  v_mfma_f32_16x16x32_bf16 v[152:155], a[192:195], a[172:175], v[152:155]
  v_mfma_f32_16x16x32_bf16 v[148:151], a[192:195], a[168:171], v[148:151]
  v_mfma_f32_16x16x32_bf16 v[144:147], a[192:195], a[164:167], v[144:147]
  s_add_u32 m0, s79, 16384
  s_nop 0
  buffer_load_dwordx4 v18, s[28:31], s53 offen offset:0 lds
  s_bitcmp1_b32 s5, 0
  s_cbranch_scc0 L_du_10
  v_mfma_f32_16x16x32_bf16 v[68:71], v[64:67], a[164:167], v[68:71]
  v_mfma_f32_16x16x32_bf16 v[76:79], a[164:167], a[164:167], v[76:79]
  v_mfma_f32_16x16x32_bf16 v[72:75], v[64:67], a[168:171], v[72:75]
  v_mfma_f32_16x16x32_bf16 v[80:83], a[168:171], a[168:171], v[80:83]
L_du_10:
  s_bitcmp1_b32 s5, 1
  s_cbranch_scc0 L_du_11
  v_mfma_f32_16x16x32_bf16 v[84:87], v[64:67], a[180:183], v[84:87]
  v_mfma_f32_16x16x32_bf16 v[88:91], v[64:67], a[184:187], v[88:91]
L_du_11:
  s_mov_b32 s14, 3435973836
  s_mov_b32 s15, 3435973836
  s_mov_b32 s16, 4294901760
  s_mov_b32 s17, 4294901760
  s_bitcmp1_b32 s5, 0
  s_cselect_b32 s18, -1, 0
  s_bitcmp1_b32 s5, 1
  s_cselect_b32 s19, -1, 0
  v_mov_b32 v55, 2147483648
  s_waitcnt lgkmcnt(0)
  v_mfma_f32_16x16x32_bf16 v[96:99], a[148:151], a[132:135], v[96:99]
  ds_read_b128 a[164:167], v197 offset:0
  ds_read_b64_tr_b16 a[180:181], v204 offset:24576
  v_mfma_f32_16x16x32_bf16 v[100:103], a[148:151], a[136:139], v[100:103]
  buffer_load_dwordx4 v19, s[28:31], s53 offen offset:1024 lds
  s_xor_b32 s54, s77, s47
  v_mfma_f32_16x16x32_bf16 v[104:107], a[148:151], a[140:143], v[104:107]
  ds_read_b64_tr_b16 a[182:183], v204 offset:25600
  ds_read_b128 a[168:171], v197 offset:2048
  v_mfma_f32_16x16x32_bf16 v[108:111], a[148:151], a[144:147], v[108:111]
  ds_read_b64_tr_b16 a[184:185], v205 offset:24576
  s_mul_i32 s55, s54, 245760
  v_cndmask_b32 v55, v55, v56, s[18:19]
  v_cndmask_b32 v76, v76, v77, s[12:13]
  v_mfma_f32_16x16x32_bf16 v[124:127], a[152:155], a[144:147], v[124:127]
  ds_read_b64_tr_b16 a[186:187], v205 offset:25600
  ds_read_b128 a[172:175], v199 offset:0
  v_cndmask_b32 v78, v78, v79, s[12:13]
  v_cndmask_b32 v76, v76, v78, s[14:15]
  v_mfma_f32_16x16x32_bf16 v[120:123], a[152:155], a[140:143], v[120:123]
  buffer_load_dwordx4 v20, s[28:31], s53 offen offset:2048 lds
  s_lshl_b32 s54, s54, 7
  ds_bpermute_b32 v77, v53, v76
  v_cndmask_b32 v80, v80, v81, s[12:13]
  v_mfma_f32_16x16x32_bf16 v[116:119], a[152:155], a[136:139], v[116:119]
  ds_read_b64_tr_b16 a[188:189], v206 offset:24576
  ds_read_b64_tr_b16 a[190:191], v206 offset:25600
  v_cndmask_b32 v82, v82, v83, s[12:13]
  v_cndmask_b32 v80, v80, v82, s[14:15]
  v_mfma_f32_16x16x32_bf16 v[112:115], a[152:155], a[132:135], v[112:115]
  ds_read_b128 a[176:179], v199 offset:2048
  s_add_u32 s77, s77, 1
  ds_bpermute_b32 v81, v53, v80
  v_cndmask_b32 v68, v68, v72, s[16:17]
  v_mfma_f32_16x16x32_bf16 v[128:131], a[156:159], a[132:135], v[128:131]
  ds_read_b64_tr_b16 a[192:193], v207 offset:24576
  v_cndmask_b32 v84, v84, v88, s[16:17]
  v_cndmask_b32 v244, v84, v68, s[8:9]
  s_waitcnt lgkmcnt(1)
  v_cndmask_b32 v245, v77, v81, s[16:17]
  v_mfma_f32_16x16x32_bf16 v[132:135], a[156:159], a[136:139], v[132:135]
  buffer_load_dwordx4 v21, s[28:31], s53 offen offset:3072 lds
  buffer_store_dwordx4 v[244:247], v55, s[36:39], s80 offen sc1
  v_mfma_f32_16x16x32_bf16 v[136:139], a[156:159], a[140:143], v[136:139]
  ds_read_b64_tr_b16 a[194:195], v207 offset:25600
  buffer_store_dwordx4 v[250:253], v29, s[36:39], 0 offen sc1
  v_mfma_f32_16x16x32_bf16 v[140:143], a[156:159], a[144:147], v[140:143]
  s_cmp_eq_u32 s77, 10
  s_cselect_b32 s77, 0, s77
  v_mfma_f32_16x16x32_bf16 v[156:159], a[160:163], a[144:147], v[156:159]
  s_add_u32 m0, s46, 131072
  s_nop 0
  buffer_load_dwordx4 v22, s[32:35], s6 offen offset:0 lds
  v_mfma_f32_16x16x32_bf16 v[152:155], a[160:163], a[140:143], v[152:155]
  v_mfma_f32_16x16x32_bf16 v[148:151], a[160:163], a[136:139], v[148:151]
  v_mfma_f32_16x16x32_bf16 v[144:147], a[160:163], a[132:135], v[144:147]
  buffer_load_dwordx4 v23, s[32:35], s6 offen offset:1024 lds
  s_waitcnt lgkmcnt(0)
  s_waitcnt vmcnt(12)
  s_barrier
  v_mfma_f32_16x16x32_bf16 v[96:99], a[180:183], a[164:167], v[96:99]
  ds_read_b128 a[132:135], v196 offset:32768
  ds_read_b64_tr_b16 a[148:149], v204 offset:49152
  v_mfma_f32_16x16x32_bf16 v[100:103], a[180:183], a[168:171], v[100:103]
  buffer_load_dwordx4 v24, s[32:35], s6 offen offset:2048 lds
  v_mfma_f32_16x16x32_bf16 v[104:107], a[180:183], a[172:175], v[104:107]
  ds_read_b64_tr_b16 a[150:151], v204 offset:50176
  ds_read_b128 a[136:139], v196 offset:34816
  v_mfma_f32_16x16x32_bf16 v[108:111], a[180:183], a[176:179], v[108:111]
  ds_read_b64_tr_b16 a[152:153], v205 offset:49152
  v_mfma_f32_16x16x32_bf16 v[124:127], a[184:187], a[176:179], v[124:127]
  ds_read_b64_tr_b16 a[154:155], v205 offset:50176
  ds_read_b128 a[140:143], v198 offset:32768
  v_mfma_f32_16x16x32_bf16 v[120:123], a[184:187], a[172:175], v[120:123]
  buffer_load_dwordx4 v25, s[32:35], s6 offen offset:3072 lds
  v_mfma_f32_16x16x32_bf16 v[116:119], a[184:187], a[168:171], v[116:119]
  ds_read_b64_tr_b16 a[156:157], v206 offset:49152
  ds_read_b64_tr_b16 a[158:159], v206 offset:50176
  v_mfma_f32_16x16x32_bf16 v[112:115], a[184:187], a[164:167], v[112:115]
  ds_read_b128 a[144:147], v198 offset:34816
  v_mfma_f32_16x16x32_bf16 v[128:131], a[188:191], a[164:167], v[128:131]
  ds_read_b64_tr_b16 a[160:161], v207 offset:49152
  v_mfma_f32_16x16x32_bf16 v[132:135], a[188:191], a[168:171], v[132:135]
  s_add_u32 m0, s46, 135168
  s_nop 0
  buffer_load_dwordx4 v26, s[32:35], s6 offen offset:0 lds
  v_mfma_f32_16x16x32_bf16 v[136:139], a[188:191], a[172:175], v[136:139]
  ds_read_b64_tr_b16 a[162:163], v207 offset:50176
  v_mfma_f32_16x16x32_bf16 v[140:143], a[188:191], a[176:179], v[140:143]
  v_mfma_f32_16x16x32_bf16 v[156:159], a[192:195], a[176:179], v[156:159]
  s_add_u32 m0, s79, 32768
  s_nop 0
  buffer_load_dwordx4 v14, s[24:27], s54 offen offset:0 lds
  v_mfma_f32_16x16x32_bf16 v[152:155], a[192:195], a[172:175], v[152:155]
  v_mfma_f32_16x16x32_bf16 v[148:151], a[192:195], a[168:171], v[148:151]
  v_mfma_f32_16x16x32_bf16 v[144:147], a[192:195], a[164:167], v[144:147]
  buffer_load_dwordx4 v15, s[24:27], s54 offen offset:1024 lds
  s_waitcnt lgkmcnt(0)
  v_mfma_f32_16x16x32_bf16 v[96:99], a[148:151], a[132:135], v[96:99]
  ds_read_b128 a[164:167], v197 offset:32768
  ds_read_b64_tr_b16 a[180:181], v204 offset:57344
  v_mfma_f32_16x16x32_bf16 v[100:103], a[148:151], a[136:139], v[100:103]
  buffer_load_dwordx4 v16, s[24:27], s54 offen offset:2048 lds
  s_xor_b32 s56, s77, s47
  v_mfma_f32_16x16x32_bf16 v[104:107], a[148:151], a[140:143], v[104:107]
  ds_read_b64_tr_b16 a[182:183], v204 offset:58368
  ds_read_b128 a[168:171], v197 offset:34816
  v_mfma_f32_16x16x32_bf16 v[108:111], a[148:151], a[144:147], v[108:111]
  ds_read_b64_tr_b16 a[184:185], v205 offset:57344
  s_mul_i32 s57, s56, 245760
  v_mfma_f32_16x16x32_bf16 v[124:127], a[152:155], a[144:147], v[124:127]
  ds_read_b64_tr_b16 a[186:187], v205 offset:58368
  ds_read_b128 a[172:175], v199 offset:32768
  v_mfma_f32_16x16x32_bf16 v[120:123], a[152:155], a[140:143], v[120:123]
  buffer_load_dwordx4 v17, s[24:27], s54 offen offset:3072 lds
  s_lshl_b32 s56, s56, 7
  v_mfma_f32_16x16x32_bf16 v[116:119], a[152:155], a[136:139], v[116:119]
  ds_read_b64_tr_b16 a[188:189], v206 offset:57344
  ds_read_b64_tr_b16 a[190:191], v206 offset:58368
  v_mfma_f32_16x16x32_bf16 v[112:115], a[152:155], a[132:135], v[112:115]
  ds_read_b128 a[176:179], v199 offset:34816
  s_add_u32 s77, s77, 1
  v_mfma_f32_16x16x32_bf16 v[128:131], a[156:159], a[132:135], v[128:131]
  ds_read_b64_tr_b16 a[192:193], v207 offset:57344
  v_mfma_f32_16x16x32_bf16 v[132:135], a[156:159], a[136:139], v[132:135]
  s_add_u32 m0, s79, 49152
  s_nop 0
  buffer_load_dwordx4 v18, s[28:31], s55 offen offset:0 lds
  v_mfma_f32_16x16x32_bf16 v[136:139], a[156:159], a[140:143], v[136:139]
  ds_read_b64_tr_b16 a[194:195], v207 offset:58368
  v_mfma_f32_16x16x32_bf16 v[140:143], a[156:159], a[144:147], v[140:143]
  s_cmp_eq_u32 s77, 10
  s_cselect_b32 s77, 0, s77
  v_mfma_f32_16x16x32_bf16 v[156:159], a[160:163], a[144:147], v[156:159]
  buffer_load_dwordx4 v19, s[28:31], s55 offen offset:1024 lds
  v_mfma_f32_16x16x32_bf16 v[152:155], a[160:163], a[140:143], v[152:155]
  v_mfma_f32_16x16x32_bf16 v[148:151], a[160:163], a[136:139], v[148:151]
  v_mfma_f32_16x16x32_bf16 v[144:147], a[160:163], a[132:135], v[144:147]
  buffer_load_dwordx4 v20, s[28:31], s55 offen offset:2048 lds
  s_waitcnt lgkmcnt(0)
  s_waitcnt vmcnt(14)
  s_barrier
  v_mfma_f32_16x16x32_bf16 v[96:99], a[180:183], a[164:167], v[96:99]
  ds_read_b128 a[132:135], v192 offset:0
  ds_read_b64_tr_b16 a[148:149], v200 offset:16384
  v_mfma_f32_16x16x32_bf16 v[100:103], a[180:183], a[168:171], v[100:103]
  buffer_load_dwordx4 v21, s[28:31], s55 offen offset:3072 lds
  v_mfma_f32_16x16x32_bf16 v[104:107], a[180:183], a[172:175], v[104:107]
  ds_read_b64_tr_b16 a[150:151], v200 offset:17408
  ds_read_b128 a[136:139], v192 offset:2048
  v_mfma_f32_16x16x32_bf16 v[108:111], a[180:183], a[176:179], v[108:111]
  ds_read_b64_tr_b16 a[152:153], v201 offset:16384
  v_mfma_f32_16x16x32_bf16 v[124:127], a[184:187], a[176:179], v[124:127]
  ds_read_b64_tr_b16 a[154:155], v201 offset:17408
  ds_read_b128 a[140:143], v194 offset:0
  v_mfma_f32_16x16x32_bf16 v[120:123], a[184:187], a[172:175], v[120:123]
  s_add_u32 m0, s79, 65536
  s_nop 0
  buffer_load_dwordx4 v14, s[24:27], s56 offen offset:0 lds
  v_mfma_f32_16x16x32_bf16 v[116:119], a[184:187], a[168:171], v[116:119]
  ds_read_b64_tr_b16 a[156:157], v202 offset:16384
  ds_read_b64_tr_b16 a[158:159], v202 offset:17408
  v_mfma_f32_16x16x32_bf16 v[112:115], a[184:187], a[164:167], v[112:115]
  ds_read_b128 a[144:147], v194 offset:2048
  v_mfma_f32_16x16x32_bf16 v[128:131], a[188:191], a[164:167], v[128:131]
  ds_read_b64_tr_b16 a[160:161], v203 offset:16384
  v_mfma_f32_16x16x32_bf16 v[132:135], a[188:191], a[168:171], v[132:135]
  buffer_load_dwordx4 v15, s[24:27], s56 offen offset:1024 lds
  v_mfma_f32_16x16x32_bf16 v[136:139], a[188:191], a[172:175], v[136:139]
  ds_read_b64_tr_b16 a[162:163], v203 offset:17408
  v_mfma_f32_16x16x32_bf16 v[140:143], a[188:191], a[176:179], v[140:143]
  v_mfma_f32_16x16x32_bf16 v[156:159], a[192:195], a[176:179], v[156:159]
  buffer_load_dwordx4 v16, s[24:27], s56 offen offset:2048 lds
  v_mfma_f32_16x16x32_bf16 v[152:155], a[192:195], a[172:175], v[152:155]
  v_mfma_f32_16x16x32_bf16 v[148:151], a[192:195], a[168:171], v[148:151]
  v_mfma_f32_16x16x32_bf16 v[144:147], a[192:195], a[164:167], v[144:147]
  buffer_load_dwordx4 v17, s[24:27], s56 offen offset:3072 lds
  s_waitcnt lgkmcnt(0)
  v_mfma_f32_16x16x32_bf16 v[96:99], a[148:151], a[132:135], v[96:99]
  ds_read_b128 a[164:167], v193 offset:0
  ds_read_b64_tr_b16 a[180:181], v200 offset:24576
  v_mfma_f32_16x16x32_bf16 v[100:103], a[148:151], a[136:139], v[100:103]
  s_add_u32 m0, s79, 81920
  s_nop 0
  buffer_load_dwordx4 v18, s[28:31], s57 offen offset:0 lds
  v_mfma_f32_16x16x32_bf16 v[104:107], a[148:151], a[140:143], v[104:107]
  ds_read_b64_tr_b16 a[182:183], v200 offset:25600
  ds_read_b128 a[168:171], v193 offset:2048
  v_mfma_f32_16x16x32_bf16 v[108:111], a[148:151], a[144:147], v[108:111]
  ds_read_b64_tr_b16 a[184:185], v201 offset:24576
  s_xor_b32 s58, s77, s47
  v_mfma_f32_16x16x32_bf16 v[124:127], a[152:155], a[144:147], v[124:127]
  ds_read_b64_tr_b16 a[186:187], v201 offset:25600
  ds_read_b128 a[172:175], v195 offset:0
  v_mfma_f32_16x16x32_bf16 v[120:123], a[152:155], a[140:143], v[120:123]
  buffer_load_dwordx4 v19, s[28:31], s57 offen offset:1024 lds
  s_mul_i32 s59, s58, 245760
  v_mfma_f32_16x16x32_bf16 v[116:119], a[152:155], a[136:139], v[116:119]
  ds_read_b64_tr_b16 a[188:189], v202 offset:24576
  ds_read_b64_tr_b16 a[190:191], v202 offset:25600
  v_mfma_f32_16x16x32_bf16 v[112:115], a[152:155], a[132:135], v[112:115]
  ds_read_b128 a[176:179], v195 offset:2048
  s_lshl_b32 s58, s58, 7
  v_mfma_f32_16x16x32_bf16 v[128:131], a[156:159], a[132:135], v[128:131]
  ds_read_b64_tr_b16 a[192:193], v203 offset:24576
  s_add_u32 s77, s77, 1
  v_mfma_f32_16x16x32_bf16 v[132:135], a[156:159], a[136:139], v[132:135]
  buffer_load_dwordx4 v20, s[28:31], s57 offen offset:2048 lds
  v_mfma_f32_16x16x32_bf16 v[136:139], a[156:159], a[140:143], v[136:139]
  ds_read_b64_tr_b16 a[194:195], v203 offset:25600
  v_mfma_f32_16x16x32_bf16 v[140:143], a[156:159], a[144:147], v[140:143]
  s_cmp_eq_u32 s77, 10
  s_cselect_b32 s77, 0, s77
  v_mfma_f32_16x16x32_bf16 v[156:159], a[160:163], a[144:147], v[156:159]
  v_mfma_f32_16x16x32_bf16 v[152:155], a[160:163], a[140:143], v[152:155]
  buffer_load_dwordx4 v21, s[28:31], s57 offen offset:3072 lds
  v_mfma_f32_16x16x32_bf16 v[148:151], a[160:163], a[136:139], v[148:151]
  v_mfma_f32_16x16x32_bf16 v[144:147], a[160:163], a[132:135], v[144:147]
  s_waitcnt lgkmcnt(0)
  s_waitcnt vmcnt(8)
  s_barrier
  v_mfma_f32_16x16x32_bf16 v[96:99], a[180:183], a[164:167], v[96:99]
  ds_read_b128 a[132:135], v192 offset:32768
  ds_read_b64_tr_b16 a[148:149], v200 offset:49152
  v_mfma_f32_16x16x32_bf16 v[100:103], a[180:183], a[168:171], v[100:103]
  s_mov_b32 s75, 0
  buffer_load_dwordx4 v[160:163], v56, s[36:39], s75 offen offset:0 sc1
  v_mfma_f32_16x16x32_bf16 v[104:107], a[180:183], a[172:175], v[104:107]
  ds_read_b64_tr_b16 a[150:151], v200 offset:50176
  ds_read_b128 a[136:139], v192 offset:34816
  v_mfma_f32_16x16x32_bf16 v[108:111], a[180:183], a[176:179], v[108:111]
  ds_read_b64_tr_b16 a[152:153], v201 offset:49152
  v_mfma_f32_16x16x32_bf16 v[124:127], a[184:187], a[176:179], v[124:127]
  ds_read_b64_tr_b16 a[154:155], v201 offset:50176
  ds_read_b128 a[140:143], v194 offset:32768
  v_mfma_f32_16x16x32_bf16 v[120:123], a[184:187], a[172:175], v[120:123]
  buffer_load_dwordx4 v[164:167], v56, s[36:39], s75 offen offset:2048 sc1
  v_mfma_f32_16x16x32_bf16 v[116:119], a[184:187], a[168:171], v[116:119]
  ds_read_b64_tr_b16 a[156:157], v202 offset:49152
  ds_read_b64_tr_b16 a[158:159], v202 offset:50176
  v_mfma_f32_16x16x32_bf16 v[112:115], a[184:187], a[164:167], v[112:115]
  ds_read_b128 a[144:147], v194 offset:34816
  v_mfma_f32_16x16x32_bf16 v[128:131], a[188:191], a[164:167], v[128:131]
  ds_read_b64_tr_b16 a[160:161], v203 offset:49152
  v_mfma_f32_16x16x32_bf16 v[132:135], a[188:191], a[168:171], v[132:135]
  s_mov_b32 s75, 4096
  buffer_load_dwordx4 v[168:171], v56, s[36:39], s75 offen offset:0 sc1
  v_mfma_f32_16x16x32_bf16 v[136:139], a[188:191], a[172:175], v[136:139]
  ds_read_b64_tr_b16 a[162:163], v203 offset:50176
  v_mfma_f32_16x16x32_bf16 v[140:143], a[188:191], a[176:179], v[140:143]
  v_mfma_f32_16x16x32_bf16 v[156:159], a[192:195], a[176:179], v[156:159]
  buffer_load_dwordx4 v[172:175], v56, s[36:39], s75 offen offset:2048 sc1
  v_mfma_f32_16x16x32_bf16 v[152:155], a[192:195], a[172:175], v[152:155]
  v_mfma_f32_16x16x32_bf16 v[148:151], a[192:195], a[168:171], v[148:151]
  v_mfma_f32_16x16x32_bf16 v[144:147], a[192:195], a[164:167], v[144:147]
  s_mov_b32 s75, 8192
  buffer_load_dwordx4 v[176:179], v56, s[36:39], s75 offen offset:0 sc1
  s_waitcnt lgkmcnt(0)
  v_mfma_f32_16x16x32_bf16 v[96:99], a[148:151], a[132:135], v[96:99]
  ds_read_b128 a[164:167], v193 offset:32768
  ds_read_b64_tr_b16 a[180:181], v200 offset:57344
  v_mfma_f32_16x16x32_bf16 v[100:103], a[148:151], a[136:139], v[100:103]
  s_add_u32 m0, s79, 98304
  s_nop 0
  buffer_load_dwordx4 v14, s[24:27], s58 offen offset:0 lds
  v_mfma_f32_16x16x32_bf16 v[104:107], a[148:151], a[140:143], v[104:107]
  ds_read_b64_tr_b16 a[182:183], v200 offset:58368
  ds_read_b128 a[168:171], v193 offset:34816
  v_mfma_f32_16x16x32_bf16 v[108:111], a[148:151], a[144:147], v[108:111]
  ds_read_b64_tr_b16 a[184:185], v201 offset:57344
  s_xor_b32 s52, s77, s47
  v_mfma_f32_16x16x32_bf16 v[124:127], a[152:155], a[144:147], v[124:127]
  ds_read_b64_tr_b16 a[186:187], v201 offset:58368
  ds_read_b128 a[172:175], v195 offset:32768
  v_mfma_f32_16x16x32_bf16 v[120:123], a[152:155], a[140:143], v[120:123]
  buffer_load_dwordx4 v15, s[24:27], s58 offen offset:1024 lds
  s_mul_i32 s53, s52, 245760
  v_mfma_f32_16x16x32_bf16 v[116:119], a[152:155], a[136:139], v[116:119]
  ds_read_b64_tr_b16 a[188:189], v202 offset:57344
  ds_read_b64_tr_b16 a[190:191], v202 offset:58368
  v_mfma_f32_16x16x32_bf16 v[112:115], a[152:155], a[132:135], v[112:115]
  ds_read_b128 a[176:179], v195 offset:34816
  s_lshl_b32 s52, s52, 7
  v_mfma_f32_16x16x32_bf16 v[128:131], a[156:159], a[132:135], v[128:131]
  ds_read_b64_tr_b16 a[192:193], v203 offset:57344
  s_add_u32 s77, s77, 1
  v_mfma_f32_16x16x32_bf16 v[132:135], a[156:159], a[136:139], v[132:135]
  buffer_load_dwordx4 v16, s[24:27], s58 offen offset:2048 lds
  v_mfma_f32_16x16x32_bf16 v[136:139], a[156:159], a[140:143], v[136:139]
L_tc0_1:
  s_cbranch_execz L_tr0
  ds_read_b64_tr_b16 a[194:195], v203 offset:58368
  v_mfma_f32_16x16x32_bf16 v[140:143], a[156:159], a[144:147], v[140:143]
  s_cmp_eq_u32 s77, 10
  s_cselect_b32 s77, 0, s77
  v_mfma_f32_16x16x32_bf16 v[156:159], a[160:163], a[144:147], v[156:159]
  buffer_load_dwordx4 v17, s[24:27], s58 offen offset:3072 lds
  v_mfma_f32_16x16x32_bf16 v[152:155], a[160:163], a[140:143], v[152:155]
  v_mfma_f32_16x16x32_bf16 v[148:151], a[160:163], a[136:139], v[148:151]
  v_mfma_f32_16x16x32_bf16 v[144:147], a[160:163], a[132:135], v[144:147]
  s_add_u32 m0, s79, 114688
  s_nop 0
  buffer_load_dwordx4 v18, s[28:31], s59 offen offset:0 lds
  s_waitcnt lgkmcnt(0)
  s_waitcnt vmcnt(10)
  s_barrier
  v_mfma_f32_16x16x32_bf16 v[96:99], a[180:183], a[164:167], v[96:99]
  ds_read_b128 a[132:135], v196 offset:0
  ds_read_b64_tr_b16 a[148:149], v204 offset:16384
  v_mfma_f32_16x16x32_bf16 v[100:103], a[180:183], a[168:171], v[100:103]
  buffer_load_dwordx4 v19, s[28:31], s59 offen offset:1024 lds
  v_mfma_f32_16x16x32_bf16 v[104:107], a[180:183], a[172:175], v[104:107]
  ds_read_b64_tr_b16 a[150:151], v204 offset:17408
  ds_read_b128 a[136:139], v196 offset:2048
  v_mfma_f32_16x16x32_bf16 v[108:111], a[180:183], a[176:179], v[108:111]
  ds_read_b64_tr_b16 a[152:153], v205 offset:16384
  v_mfma_f32_16x16x32_bf16 v[124:127], a[184:187], a[176:179], v[124:127]
  ds_read_b64_tr_b16 a[154:155], v205 offset:17408
  ds_read_b128 a[140:143], v198 offset:0
  v_mfma_f32_16x16x32_bf16 v[120:123], a[184:187], a[172:175], v[120:123]
  buffer_load_dwordx4 v20, s[28:31], s59 offen offset:2048 lds
  v_mfma_f32_16x16x32_bf16 v[116:119], a[184:187], a[168:171], v[116:119]
  ds_read_b64_tr_b16 a[156:157], v206 offset:16384
  ds_read_b64_tr_b16 a[158:159], v206 offset:17408
  v_mfma_f32_16x16x32_bf16 v[112:115], a[184:187], a[164:167], v[112:115]
  ds_read_b128 a[144:147], v198 offset:2048
  v_mfma_f32_16x16x32_bf16 v[128:131], a[188:191], a[164:167], v[128:131]
  ds_read_b64_tr_b16 a[160:161], v207 offset:16384
  v_mfma_f32_16x16x32_bf16 v[132:135], a[188:191], a[168:171], v[132:135]
  buffer_load_dwordx4 v21, s[28:31], s59 offen offset:3072 lds
  v_mfma_f32_16x16x32_bf16 v[136:139], a[188:191], a[172:175], v[136:139]
  ds_read_b64_tr_b16 a[162:163], v207 offset:17408
  v_mfma_f32_16x16x32_bf16 v[140:143], a[188:191], a[176:179], v[140:143]
  v_mfma_f32_16x16x32_bf16 v[156:159], a[192:195], a[176:179], v[156:159]
  s_add_u32 m0, s79, 0
  s_nop 0
  buffer_load_dwordx4 v14, s[24:27], s52 offen offset:0 lds
  v_mfma_f32_16x16x32_bf16 v[152:155], a[192:195], a[172:175], v[152:155]
  v_mfma_f32_16x16x32_bf16 v[148:151], a[192:195], a[168:171], v[148:151]
  v_mfma_f32_16x16x32_bf16 v[144:147], a[192:195], a[164:167], v[144:147]
  buffer_load_dwordx4 v15, s[24:27], s52 offen offset:1024 lds
  s_waitcnt lgkmcnt(0)
  v_mfma_f32_16x16x32_bf16 v[96:99], a[148:151], a[132:135], v[96:99]
  ds_read_b128 a[164:167], v197 offset:0
  ds_read_b64_tr_b16 a[180:181], v204 offset:24576
  s_waitcnt vmcnt(10)
  v_cmp_eq_u64 s[4:5], s[10:11], v[178:179]
  v_mfma_f32_16x16x32_bf16 v[100:103], a[148:151], a[136:139], v[100:103]
  buffer_load_dwordx4 v16, s[24:27], s52 offen offset:2048 lds
  s_xor_b32 s54, s77, s47
  v_cmp_eq_u64 s[12:13], s[10:11], v[162:163]
  v_mfma_f32_16x16x32_bf16 v[104:107], a[148:151], a[140:143], v[104:107]
  ds_read_b64_tr_b16 a[182:183], v204 offset:25600
  ds_read_b128 a[168:171], v197 offset:2048
  v_cmp_eq_u64 s[14:15], s[10:11], v[166:167]
  v_mfma_f32_16x16x32_bf16 v[108:111], a[148:151], a[144:147], v[108:111]
  ds_read_b64_tr_b16 a[184:185], v205 offset:24576
  s_mul_i32 s55, s54, 245760
  v_cmp_eq_u64 s[16:17], s[10:11], v[170:171]
  v_mfma_f32_16x16x32_bf16 v[124:127], a[152:155], a[144:147], v[124:127]
  ds_read_b64_tr_b16 a[186:187], v205 offset:25600
  ds_read_b128 a[172:175], v199 offset:0
  v_cmp_eq_u64 s[18:19], s[10:11], v[174:175]
  v_mfma_f32_16x16x32_bf16 v[120:123], a[152:155], a[140:143], v[120:123]
  buffer_load_dwordx4 v17, s[24:27], s52 offen offset:3072 lds
  s_lshl_b32 s54, s54, 7
  s_and_b64 s[4:5], s[4:5], s[12:13]
  v_mfma_f32_16x16x32_bf16 v[116:119], a[152:155], a[136:139], v[116:119]
  ds_read_b64_tr_b16 a[188:189], v206 offset:24576
  ds_read_b64_tr_b16 a[190:191], v206 offset:25600
  s_and_b64 s[4:5], s[4:5], s[14:15]
  v_mfma_f32_16x16x32_bf16 v[112:115], a[152:155], a[132:135], v[112:115]
  ds_read_b128 a[176:179], v199 offset:2048
  s_and_b64 s[4:5], s[4:5], s[16:17]
  s_and_b64 s[4:5], s[4:5], s[18:19]
  v_mfma_f32_16x16x32_bf16 v[128:131], a[156:159], a[132:135], v[128:131]
  ds_read_b64_tr_b16 a[192:193], v207 offset:24576
  s_cmp_eq_u64 s[4:5], -1
  s_cbranch_scc0 L_retry_12
L_back_13:
  v_mfma_f32_16x16x32_bf16 v[132:135], a[156:159], a[136:139], v[132:135]
  s_add_u32 m0, s79, 16384
  s_nop 0
  buffer_load_dwordx4 v18, s[28:31], s53 offen offset:0 lds
  v_add_f32 v160, v160, v164
  v_mfma_f32_16x16x32_bf16 v[136:139], a[156:159], a[140:143], v[136:139]
  ds_read_b64_tr_b16 a[194:195], v207 offset:25600
  v_add_f32 v161, v161, v165
  v_add_f32 v160, v160, v168
  v_mfma_f32_16x16x32_bf16 v[140:143], a[156:159], a[144:147], v[140:143]
  v_add_f32 v161, v161, v169
  v_add_f32 v160, v160, v172
  v_add_f32 v161, v161, v173
  v_mfma_f32_16x16x32_bf16 v[156:159], a[160:163], a[144:147], v[156:159]
  buffer_load_dwordx4 v19, s[28:31], s53 offen offset:1024 lds
  v_add_f32 v160, v160, v176
  v_add_f32 v161, v161, v177
  v_mfma_f32_16x16x32_bf16 v[152:155], a[160:163], a[140:143], v[152:155]
  s_mov_b32 s72, 986500301
  s_cmp_lt_u32 s23, 5
  s_cselect_b32 s73, 1051011932, 1065353216
  v_mfma_f32_16x16x32_bf16 v[148:151], a[160:163], a[136:139], v[148:151]
  v_mul_f32 v54, 3133983949, v160
  v_mul_f32 v55, v54, v54
  v_fma_f32 v52, v161, s72, -v55
  v_mfma_f32_16x16x32_bf16 v[144:147], a[160:163], a[132:135], v[144:147]
  buffer_load_dwordx4 v20, s[28:31], s53 offen offset:2048 lds
  v_max_f32 v52, 0, v52
  s_waitcnt lgkmcnt(0)
  s_waitcnt vmcnt(7)
  s_barrier
  v_mfma_f32_16x16x32_bf16 v[96:99], a[180:183], a[164:167], v[96:99]
  ds_read_b128 a[132:135], v196 offset:32768
  ds_read_b64_tr_b16 a[148:149], v204 offset:49152
  v_add_f32 v52, 925353388, v52
  v_mfma_f32_16x16x32_bf16 v[100:103], a[180:183], a[168:171], v[100:103]
  buffer_load_dwordx2 v[58:59], v57, s[36:39], 0 offen offset:512 sc1
  v_rsq_f32 v52, v52
  v_mfma_f32_16x16x32_bf16 v[104:107], a[180:183], a[172:175], v[104:107]
  ds_read_b64_tr_b16 a[150:151], v204 offset:50176
  ds_read_b128 a[136:139], v196 offset:34816
  v_cndmask_b32 v54, v160, v54, s[8:9]
  v_mfma_f32_16x16x32_bf16 v[108:111], a[180:183], a[176:179], v[108:111]
  ds_read_b64_tr_b16 a[152:153], v205 offset:49152
  v_mul_f32 v52, s73, v52
  v_cvt_pk_bf16_f32 v164, v54, v54
  v_mfma_f32_16x16x32_bf16 v[124:127], a[184:187], a[176:179], v[124:127]
  ds_read_b64_tr_b16 a[154:155], v205 offset:50176
  ds_read_b128 a[140:143], v198 offset:32768
  v_mov_b32 v53, v52
  v_mfma_f32_16x16x32_bf16 v[120:123], a[184:187], a[172:175], v[120:123]
  buffer_load_dwordx4 v21, s[28:31], s53 offen offset:3072 lds
  v_and_b32 v55, s78, v164
  v_sub_f32 v55, v54, v55
  v_mfma_f32_16x16x32_bf16 v[116:119], a[184:187], a[168:171], v[116:119]
  ds_read_b64_tr_b16 a[156:157], v206 offset:49152
  ds_read_b64_tr_b16 a[158:159], v206 offset:50176
  v_mfma_f32_16x16x32_bf16 v[112:115], a[184:187], a[164:167], v[112:115]
  ds_read_b128 a[144:147], v198 offset:34816
  v_permlane32_swap_b32 v52, v53
  v_mfma_f32_16x16x32_bf16 v[128:131], a[188:191], a[164:167], v[128:131]
  ds_read_b64_tr_b16 a[160:161], v207 offset:49152
  v_cvt_pk_bf16_f32 v168, v54, v55
  v_cndmask_b32 v54, v54, v55, s[8:9]
  v_mfma_f32_16x16x32_bf16 v[132:135], a[188:191], a[168:171], v[132:135]
  s_add_u32 m0, s79, 32768
  s_nop 0
  buffer_load_dwordx4 v14, s[24:27], s54 offen offset:0 lds
  v_cndmask_b32 v164, v168, v164, s[8:9]
  v_mfma_f32_16x16x32_bf16 v[136:139], a[188:191], a[172:175], v[136:139]
  ds_read_b64_tr_b16 a[162:163], v207 offset:50176
  v_cvt_pk_bf16_f32 v165, v54, 0
  v_mfma_f32_16x16x32_bf16 v[140:143], a[188:191], a[176:179], v[140:143]
  v_mfma_f32_16x16x32_bf16 v[156:159], a[192:195], a[176:179], v[156:159]
  buffer_load_dwordx4 v15, s[24:27], s54 offen offset:1024 lds
  v_mfma_f32_16x16x32_bf16 v[152:155], a[192:195], a[172:175], v[152:155]
  v_mfma_f32_16x16x32_bf16 v[148:151], a[192:195], a[168:171], v[148:151]
  v_mfma_f32_16x16x32_bf16 v[144:147], a[192:195], a[164:167], v[144:147]
  buffer_load_dwordx4 v16, s[24:27], s54 offen offset:2048 lds
  s_waitcnt lgkmcnt(0)
  v_mfma_f32_16x16x32_bf16 v[96:99], a[148:151], a[132:135], v[96:99]
  ds_write_b32 v31, v52
  ds_write_b64 v30, v[164:165]
  ds_read_b128 a[164:167], v197 offset:32768
  ds_read_b64_tr_b16 a[180:181], v204 offset:57344
  v_mfma_f32_16x16x32_bf16 v[100:103], a[148:151], a[136:139], v[100:103]
  buffer_load_dwordx4 v17, s[24:27], s54 offen offset:3072 lds
  v_mfma_f32_16x16x32_bf16 v[104:107], a[148:151], a[140:143], v[104:107]
  ds_read_b64_tr_b16 a[182:183], v204 offset:58368
  ds_read_b128 a[168:171], v197 offset:34816
  v_mfma_f32_16x16x32_bf16 v[108:111], a[148:151], a[144:147], v[108:111]
  ds_read_b64_tr_b16 a[184:185], v205 offset:57344
  v_mfma_f32_16x16x32_bf16 v[124:127], a[152:155], a[144:147], v[124:127]
  ds_read_b64_tr_b16 a[186:187], v205 offset:58368
  ds_read_b128 a[172:175], v199 offset:32768
  v_mfma_f32_16x16x32_bf16 v[120:123], a[152:155], a[140:143], v[120:123]
  s_add_u32 m0, s79, 49152
  s_nop 0
  buffer_load_dwordx4 v18, s[28:31], s55 offen offset:0 lds
  v_mfma_f32_16x16x32_bf16 v[116:119], a[152:155], a[136:139], v[116:119]
  ds_read_b64_tr_b16 a[188:189], v206 offset:57344
  ds_read_b64_tr_b16 a[190:191], v206 offset:58368
  v_mfma_f32_16x16x32_bf16 v[112:115], a[152:155], a[132:135], v[112:115]
  ds_read_b128 a[176:179], v199 offset:34816
  v_mfma_f32_16x16x32_bf16 v[128:131], a[156:159], a[132:135], v[128:131]
  ds_read_b64_tr_b16 a[192:193], v207 offset:57344
  v_mfma_f32_16x16x32_bf16 v[132:135], a[156:159], a[136:139], v[132:135]
  buffer_load_dwordx4 v19, s[28:31], s55 offen offset:1024 lds
  v_mfma_f32_16x16x32_bf16 v[136:139], a[156:159], a[140:143], v[136:139]
  ds_read_b64_tr_b16 a[194:195], v207 offset:58368
  v_mfma_f32_16x16x32_bf16 v[140:143], a[156:159], a[144:147], v[140:143]
  v_mfma_f32_16x16x32_bf16 v[156:159], a[160:163], a[144:147], v[156:159]
  buffer_load_dwordx4 v20, s[28:31], s55 offen offset:2048 lds
  v_mfma_f32_16x16x32_bf16 v[152:155], a[160:163], a[140:143], v[152:155]
  v_mfma_f32_16x16x32_bf16 v[148:151], a[160:163], a[136:139], v[148:151]
  v_mfma_f32_16x16x32_bf16 v[144:147], a[160:163], a[132:135], v[144:147]
  buffer_load_dwordx4 v21, s[28:31], s55 offen offset:3072 lds
  s_waitcnt lgkmcnt(0)
  s_waitcnt vmcnt(8)
  s_barrier
  v_cmp_eq_u64 vcc, s[10:11], v[58:59]
  s_nop 1
  s_cmp_eq_u64 vcc, -1
  s_cbranch_scc0 L_ckr_14
L_ckb_15:
  v_mfma_f32_16x16x32_bf16 v[96:99], a[180:183], a[164:167], v[96:99]
  ds_read_b128 a[132:135], v192 offset:0
  ds_read_b64_tr_b16 a[148:149], v200 offset:16384
  v_mfma_f32_16x16x32_bf16 v[100:103], a[180:183], a[168:171], v[100:103]
  s_mul_i32 s19, s50, 5120
  s_add_u32 m0, s19, 65536
  s_add_u32 s68, s63, s50
  s_mul_i32 s68, s68, 21504
  s_add_u32 s68, s68, 23216128
  buffer_load_dwordx4 v2, s[36:39], s68 offen offset:0 sc1 lds
  v_mfma_f32_16x16x32_bf16 v[104:107], a[180:183], a[172:175], v[104:107]
  ds_read_b64_tr_b16 a[150:151], v200 offset:17408
  ds_read_b128 a[136:139], v192 offset:2048
  v_mfma_f32_16x16x32_bf16 v[108:111], a[180:183], a[176:179], v[108:111]
  ds_read_b64_tr_b16 a[152:153], v201 offset:16384
  ds_read_b64 v[40:41], v34 offset:0
  v_mfma_f32_16x16x32_bf16 v[124:127], a[184:187], a[176:179], v[124:127]
  ds_read_b64_tr_b16 a[154:155], v201 offset:17408
  ds_read_b128 a[140:143], v194 offset:0
  v_mfma_f32_16x16x32_bf16 v[120:123], a[184:187], a[172:175], v[120:123]
  buffer_load_dwordx4 v2, s[36:39], s68 offen offset:1024 sc1 lds
  ds_read_b64 v[222:223], v36 offset:0
  v_mfma_f32_16x16x32_bf16 v[116:119], a[184:187], a[168:171], v[116:119]
  ds_read_b64_tr_b16 a[156:157], v202 offset:16384
  ds_read_b64_tr_b16 a[158:159], v202 offset:17408
  v_mfma_f32_16x16x32_bf16 v[112:115], a[184:187], a[164:167], v[112:115]
  ds_read_b128 a[144:147], v194 offset:2048
  ds_read_b64 v[42:43], v34 offset:128
  v_mfma_f32_16x16x32_bf16 v[128:131], a[188:191], a[164:167], v[128:131]
  ds_read_b64_tr_b16 a[160:161], v203 offset:16384
  ds_read_b64 v[224:225], v36 offset:128
  v_mfma_f32_16x16x32_bf16 v[132:135], a[188:191], a[168:171], v[132:135]
  buffer_load_dwordx4 v2, s[36:39], s68 offen offset:2048 sc1 lds
  ds_read_b64 v[44:45], v35 offset:0
  v_mfma_f32_16x16x32_bf16 v[136:139], a[188:191], a[172:175], v[136:139]
  ds_read_b64_tr_b16 a[162:163], v203 offset:17408
  ds_read_b64 v[226:227], v37 offset:0
  v_mfma_f32_16x16x32_bf16 v[140:143], a[188:191], a[176:179], v[140:143]
  ds_read_b64 v[46:47], v35 offset:128
  ds_read_b64 v[228:229], v37 offset:128
  v_mfma_f32_16x16x32_bf16 v[156:159], a[192:195], a[176:179], v[156:159]
  ds_read_b32 v160, v60 offset:0
  ds_read_b32 v161, v60 offset:64
  v_mfma_f32_16x16x32_bf16 v[152:155], a[192:195], a[172:175], v[152:155]
  buffer_load_dwordx4 v2, s[36:39], s68 offen offset:3072 sc1 lds
  ds_read_b32 v162, v61 offset:0
  v_mfma_f32_16x16x32_bf16 v[148:151], a[192:195], a[168:171], v[148:151]
  ds_read_b32 v163, v61 offset:64
  v_mfma_f32_16x16x32_bf16 v[144:147], a[192:195], a[164:167], v[144:147]
  s_sub_u32 s52, s82, 2195456
  s_cselect_b32 s52, 2147483648, s52
  s_waitcnt lgkmcnt(0)
  v_mfma_f32_16x16x32_bf16 v[96:99], a[148:151], a[132:135], v[96:99]
  ds_read_b128 a[164:167], v193 offset:0
  ds_read_b64_tr_b16 a[180:181], v200 offset:24576
  v_mfma_f32_16x16x32_bf16 v[100:103], a[148:151], a[136:139], v[100:103]
  s_add_u32 m0, m0, 4096
  s_add_u32 s68, s68, 4096
  buffer_load_dwordx4 v2, s[36:39], s68 offen offset:0 sc1 lds
  v_mfma_f32_16x16x32_bf16 v[104:107], a[148:151], a[140:143], v[104:107]
  ds_read_b64_tr_b16 a[182:183], v200 offset:25600
  ds_read_b128 a[168:171], v193 offset:2048
  v_mfma_f32_16x16x32_bf16 v[108:111], a[148:151], a[144:147], v[108:111]
  ds_read_b64_tr_b16 a[184:185], v201 offset:24576
  v_mfma_f32_16x16x32_bf16 v[124:127], a[152:155], a[144:147], v[124:127]
  ds_read_b64_tr_b16 a[186:187], v201 offset:25600
  ds_read_b128 a[172:175], v195 offset:0
  v_mfma_f32_16x16x32_bf16 v[120:123], a[152:155], a[140:143], v[120:123]
  s_min_u32 s68, s50, 2
  s_mul_i32 s19, s68, 5120
  s_add_u32 m0, s19, 86016
  s_add_u32 s68, s68, s69
  s_mul_i32 s68, s68, 21504
  s_add_u32 s68, s68, 23216128
  buffer_load_dwordx4 v2, s[36:39], s68 offen offset:0 sc1 lds
  v_mfma_f32_16x16x32_bf16 v[116:119], a[152:155], a[136:139], v[116:119]
  ds_read_b64_tr_b16 a[188:189], v202 offset:24576
  ds_read_b64_tr_b16 a[190:191], v202 offset:25600
  v_mfma_f32_16x16x32_bf16 v[112:115], a[152:155], a[132:135], v[112:115]
  ds_read_b128 a[176:179], v195 offset:2048
  v_mfma_f32_16x16x32_bf16 v[128:131], a[156:159], a[132:135], v[128:131]
  ds_read_b64_tr_b16 a[192:193], v203 offset:24576
  v_mfma_f32_16x16x32_bf16 v[132:135], a[156:159], a[136:139], v[132:135]
  buffer_load_dwordx4 v2, s[36:39], s68 offen offset:1024 sc1 lds
  v_mfma_f32_16x16x32_bf16 v[136:139], a[156:159], a[140:143], v[136:139]
  ds_read_b64_tr_b16 a[194:195], v203 offset:25600
  v_mfma_f32_16x16x32_bf16 v[140:143], a[156:159], a[144:147], v[140:143]
  s_sub_u32 s53, s82, 1921024
  s_cselect_b32 s53, 2147483648, s53
  v_mfma_f32_16x16x32_bf16 v[156:159], a[160:163], a[144:147], v[156:159]
  s_sub_u32 s54, s82, 1646592
  s_cselect_b32 s54, 2147483648, s54
  v_mfma_f32_16x16x32_bf16 v[152:155], a[160:163], a[140:143], v[152:155]
  buffer_load_dwordx4 v2, s[36:39], s68 offen offset:2048 sc1 lds
  v_mfma_f32_16x16x32_bf16 v[148:151], a[160:163], a[136:139], v[148:151]
  s_sub_u32 s55, s82, 1372160
  s_cselect_b32 s55, 2147483648, s55
  v_mfma_f32_16x16x32_bf16 v[144:147], a[160:163], a[132:135], v[144:147]
  s_sub_u32 s56, s82, 1097728
  s_cselect_b32 s56, 2147483648, s56
  v_mfma_f32_16x16x16_bf16 v[96:99], v[222:223], v[40:41], v[96:99]
  s_sub_u32 s57, s82, 823296
  s_cselect_b32 s57, 2147483648, s57
  v_mfma_f32_16x16x16_bf16 v[100:103], v[222:223], v[42:43], v[100:103]
  s_sub_u32 s58, s82, 548864
  s_cselect_b32 s58, 2147483648, s58
  v_mfma_f32_16x16x16_bf16 v[104:107], v[222:223], v[44:45], v[104:107]
  s_sub_u32 s59, s82, 274432
  s_cselect_b32 s59, 2147483648, s59
  v_mfma_f32_16x16x16_bf16 v[108:111], v[222:223], v[46:47], v[108:111]
  s_add_u32 s60, s82, 0
  s_add_u32 s61, s82, 274432
  v_mfma_f32_16x16x16_bf16 v[112:115], v[224:225], v[40:41], v[112:115]
  v_mfma_f32_16x16x16_bf16 v[116:119], v[224:225], v[42:43], v[116:119]
  v_mfma_f32_16x16x16_bf16 v[120:123], v[224:225], v[44:45], v[120:123]
  v_mfma_f32_16x16x16_bf16 v[124:127], v[224:225], v[46:47], v[124:127]
  v_mfma_f32_16x16x16_bf16 v[128:131], v[226:227], v[40:41], v[128:131]
  v_mfma_f32_16x16x16_bf16 v[132:135], v[226:227], v[42:43], v[132:135]
  v_mfma_f32_16x16x16_bf16 v[136:139], v[226:227], v[44:45], v[136:139]
  v_mfma_f32_16x16x16_bf16 v[140:143], v[226:227], v[46:47], v[140:143]
  v_mfma_f32_16x16x16_bf16 v[144:147], v[228:229], v[40:41], v[144:147]
  v_mfma_f32_16x16x16_bf16 v[148:151], v[228:229], v[42:43], v[148:151]
  v_mfma_f32_16x16x16_bf16 v[152:155], v[228:229], v[44:45], v[152:155]
  v_mfma_f32_16x16x16_bf16 v[156:159], v[228:229], v[46:47], v[156:159]
  s_waitcnt lgkmcnt(0)
  s_waitcnt vmcnt(8)
  s_barrier
  v_mfma_f32_16x16x32_bf16 v[96:99], a[180:183], a[164:167], v[96:99]
  ds_read_b128 a[132:135], v192 offset:32768
  ds_read_b64_tr_b16 a[148:149], v200 offset:49152
  v_mfma_f32_16x16x32_bf16 v[100:103], a[180:183], a[168:171], v[100:103]
  ds_read_b64_tr_b16 a[150:151], v200 offset:50176
  ds_read_b128 a[136:139], v192 offset:34816
  v_mfma_f32_16x16x32_bf16 v[112:115], a[184:187], a[164:167], v[112:115]
  ds_read_b128 a[196:199], v193 offset:32768
  ds_read_b64_tr_b16 a[212:213], v200 offset:57344
  v_mfma_f32_16x16x32_bf16 v[116:119], a[184:187], a[168:171], v[116:119]
  ds_read_b64_tr_b16 a[214:215], v200 offset:58368
  ds_read_b128 a[200:203], v193 offset:34816
  s_waitcnt lgkmcnt(5)
  v_mfma_f32_16x16x32_bf16 v[96:99], a[148:151], a[132:135], v[96:99]
  ds_read_b64_tr_b16 a[152:153], v201 offset:49152
  ds_read_b64_tr_b16 a[154:155], v201 offset:50176
  s_waitcnt lgkmcnt(6)
  v_mfma_f32_16x16x32_bf16 v[100:103], a[148:151], a[136:139], v[100:103]
  ds_read_b64_tr_b16 a[216:217], v201 offset:57344
  ds_read_b64_tr_b16 a[218:219], v201 offset:58368
  s_waitcnt lgkmcnt(5)
  v_mfma_f32_16x16x32_bf16 v[96:99], a[212:215], a[196:199], v[96:99]
  buffer_load_dwordx2 v[58:59], v57, s[36:39], 0 offen offset:0 sc1
  ds_read_b64_tr_b16 a[156:157], v202 offset:49152
  s_waitcnt lgkmcnt(5)
  v_mfma_f32_16x16x32_bf16 v[100:103], a[212:215], a[200:203], v[100:103]
  ds_read_b64_tr_b16 a[158:159], v202 offset:50176
  ds_read_b64_tr_b16 a[220:221], v202 offset:57344
  v_mfma_f32_16x16x32_bf16 v[128:131], a[188:191], a[164:167], v[128:131]
  ds_read_b64_tr_b16 a[222:223], v202 offset:58368
  ds_read_b64_tr_b16 a[160:161], v203 offset:49152
  v_mfma_f32_16x16x32_bf16 v[132:135], a[188:191], a[168:171], v[132:135]
  ds_read_b64_tr_b16 a[162:163], v203 offset:50176
  v_mul_f32 v96, v96, v160
  v_mul_f32 v97, v97, v160
  v_mul_f32 v98, v98, v160
  v_mul_f32 v99, v99, v160
  s_waitcnt lgkmcnt(8)
  v_mfma_f32_16x16x32_bf16 v[112:115], a[152:155], a[132:135], v[112:115]
  ds_read_b64_tr_b16 a[224:225], v203 offset:57344
  v_mul_f32 v100, v100, v161
  v_mul_f32 v101, v101, v161
  v_mul_f32 v102, v102, v161
  v_mul_f32 v103, v103, v161
  v_mfma_f32_16x16x32_bf16 v[116:119], a[152:155], a[136:139], v[116:119]
  ds_read_b64_tr_b16 a[226:227], v203 offset:58368
  v_cvt_pk_bf16_f32 v64, v96, v97
  v_cvt_pk_bf16_f32 v65, v98, v99
  v_cvt_pk_bf16_f32 v66, v100, v101
  v_cvt_pk_bf16_f32 v67, v102, v103
  s_waitcnt lgkmcnt(8)
  v_mfma_f32_16x16x32_bf16 v[112:115], a[216:219], a[196:199], v[112:115]
  ds_read_b128 a[140:143], v194 offset:32768
  v_permlane16_swap_b32 v64, v66
  v_permlane16_swap_b32 v65, v67
  v_mfma_f32_16x16x32_bf16 v[116:119], a[216:219], a[200:203], v[116:119]
  ds_read_b128 a[204:207], v195 offset:32768
  buffer_store_dwordx4 v[64:67], v2, s[36:39], s0 offen offset:0 sc1
  v_mfma_f32_16x16x32_bf16 v[144:147], a[192:195], a[164:167], v[144:147]
  ds_read_b128 a[144:147], v194 offset:34816
  ds_read_b128 a[208:211], v195 offset:34816
  v_mfma_f32_16x16x32_bf16 v[148:151], a[192:195], a[168:171], v[148:151]
  v_mul_f32 v112, v112, v160
  v_mul_f32 v113, v113, v160
  v_mul_f32 v114, v114, v160
  v_mul_f32 v115, v115, v160
  v_mul_f32 v116, v116, v161
  s_waitcnt lgkmcnt(10)
  v_mfma_f32_16x16x32_bf16 v[128:131], a[156:159], a[132:135], v[128:131]
  v_mul_f32 v117, v117, v161
  v_mul_f32 v118, v118, v161
  v_mul_f32 v119, v119, v161
  v_cvt_pk_bf16_f32 v68, v112, v113
  v_cvt_pk_bf16_f32 v69, v114, v115
  v_mfma_f32_16x16x32_bf16 v[132:135], a[156:159], a[136:139], v[132:135]
  v_cvt_pk_bf16_f32 v70, v116, v117
  v_cvt_pk_bf16_f32 v71, v118, v119
  s_waitcnt lgkmcnt(8)
  v_mfma_f32_16x16x32_bf16 v[128:131], a[220:223], a[196:199], v[128:131]
  v_permlane16_swap_b32 v68, v70
  v_permlane16_swap_b32 v69, v71
  v_mfma_f32_16x16x32_bf16 v[132:135], a[220:223], a[200:203], v[132:135]
  buffer_store_dwordx4 v[68:71], v2, s[36:39], s0 offen offset:1024 sc1
  v_mfma_f32_16x16x32_bf16 v[104:107], a[180:183], a[172:175], v[104:107]
  v_mfma_f32_16x16x32_bf16 v[108:111], a[180:183], a[176:179], v[108:111]
  s_nop 1
  v_mul_f32 v128, v128, v160
  v_mul_f32 v129, v129, v160
  v_mul_f32 v130, v130, v160
  v_mul_f32 v131, v131, v160
  v_mul_f32 v132, v132, v161
  s_waitcnt lgkmcnt(6)
  v_mfma_f32_16x16x32_bf16 v[144:147], a[160:163], a[132:135], v[144:147]
  v_mul_f32 v133, v133, v161
  v_mul_f32 v134, v134, v161
  v_mul_f32 v135, v135, v161
  v_cvt_pk_bf16_f32 v72, v128, v129
  v_cvt_pk_bf16_f32 v73, v130, v131
  v_mfma_f32_16x16x32_bf16 v[148:151], a[160:163], a[136:139], v[148:151]
  v_cvt_pk_bf16_f32 v74, v132, v133
  v_cvt_pk_bf16_f32 v75, v134, v135
  s_waitcnt lgkmcnt(4)
  v_mfma_f32_16x16x32_bf16 v[144:147], a[224:227], a[196:199], v[144:147]
  v_permlane16_swap_b32 v72, v74
  v_permlane16_swap_b32 v73, v75
  v_mfma_f32_16x16x32_bf16 v[148:151], a[224:227], a[200:203], v[148:151]
  buffer_store_dwordx4 v[72:75], v2, s[36:39], s20 offen offset:0 sc1
  v_mfma_f32_16x16x32_bf16 v[120:123], a[184:187], a[172:175], v[120:123]
  v_mfma_f32_16x16x32_bf16 v[124:127], a[184:187], a[176:179], v[124:127]
  s_nop 1
  v_mul_f32 v144, v144, v160
  v_mul_f32 v145, v145, v160
  v_mul_f32 v146, v146, v160
  v_mul_f32 v147, v147, v160
  v_mul_f32 v148, v148, v161
  s_waitcnt lgkmcnt(3)
  v_mfma_f32_16x16x32_bf16 v[104:107], a[148:151], a[140:143], v[104:107]
  v_mul_f32 v149, v149, v161
  v_mul_f32 v150, v150, v161
  v_mul_f32 v151, v151, v161
  v_cvt_pk_bf16_f32 v76, v144, v145
  v_cvt_pk_bf16_f32 v77, v146, v147
  s_waitcnt lgkmcnt(1)
  v_mfma_f32_16x16x32_bf16 v[108:111], a[148:151], a[144:147], v[108:111]
  v_cvt_pk_bf16_f32 v78, v148, v149
  v_cvt_pk_bf16_f32 v79, v150, v151
  v_mfma_f32_16x16x32_bf16 v[104:107], a[212:215], a[204:207], v[104:107]
  v_permlane16_swap_b32 v76, v78
  v_permlane16_swap_b32 v77, v79
  s_waitcnt lgkmcnt(0)
  v_mfma_f32_16x16x32_bf16 v[108:111], a[212:215], a[208:211], v[108:111]
  buffer_store_dwordx4 v[76:79], v2, s[36:39], s20 offen offset:1024 sc1
  v_mfma_f32_16x16x32_bf16 v[136:139], a[188:191], a[172:175], v[136:139]
  v_mfma_f32_16x16x32_bf16 v[140:143], a[188:191], a[176:179], v[140:143]
  s_nop 0
  v_mul_f32 v104, v104, v162
  v_mul_f32 v105, v105, v162
  v_mul_f32 v106, v106, v162
  v_mul_f32 v107, v107, v162
  v_mul_f32 v108, v108, v163
  v_mul_f32 v109, v109, v163
  v_mul_f32 v110, v110, v163
  v_mfma_f32_16x16x32_bf16 v[120:123], a[152:155], a[140:143], v[120:123]
  v_mul_f32 v111, v111, v163
  v_cvt_pk_bf16_f32 v80, v104, v105
  v_cvt_pk_bf16_f32 v81, v106, v107
  v_cvt_pk_bf16_f32 v82, v108, v109
  v_cvt_pk_bf16_f32 v83, v110, v111
  v_mfma_f32_16x16x32_bf16 v[124:127], a[152:155], a[144:147], v[124:127]
  v_permlane16_swap_b32 v80, v82
  v_permlane16_swap_b32 v81, v83
  v_mfma_f32_16x16x32_bf16 v[120:123], a[216:219], a[204:207], v[120:123]
  buffer_store_dwordx4 v[80:83], v2, s[36:39], s1 offen offset:0 sc1
  v_mfma_f32_16x16x32_bf16 v[124:127], a[216:219], a[208:211], v[124:127]
  v_mfma_f32_16x16x32_bf16 v[152:155], a[192:195], a[172:175], v[152:155]
  v_mfma_f32_16x16x32_bf16 v[156:159], a[192:195], a[176:179], v[156:159]
  s_nop 3
  v_mul_f32 v120, v120, v162
  v_mul_f32 v121, v121, v162
  v_mul_f32 v122, v122, v162
  v_mul_f32 v123, v123, v162
  v_mul_f32 v124, v124, v163
  v_mul_f32 v125, v125, v163
  v_mul_f32 v126, v126, v163
  v_mfma_f32_16x16x32_bf16 v[136:139], a[156:159], a[140:143], v[136:139]
  v_mul_f32 v127, v127, v163
  v_cvt_pk_bf16_f32 v84, v120, v121
  v_cvt_pk_bf16_f32 v85, v122, v123
  v_cvt_pk_bf16_f32 v86, v124, v125
  v_cvt_pk_bf16_f32 v87, v126, v127
  v_mfma_f32_16x16x32_bf16 v[140:143], a[156:159], a[144:147], v[140:143]
  v_permlane16_swap_b32 v84, v86
  v_permlane16_swap_b32 v85, v87
  buffer_store_dwordx4 v[84:87], v2, s[36:39], s1 offen offset:1024 sc1
  v_mfma_f32_16x16x32_bf16 v[136:139], a[220:223], a[204:207], v[136:139]
  v_mfma_f32_16x16x32_bf16 v[140:143], a[220:223], a[208:211], v[140:143]
  v_mfma_f32_16x16x32_bf16 v[152:155], a[160:163], a[140:143], v[152:155]
  v_mfma_f32_16x16x32_bf16 v[156:159], a[160:163], a[144:147], v[156:159]
  s_nop 4
  v_mul_f32 v136, v136, v162
  v_mul_f32 v137, v137, v162
  v_mul_f32 v138, v138, v162
  v_mul_f32 v139, v139, v162
  v_mul_f32 v140, v140, v163
  v_mul_f32 v141, v141, v163
  v_mul_f32 v142, v142, v163
  v_mfma_f32_16x16x32_bf16 v[152:155], a[224:227], a[204:207], v[152:155]
  v_mul_f32 v143, v143, v163
  v_cvt_pk_bf16_f32 v88, v136, v137
  v_cvt_pk_bf16_f32 v89, v138, v139
  v_cvt_pk_bf16_f32 v90, v140, v141
  v_cvt_pk_bf16_f32 v91, v142, v143
  v_mfma_f32_16x16x32_bf16 v[156:159], a[224:227], a[208:211], v[156:159]
  v_permlane16_swap_b32 v88, v90
  v_permlane16_swap_b32 v89, v91
  buffer_store_dwordx4 v[88:91], v2, s[36:39], s21 offen offset:0 sc1
  v_mul_f32 v152, v152, v162
  v_mul_f32 v153, v153, v162
  v_mul_f32 v154, v154, v162
  v_mul_f32 v155, v155, v162
  s_nop 0
  v_mul_f32 v156, v156, v163
  v_mul_f32 v157, v157, v163
  v_mul_f32 v158, v158, v163
  v_mul_f32 v159, v159, v163
  v_cvt_pk_bf16_f32 v92, v152, v153
  v_cvt_pk_bf16_f32 v93, v154, v155
  v_cvt_pk_bf16_f32 v94, v156, v157
  v_cvt_pk_bf16_f32 v95, v158, v159
  s_nop 0
  v_permlane16_swap_b32 v92, v94
  v_permlane16_swap_b32 v93, v95
  buffer_store_dwordx4 v[92:95], v2, s[36:39], s21 offen offset:1024 sc1
  s_branch L_p1j
L_p1v:
L_tc0_4:
  s_cbranch_execz L_tr0
  s_waitcnt lgkmcnt(0)
  v_mfma_f32_16x16x32_bf16 v[96:99], a[132:135], a[148:151], 0
  ds_read_b128 a[164:167], v193 offset:0
  ds_read_b64_tr_b16 a[180:181], v200 offset:24576
  s_and_b32 s83, s49, 7
  s_mul_i32 s72, s83, 102400
  v_mfma_f32_16x16x32_bf16 v[112:115], a[132:135], a[152:155], 0
  s_add_u32 m0, s79, 65536
  s_nop 0
  buffer_load_dwordx4 v14, s[24:27], s56 offen offset:0 lds
  s_mul_i32 s73, s50, 25600
  s_add_u32 s72, s72, s73
  v_mfma_f32_16x16x32_bf16 v[128:131], a[132:135], a[156:159], 0
  ds_read_b64_tr_b16 a[182:183], v200 offset:25600
  ds_read_b128 a[168:171], v193 offset:2048
  s_add_u32 s62, s72, 20185088
  s_and_b32 s72, s49, 15
  v_mfma_f32_16x16x32_bf16 v[144:147], a[132:135], a[160:163], 0
  ds_read_b64_tr_b16 a[184:185], v201 offset:24576
  s_mul_i32 s72, s72, 7
  s_min_u32 s66, s72, 101
  v_mfma_f32_16x16x32_bf16 v[148:151], a[136:139], a[160:163], 0
  ds_read_b64_tr_b16 a[186:187], v201 offset:25600
  ds_read_b128 a[172:175], v195 offset:0
  v_mfma_f32_16x16x32_bf16 v[132:135], a[136:139], a[156:159], 0
  buffer_load_dwordx4 v15, s[24:27], s56 offen offset:1024 lds
  s_bitcmp1_b32 s66, 0
  s_cselect_b32 s72, 3, 0
  s_cselect_b32 s73, 0, 4
  v_mfma_f32_16x16x32_bf16 v[116:119], a[136:139], a[152:155], 0
  ds_read_b64_tr_b16 a[188:189], v202 offset:24576
  ds_read_b64_tr_b16 a[190:191], v202 offset:25600
  s_add_u32 s63, s66, s72
  s_add_u32 s69, s66, s73
  v_mfma_f32_16x16x32_bf16 v[100:103], a[136:139], a[148:151], 0
  ds_read_b128 a[176:179], v195 offset:2048
  s_mul_i32 s72, s50, 3072
  s_min_u32 s45, s72, 8192
  s_mul_i32 s72, s69, 21504
  v_mfma_f32_16x16x32_bf16 v[104:107], a[140:143], a[148:151], 0
  ds_read_b64_tr_b16 a[192:193], v203 offset:24576
  buffer_load_dwordx4 v16, s[24:27], s56 offen offset:2048 lds
  s_add_u32 s72, s72, s45
L_tc0_5:
  s_cbranch_execz L_tr0
  s_add_u32 s44, s72, 23226368
  v_mfma_f32_16x16x32_bf16 v[120:123], a[140:143], a[152:155], 0
  buffer_load_dwordx4 v17, s[24:27], s56 offen offset:3072 lds
  s_mul_i32 s67, s50, 14
  s_mul_i32 s72, s83, 54
  s_add_u32 s72, s72, s67
  v_mfma_f32_16x16x32_bf16 v[136:139], a[140:143], a[156:159], 0
  ds_read_b64_tr_b16 a[194:195], v203 offset:25600
  s_mul_i32 s72, s72, 5120
  s_add_u32 s64, s72, 21004288
  v_mfma_f32_16x16x32_bf16 v[152:155], a[140:143], a[160:163], 0
  s_add_u32 m0, s79, 81920
  s_nop 0
  buffer_load_dwordx4 v18, s[28:31], s57 offen offset:0 lds
  s_cmp_eq_u32 s50, 3
  s_cselect_b32 s65, 2147483648, s64
  v_mfma_f32_16x16x32_bf16 v[156:159], a[144:147], a[160:163], 0
  buffer_load_dwordx4 v19, s[28:31], s57 offen offset:1024 lds
  v_add_u32 v216, 32768, v29
  s_lshr_b32 s72, s49, 3
  s_lshl_b32 s72, s72, 1
  v_mfma_f32_16x16x32_bf16 v[140:143], a[144:147], a[156:159], 0
  s_lshl_b32 s73, s48, 3
  s_add_u32 s72, s72, s73
  s_mul_i32 s82, s72, 274432
  s_lshl_b32 s73, s50, 7
  v_mfma_f32_16x16x32_bf16 v[124:127], a[144:147], a[152:155], 0
  buffer_load_dwordx4 v20, s[28:31], s57 offen offset:2048 lds
  s_add_u32 s73, s73, 151552
  v_and_b32 v60, 48, v1
  v_add_u32 v60, s73, v60
  v_mfma_f32_16x16x32_bf16 v[108:111], a[144:147], a[148:151], 0
  buffer_load_dwordx4 v21, s[28:31], s57 offen offset:3072 lds
  v_xor_b32 v61, 128, v60
  s_lshl_b32 s72, s48, 11
  s_add_u32 s72, s72, 25821184
  s_bitcmp1_b32 s5, 0
  s_cbranch_scc0 L_du_16
  v_mfma_f32_16x16x32_bf16 v[68:71], v[64:67], a[132:135], 0
  v_mfma_f32_16x16x32_bf16 v[76:79], a[132:135], a[132:135], 0
  v_mfma_f32_16x16x32_bf16 v[72:75], v[64:67], a[136:139], 0
  v_mfma_f32_16x16x32_bf16 v[80:83], a[136:139], a[136:139], 0
L_du_16:
  s_bitcmp1_b32 s5, 1
  s_cbranch_scc0 L_du_17
  v_mfma_f32_16x16x32_bf16 v[84:87], v[64:67], a[148:151], 0
  v_mfma_f32_16x16x32_bf16 v[88:91], v[64:67], a[152:155], 0
L_du_17:
  s_waitcnt lgkmcnt(0)
  s_waitcnt vmcnt(8)
  s_barrier
  v_mfma_f32_16x16x32_bf16 v[96:99], a[164:167], a[180:183], v[96:99]
  ds_read_b128 a[132:135], v192 offset:32768
  ds_read_b64_tr_b16 a[148:149], v200 offset:49152
  v_and_b32 v57, 15, v1
  v_lshlrev_b32 v57, 5, v57
  v_mfma_f32_16x16x32_bf16 v[112:115], a[164:167], a[184:187], v[112:115]
  s_add_u32 m0, s79, 98304
  s_nop 0
  buffer_load_dwordx4 v14, s[24:27], s58 offen offset:0 lds
  v_add_u32 v57, s72, v57
  s_xor_b32 s73, s76, 0
  v_mfma_f32_16x16x32_bf16 v[128:131], a[164:167], a[188:191], v[128:131]
  ds_read_b64_tr_b16 a[150:151], v200 offset:50176
  ds_read_b128 a[136:139], v192 offset:34816
  s_lshl_b32 s73, s73, 5
  s_sub_u32 s74, s23, 10
  v_mfma_f32_16x16x32_bf16 v[144:147], a[164:167], a[192:195], v[144:147]
  ds_read_b64_tr_b16 a[152:153], v201 offset:49152
  s_lshl_b32 s74, s74, 7
  s_add_u32 s73, s73, s74
  v_lshrrev_b32 v63, 2, v32
  v_mfma_f32_16x16x32_bf16 v[148:151], a[168:171], a[192:195], v[148:151]
  ds_read_b64_tr_b16 a[154:155], v201 offset:50176
  ds_read_b128 a[140:143], v194 offset:32768
  v_add_u32 v63, s73, v63
  v_mul_u32_u24 v38, 3277, v63
  v_mfma_f32_16x16x32_bf16 v[132:135], a[168:171], a[188:191], v[132:135]
  buffer_load_dwordx4 v15, s[24:27], s58 offen offset:1024 lds
  v_lshrrev_b32 v38, 16, v38
  v_mul_u32_u24 v38, 960, v38
  v_lshl_add_u32 v38, v63, 4, v38
  v_mfma_f32_16x16x32_bf16 v[116:119], a[168:171], a[184:187], v[116:119]
  ds_read_b64_tr_b16 a[156:157], v202 offset:49152
  ds_read_b64_tr_b16 a[158:159], v202 offset:50176
  v_mul_u32_u24 v63, 320, v33
  v_add_u32 v38, v38, v63
  v_mfma_f32_16x16x32_bf16 v[100:103], a[168:171], a[180:183], v[100:103]
  ds_read_b128 a[144:147], v194 offset:34816
  s_xor_b32 s73, s76, 1
  s_lshl_b32 s73, s73, 5
  s_sub_u32 s74, s23, 10
  v_mfma_f32_16x16x32_bf16 v[104:107], a[172:175], a[180:183], v[104:107]
  ds_read_b64_tr_b16 a[160:161], v203 offset:49152
  s_lshl_b32 s74, s74, 7
  s_add_u32 s73, s73, s74
  v_lshrrev_b32 v63, 2, v32
  v_mfma_f32_16x16x32_bf16 v[120:123], a[172:175], a[184:187], v[120:123]
  buffer_load_dwordx4 v16, s[24:27], s58 offen offset:2048 lds
  v_add_u32 v63, s73, v63
  v_mul_u32_u24 v39, 3277, v63
  v_lshrrev_b32 v39, 16, v39
  v_mfma_f32_16x16x32_bf16 v[136:139], a[172:175], a[188:191], v[136:139]
  ds_read_b64_tr_b16 a[162:163], v203 offset:50176
  v_mul_u32_u24 v39, 960, v39
  v_lshl_add_u32 v39, v63, 4, v39
  v_mul_u32_u24 v63, 320, v33
  v_mfma_f32_16x16x32_bf16 v[152:155], a[172:175], a[192:195], v[152:155]
  v_add_u32 v39, v39, v63
  s_xor_b32 s73, s50, 0
  s_lshl_b32 s74, s22, 2
  s_add_u32 s73, s73, s74
  v_mfma_f32_16x16x32_bf16 v[156:159], a[176:179], a[192:195], v[156:159]
  s_mul_i32 s73, s73, 274432
  s_add_u32 s0, s73, 81920
  s_xor_b32 s73, s50, 1
  s_lshl_b32 s74, s22, 2
  v_mfma_f32_16x16x32_bf16 v[140:143], a[176:179], a[188:191], v[140:143]
  buffer_load_dwordx4 v17, s[24:27], s58 offen offset:3072 lds
  s_add_u32 s73, s73, s74
  s_mul_i32 s73, s73, 274432
  s_add_u32 s1, s73, 81920
  v_mfma_f32_16x16x32_bf16 v[124:127], a[176:179], a[184:187], v[124:127]
  v_mfma_f32_16x16x32_bf16 v[108:111], a[176:179], a[180:183], v[108:111]
  s_bitcmp1_b32 s5, 0
  s_cbranch_scc0 L_du_18
  v_mfma_f32_16x16x32_bf16 v[68:71], v[64:67], a[164:167], v[68:71]
  v_mfma_f32_16x16x32_bf16 v[76:79], a[164:167], a[164:167], v[76:79]
  v_mfma_f32_16x16x32_bf16 v[72:75], v[64:67], a[168:171], v[72:75]
  v_mfma_f32_16x16x32_bf16 v[80:83], a[168:171], a[168:171], v[80:83]
L_du_18:
  s_bitcmp1_b32 s5, 1
  s_cbranch_scc0 L_du_19
  v_mfma_f32_16x16x32_bf16 v[84:87], v[64:67], a[180:183], v[84:87]
  v_mfma_f32_16x16x32_bf16 v[88:91], v[64:67], a[184:187], v[88:91]
L_du_19:
  v_readfirstlane_b32 s10, v254
  v_readfirstlane_b32 s11, v255
  s_getreg_b32 s4, hwreg(HW_REG_XCC_ID, 0, 4)
  s_add_u32 s10, s10, 2135587861
  s_addc_u32 s11, s11, 2654435769
  v_mov_b32 v250, s10
  v_mov_b32 v251, s11
  v_mov_b32 v252, s4
  s_waitcnt lgkmcnt(0)
  v_mfma_f32_16x16x32_bf16 v[96:99], a[132:135], a[148:151], v[96:99]
  ds_read_b128 a[164:167], v193 offset:32768
  ds_read_b64_tr_b16 a[180:181], v200 offset:57344
  v_mfma_f32_16x16x32_bf16 v[112:115], a[132:135], a[152:155], v[112:115]
  s_add_u32 m0, s79, 114688
  s_nop 0
  buffer_load_dwordx4 v18, s[28:31], s59 offen offset:0 lds
  v_mfma_f32_16x16x32_bf16 v[128:131], a[132:135], a[156:159], v[128:131]
  ds_read_b64_tr_b16 a[182:183], v200 offset:58368
  ds_read_b128 a[168:171], v193 offset:34816
  v_mfma_f32_16x16x32_bf16 v[144:147], a[132:135], a[160:163], v[144:147]
  ds_read_b64_tr_b16 a[184:185], v201 offset:57344
  s_xor_b32 s52, s77, s47
  v_mfma_f32_16x16x32_bf16 v[148:151], a[136:139], a[160:163], v[148:151]
  ds_read_b64_tr_b16 a[186:187], v201 offset:58368
  ds_read_b128 a[172:175], v195 offset:32768
  v_mfma_f32_16x16x32_bf16 v[132:135], a[136:139], a[156:159], v[132:135]
  buffer_load_dwordx4 v19, s[28:31], s59 offen offset:1024 lds
  s_mul_i32 s53, s52, 245760
  v_mfma_f32_16x16x32_bf16 v[116:119], a[136:139], a[152:155], v[116:119]
  ds_read_b64_tr_b16 a[188:189], v202 offset:57344
  ds_read_b64_tr_b16 a[190:191], v202 offset:58368
  v_mfma_f32_16x16x32_bf16 v[100:103], a[136:139], a[148:151], v[100:103]
  ds_read_b128 a[176:179], v195 offset:34816
  s_lshl_b32 s52, s52, 7
  v_mfma_f32_16x16x32_bf16 v[104:107], a[140:143], a[148:151], v[104:107]
  ds_read_b64_tr_b16 a[192:193], v203 offset:57344
  s_add_u32 s77, s77, 1
  v_mfma_f32_16x16x32_bf16 v[120:123], a[140:143], a[152:155], v[120:123]
  buffer_load_dwordx4 v20, s[28:31], s59 offen offset:2048 lds
  v_mfma_f32_16x16x32_bf16 v[136:139], a[140:143], a[156:159], v[136:139]
  ds_read_b64_tr_b16 a[194:195], v203 offset:58368
  v_mfma_f32_16x16x32_bf16 v[152:155], a[140:143], a[160:163], v[152:155]
  s_cmp_eq_u32 s77, 10
  s_cselect_b32 s77, 0, s77
  v_mfma_f32_16x16x32_bf16 v[156:159], a[144:147], a[160:163], v[156:159]
  v_mfma_f32_16x16x32_bf16 v[140:143], a[144:147], a[156:159], v[140:143]
  buffer_load_dwordx4 v21, s[28:31], s59 offen offset:3072 lds
  v_mfma_f32_16x16x32_bf16 v[124:127], a[144:147], a[152:155], v[124:127]
  v_mfma_f32_16x16x32_bf16 v[108:111], a[144:147], a[148:151], v[108:111]
  s_bitcmp1_b32 s5, 0
  s_cbranch_scc0 L_du_20
  v_mfma_f32_16x16x32_bf16 v[68:71], v[64:67], a[132:135], v[68:71]
  v_mfma_f32_16x16x32_bf16 v[76:79], a[132:135], a[132:135], v[76:79]
  v_mfma_f32_16x16x32_bf16 v[72:75], v[64:67], a[136:139], v[72:75]
  v_mfma_f32_16x16x32_bf16 v[80:83], a[136:139], a[136:139], v[80:83]
L_du_20:
  s_bitcmp1_b32 s5, 1
  s_cbranch_scc0 L_du_21
  v_mfma_f32_16x16x32_bf16 v[84:87], v[64:67], a[148:151], v[84:87]
  v_mfma_f32_16x16x32_bf16 v[88:91], v[64:67], a[152:155], v[88:91]
L_du_21:
  v_mov_b32 v253, 0
  v_mov_b32 v254, s10
  v_mov_b32 v255, s11
  v_mov_b32 v246, s10
  v_mov_b32 v247, s11
  s_mov_b32 s12, 2863311530
  s_mov_b32 s13, 2863311530
  s_waitcnt lgkmcnt(0)
  s_waitcnt vmcnt(8)
  s_barrier
  v_mfma_f32_16x16x32_bf16 v[96:99], a[164:167], a[180:183], v[96:99]
  ds_read_b128 a[132:135], v196 offset:0
  ds_read_b64_tr_b16 a[148:149], v204 offset:16384
  v_mfma_f32_16x16x32_bf16 v[112:115], a[164:167], a[184:187], v[112:115]
  s_add_u32 m0, s79, 0
  s_nop 0
  buffer_load_dwordx4 v14, s[24:27], s52 offen offset:0 lds
  v_mfma_f32_16x16x32_bf16 v[128:131], a[164:167], a[188:191], v[128:131]
  ds_read_b64_tr_b16 a[150:151], v204 offset:17408
  ds_read_b128 a[136:139], v196 offset:2048
  v_mfma_f32_16x16x32_bf16 v[144:147], a[164:167], a[192:195], v[144:147]
  ds_read_b64_tr_b16 a[152:153], v205 offset:16384
  v_mfma_f32_16x16x32_bf16 v[148:151], a[168:171], a[192:195], v[148:151]
  ds_read_b64_tr_b16 a[154:155], v205 offset:17408
  ds_read_b128 a[140:143], v198 offset:0
  v_mfma_f32_16x16x32_bf16 v[132:135], a[168:171], a[188:191], v[132:135]
  buffer_load_dwordx4 v15, s[24:27], s52 offen offset:1024 lds
  v_mfma_f32_16x16x32_bf16 v[116:119], a[168:171], a[184:187], v[116:119]
  ds_read_b64_tr_b16 a[156:157], v206 offset:16384
  ds_read_b64_tr_b16 a[158:159], v206 offset:17408
  v_mfma_f32_16x16x32_bf16 v[100:103], a[168:171], a[180:183], v[100:103]
  ds_read_b128 a[144:147], v198 offset:2048
  v_mfma_f32_16x16x32_bf16 v[104:107], a[172:175], a[180:183], v[104:107]
  ds_read_b64_tr_b16 a[160:161], v207 offset:16384
  v_mfma_f32_16x16x32_bf16 v[120:123], a[172:175], a[184:187], v[120:123]
  buffer_load_dwordx4 v16, s[24:27], s52 offen offset:2048 lds
  v_mfma_f32_16x16x32_bf16 v[136:139], a[172:175], a[188:191], v[136:139]
  ds_read_b64_tr_b16 a[162:163], v207 offset:17408
  v_mfma_f32_16x16x32_bf16 v[152:155], a[172:175], a[192:195], v[152:155]
  v_mfma_f32_16x16x32_bf16 v[156:159], a[176:179], a[192:195], v[156:159]
  buffer_load_dwordx4 v17, s[24:27], s52 offen offset:3072 lds
  v_mfma_f32_16x16x32_bf16 v[140:143], a[176:179], a[188:191], v[140:143]
  v_mfma_f32_16x16x32_bf16 v[124:127], a[176:179], a[184:187], v[124:127]
  v_mfma_f32_16x16x32_bf16 v[108:111], a[176:179], a[180:183], v[108:111]
  s_add_u32 m0, s79, 16384
  s_nop 0
  buffer_load_dwordx4 v18, s[28:31], s53 offen offset:0 lds
  s_bitcmp1_b32 s5, 0
  s_cbranch_scc0 L_du_22
  v_mfma_f32_16x16x32_bf16 v[68:71], v[64:67], a[164:167], v[68:71]
  v_mfma_f32_16x16x32_bf16 v[76:79], a[164:167], a[164:167], v[76:79]
  v_mfma_f32_16x16x32_bf16 v[72:75], v[64:67], a[168:171], v[72:75]
  v_mfma_f32_16x16x32_bf16 v[80:83], a[168:171], a[168:171], v[80:83]
L_du_22:
  s_bitcmp1_b32 s5, 1
  s_cbranch_scc0 L_du_23
  v_mfma_f32_16x16x32_bf16 v[84:87], v[64:67], a[180:183], v[84:87]
  v_mfma_f32_16x16x32_bf16 v[88:91], v[64:67], a[184:187], v[88:91]
L_du_23:
  s_mov_b32 s14, 3435973836
  s_mov_b32 s15, 3435973836
  s_mov_b32 s16, 4294901760
  s_mov_b32 s17, 4294901760
  s_bitcmp1_b32 s5, 0
  s_cselect_b32 s18, -1, 0
  s_bitcmp1_b32 s5, 1
  s_cselect_b32 s19, -1, 0
  v_mov_b32 v55, 2147483648
  s_waitcnt lgkmcnt(0)
  v_mfma_f32_16x16x32_bf16 v[96:99], a[132:135], a[148:151], v[96:99]
  ds_read_b128 a[164:167], v197 offset:0
  ds_read_b64_tr_b16 a[180:181], v204 offset:24576
  v_mfma_f32_16x16x32_bf16 v[112:115], a[132:135], a[152:155], v[112:115]
  buffer_load_dwordx4 v19, s[28:31], s53 offen offset:1024 lds
  s_xor_b32 s54, s77, s47
  v_mfma_f32_16x16x32_bf16 v[128:131], a[132:135], a[156:159], v[128:131]
  ds_read_b64_tr_b16 a[182:183], v204 offset:25600
  ds_read_b128 a[168:171], v197 offset:2048
  v_mfma_f32_16x16x32_bf16 v[144:147], a[132:135], a[160:163], v[144:147]
  ds_read_b64_tr_b16 a[184:185], v205 offset:24576
  s_mul_i32 s55, s54, 245760
  v_cndmask_b32 v55, v55, v56, s[18:19]
  v_cndmask_b32 v76, v76, v77, s[12:13]
  v_mfma_f32_16x16x32_bf16 v[148:151], a[136:139], a[160:163], v[148:151]
  ds_read_b64_tr_b16 a[186:187], v205 offset:25600
  ds_read_b128 a[172:175], v199 offset:0
  v_cndmask_b32 v78, v78, v79, s[12:13]
  v_cndmask_b32 v76, v76, v78, s[14:15]
  v_mfma_f32_16x16x32_bf16 v[132:135], a[136:139], a[156:159], v[132:135]
  buffer_load_dwordx4 v20, s[28:31], s53 offen offset:2048 lds
  s_lshl_b32 s54, s54, 7
  ds_bpermute_b32 v77, v53, v76
  v_cndmask_b32 v80, v80, v81, s[12:13]
  v_mfma_f32_16x16x32_bf16 v[116:119], a[136:139], a[152:155], v[116:119]
  ds_read_b64_tr_b16 a[188:189], v206 offset:24576
  ds_read_b64_tr_b16 a[190:191], v206 offset:25600
  v_cndmask_b32 v82, v82, v83, s[12:13]
  v_cndmask_b32 v80, v80, v82, s[14:15]
  v_mfma_f32_16x16x32_bf16 v[100:103], a[136:139], a[148:151], v[100:103]
  ds_read_b128 a[176:179], v199 offset:2048
  s_add_u32 s77, s77, 1
  ds_bpermute_b32 v81, v53, v80
  v_cndmask_b32 v68, v68, v72, s[16:17]
  v_mfma_f32_16x16x32_bf16 v[104:107], a[140:143], a[148:151], v[104:107]
  ds_read_b64_tr_b16 a[192:193], v207 offset:24576
  v_cndmask_b32 v84, v84, v88, s[16:17]
  v_cndmask_b32 v244, v84, v68, s[8:9]
  s_waitcnt lgkmcnt(1)
  v_cndmask_b32 v245, v77, v81, s[16:17]
  v_mfma_f32_16x16x32_bf16 v[120:123], a[140:143], a[152:155], v[120:123]
  buffer_load_dwordx4 v21, s[28:31], s53 offen offset:3072 lds
  buffer_store_dwordx4 v[244:247], v55, s[36:39], s80 offen sc1
  v_mfma_f32_16x16x32_bf16 v[136:139], a[140:143], a[156:159], v[136:139]
  ds_read_b64_tr_b16 a[194:195], v207 offset:25600
  buffer_store_dwordx4 v[250:253], v29, s[36:39], 0 offen sc1
  v_mfma_f32_16x16x32_bf16 v[152:155], a[140:143], a[160:163], v[152:155]
  s_cmp_eq_u32 s77, 10
  s_cselect_b32 s77, 0, s77
  v_mfma_f32_16x16x32_bf16 v[156:159], a[144:147], a[160:163], v[156:159]
  s_add_u32 m0, s46, 131072
  s_nop 0
  buffer_load_dwordx4 v22, s[32:35], s6 offen offset:0 lds
  v_mfma_f32_16x16x32_bf16 v[140:143], a[144:147], a[156:159], v[140:143]
  v_mfma_f32_16x16x32_bf16 v[124:127], a[144:147], a[152:155], v[124:127]
  v_mfma_f32_16x16x32_bf16 v[108:111], a[144:147], a[148:151], v[108:111]
  buffer_load_dwordx4 v23, s[32:35], s6 offen offset:1024 lds
  s_waitcnt lgkmcnt(0)
  s_waitcnt vmcnt(12)
  s_barrier
  v_mfma_f32_16x16x32_bf16 v[96:99], a[164:167], a[180:183], v[96:99]
  ds_read_b128 a[132:135], v196 offset:32768
  ds_read_b64_tr_b16 a[148:149], v204 offset:49152
  v_mfma_f32_16x16x32_bf16 v[112:115], a[164:167], a[184:187], v[112:115]
  buffer_load_dwordx4 v24, s[32:35], s6 offen offset:2048 lds
  v_mfma_f32_16x16x32_bf16 v[128:131], a[164:167], a[188:191], v[128:131]
  ds_read_b64_tr_b16 a[150:151], v204 offset:50176
  ds_read_b128 a[136:139], v196 offset:34816
  v_mfma_f32_16x16x32_bf16 v[144:147], a[164:167], a[192:195], v[144:147]
  ds_read_b64_tr_b16 a[152:153], v205 offset:49152
  v_mfma_f32_16x16x32_bf16 v[148:151], a[168:171], a[192:195], v[148:151]
  ds_read_b64_tr_b16 a[154:155], v205 offset:50176
  ds_read_b128 a[140:143], v198 offset:32768
  v_mfma_f32_16x16x32_bf16 v[132:135], a[168:171], a[188:191], v[132:135]
  buffer_load_dwordx4 v25, s[32:35], s6 offen offset:3072 lds
  v_mfma_f32_16x16x32_bf16 v[116:119], a[168:171], a[184:187], v[116:119]
  ds_read_b64_tr_b16 a[156:157], v206 offset:49152
  ds_read_b64_tr_b16 a[158:159], v206 offset:50176
  v_mfma_f32_16x16x32_bf16 v[100:103], a[168:171], a[180:183], v[100:103]
  ds_read_b128 a[144:147], v198 offset:34816
  v_mfma_f32_16x16x32_bf16 v[104:107], a[172:175], a[180:183], v[104:107]
  ds_read_b64_tr_b16 a[160:161], v207 offset:49152
  v_mfma_f32_16x16x32_bf16 v[120:123], a[172:175], a[184:187], v[120:123]
  s_add_u32 m0, s46, 135168
  s_nop 0
  buffer_load_dwordx4 v26, s[32:35], s6 offen offset:0 lds
  v_mfma_f32_16x16x32_bf16 v[136:139], a[172:175], a[188:191], v[136:139]
  ds_read_b64_tr_b16 a[162:163], v207 offset:50176
  v_mfma_f32_16x16x32_bf16 v[152:155], a[172:175], a[192:195], v[152:155]
  v_mfma_f32_16x16x32_bf16 v[156:159], a[176:179], a[192:195], v[156:159]
  s_add_u32 m0, s79, 32768
  s_nop 0
  buffer_load_dwordx4 v14, s[24:27], s54 offen offset:0 lds
  v_mfma_f32_16x16x32_bf16 v[140:143], a[176:179], a[188:191], v[140:143]
  v_mfma_f32_16x16x32_bf16 v[124:127], a[176:179], a[184:187], v[124:127]
  v_mfma_f32_16x16x32_bf16 v[108:111], a[176:179], a[180:183], v[108:111]
  buffer_load_dwordx4 v15, s[24:27], s54 offen offset:1024 lds
  s_waitcnt lgkmcnt(0)
  v_mfma_f32_16x16x32_bf16 v[96:99], a[132:135], a[148:151], v[96:99]
  ds_read_b128 a[164:167], v197 offset:32768
  ds_read_b64_tr_b16 a[180:181], v204 offset:57344
  v_mfma_f32_16x16x32_bf16 v[112:115], a[132:135], a[152:155], v[112:115]
  buffer_load_dwordx4 v16, s[24:27], s54 offen offset:2048 lds
  s_xor_b32 s56, s77, s47
  v_mfma_f32_16x16x32_bf16 v[128:131], a[132:135], a[156:159], v[128:131]
  ds_read_b64_tr_b16 a[182:183], v204 offset:58368
  ds_read_b128 a[168:171], v197 offset:34816
  v_mfma_f32_16x16x32_bf16 v[144:147], a[132:135], a[160:163], v[144:147]
  ds_read_b64_tr_b16 a[184:185], v205 offset:57344
  s_mul_i32 s57, s56, 245760
  v_mfma_f32_16x16x32_bf16 v[148:151], a[136:139], a[160:163], v[148:151]
  ds_read_b64_tr_b16 a[186:187], v205 offset:58368
  ds_read_b128 a[172:175], v199 offset:32768
  v_mfma_f32_16x16x32_bf16 v[132:135], a[136:139], a[156:159], v[132:135]
  buffer_load_dwordx4 v17, s[24:27], s54 offen offset:3072 lds
  s_lshl_b32 s56, s56, 7
  v_mfma_f32_16x16x32_bf16 v[116:119], a[136:139], a[152:155], v[116:119]
  ds_read_b64_tr_b16 a[188:189], v206 offset:57344
  ds_read_b64_tr_b16 a[190:191], v206 offset:58368
  v_mfma_f32_16x16x32_bf16 v[100:103], a[136:139], a[148:151], v[100:103]
  ds_read_b128 a[176:179], v199 offset:34816
  s_add_u32 s77, s77, 1
  v_mfma_f32_16x16x32_bf16 v[104:107], a[140:143], a[148:151], v[104:107]
  ds_read_b64_tr_b16 a[192:193], v207 offset:57344
  v_mfma_f32_16x16x32_bf16 v[120:123], a[140:143], a[152:155], v[120:123]
  s_add_u32 m0, s79, 49152
  s_nop 0
  buffer_load_dwordx4 v18, s[28:31], s55 offen offset:0 lds
  v_mfma_f32_16x16x32_bf16 v[136:139], a[140:143], a[156:159], v[136:139]
  ds_read_b64_tr_b16 a[194:195], v207 offset:58368
  v_mfma_f32_16x16x32_bf16 v[152:155], a[140:143], a[160:163], v[152:155]
  s_cmp_eq_u32 s77, 10
  s_cselect_b32 s77, 0, s77
  v_mfma_f32_16x16x32_bf16 v[156:159], a[144:147], a[160:163], v[156:159]
  buffer_load_dwordx4 v19, s[28:31], s55 offen offset:1024 lds
  v_mfma_f32_16x16x32_bf16 v[140:143], a[144:147], a[156:159], v[140:143]
  v_mfma_f32_16x16x32_bf16 v[124:127], a[144:147], a[152:155], v[124:127]
  v_mfma_f32_16x16x32_bf16 v[108:111], a[144:147], a[148:151], v[108:111]
  buffer_load_dwordx4 v20, s[28:31], s55 offen offset:2048 lds
  s_waitcnt lgkmcnt(0)
  s_waitcnt vmcnt(14)
  s_barrier
  v_mfma_f32_16x16x32_bf16 v[96:99], a[164:167], a[180:183], v[96:99]
  ds_read_b128 a[132:135], v192 offset:0
  ds_read_b64_tr_b16 a[148:149], v200 offset:16384
  v_mfma_f32_16x16x32_bf16 v[112:115], a[164:167], a[184:187], v[112:115]
  buffer_load_dwordx4 v21, s[28:31], s55 offen offset:3072 lds
  v_mfma_f32_16x16x32_bf16 v[128:131], a[164:167], a[188:191], v[128:131]
  ds_read_b64_tr_b16 a[150:151], v200 offset:17408
  ds_read_b128 a[136:139], v192 offset:2048
  v_mfma_f32_16x16x32_bf16 v[144:147], a[164:167], a[192:195], v[144:147]
  ds_read_b64_tr_b16 a[152:153], v201 offset:16384
  v_mfma_f32_16x16x32_bf16 v[148:151], a[168:171], a[192:195], v[148:151]
  ds_read_b64_tr_b16 a[154:155], v201 offset:17408
  ds_read_b128 a[140:143], v194 offset:0
  v_mfma_f32_16x16x32_bf16 v[132:135], a[168:171], a[188:191], v[132:135]
  s_add_u32 m0, s79, 65536
  s_nop 0
  buffer_load_dwordx4 v14, s[24:27], s56 offen offset:0 lds
  v_mfma_f32_16x16x32_bf16 v[116:119], a[168:171], a[184:187], v[116:119]
  ds_read_b64_tr_b16 a[156:157], v202 offset:16384
  ds_read_b64_tr_b16 a[158:159], v202 offset:17408
  v_mfma_f32_16x16x32_bf16 v[100:103], a[168:171], a[180:183], v[100:103]
  ds_read_b128 a[144:147], v194 offset:2048
  v_mfma_f32_16x16x32_bf16 v[104:107], a[172:175], a[180:183], v[104:107]
  ds_read_b64_tr_b16 a[160:161], v203 offset:16384
  v_mfma_f32_16x16x32_bf16 v[120:123], a[172:175], a[184:187], v[120:123]
  buffer_load_dwordx4 v15, s[24:27], s56 offen offset:1024 lds
  v_mfma_f32_16x16x32_bf16 v[136:139], a[172:175], a[188:191], v[136:139]
  ds_read_b64_tr_b16 a[162:163], v203 offset:17408
  v_mfma_f32_16x16x32_bf16 v[152:155], a[172:175], a[192:195], v[152:155]
  v_mfma_f32_16x16x32_bf16 v[156:159], a[176:179], a[192:195], v[156:159]
  buffer_load_dwordx4 v16, s[24:27], s56 offen offset:2048 lds
  v_mfma_f32_16x16x32_bf16 v[140:143], a[176:179], a[188:191], v[140:143]
  v_mfma_f32_16x16x32_bf16 v[124:127], a[176:179], a[184:187], v[124:127]
  v_mfma_f32_16x16x32_bf16 v[108:111], a[176:179], a[180:183], v[108:111]
  buffer_load_dwordx4 v17, s[24:27], s56 offen offset:3072 lds
  s_waitcnt lgkmcnt(0)
  v_mfma_f32_16x16x32_bf16 v[96:99], a[132:135], a[148:151], v[96:99]
  ds_read_b128 a[164:167], v193 offset:0
  ds_read_b64_tr_b16 a[180:181], v200 offset:24576
  v_mfma_f32_16x16x32_bf16 v[112:115], a[132:135], a[152:155], v[112:115]
  s_add_u32 m0, s79, 81920
  s_nop 0
  buffer_load_dwordx4 v18, s[28:31], s57 offen offset:0 lds
  v_mfma_f32_16x16x32_bf16 v[128:131], a[132:135], a[156:159], v[128:131]
  ds_read_b64_tr_b16 a[182:183], v200 offset:25600
  ds_read_b128 a[168:171], v193 offset:2048
  v_mfma_f32_16x16x32_bf16 v[144:147], a[132:135], a[160:163], v[144:147]
  ds_read_b64_tr_b16 a[184:185], v201 offset:24576
  s_xor_b32 s58, s77, s47
  v_mfma_f32_16x16x32_bf16 v[148:151], a[136:139], a[160:163], v[148:151]
  ds_read_b64_tr_b16 a[186:187], v201 offset:25600
  ds_read_b128 a[172:175], v195 offset:0
  v_mfma_f32_16x16x32_bf16 v[132:135], a[136:139], a[156:159], v[132:135]
  buffer_load_dwordx4 v19, s[28:31], s57 offen offset:1024 lds
  s_mul_i32 s59, s58, 245760
  v_mfma_f32_16x16x32_bf16 v[116:119], a[136:139], a[152:155], v[116:119]
  ds_read_b64_tr_b16 a[188:189], v202 offset:24576
  ds_read_b64_tr_b16 a[190:191], v202 offset:25600
  v_mfma_f32_16x16x32_bf16 v[100:103], a[136:139], a[148:151], v[100:103]
  ds_read_b128 a[176:179], v195 offset:2048
  s_lshl_b32 s58, s58, 7
  v_mfma_f32_16x16x32_bf16 v[104:107], a[140:143], a[148:151], v[104:107]
  ds_read_b64_tr_b16 a[192:193], v203 offset:24576
  s_add_u32 s77, s77, 1
  v_mfma_f32_16x16x32_bf16 v[120:123], a[140:143], a[152:155], v[120:123]
  buffer_load_dwordx4 v20, s[28:31], s57 offen offset:2048 lds
  v_mfma_f32_16x16x32_bf16 v[136:139], a[140:143], a[156:159], v[136:139]
  ds_read_b64_tr_b16 a[194:195], v203 offset:25600
  v_mfma_f32_16x16x32_bf16 v[152:155], a[140:143], a[160:163], v[152:155]
  s_cmp_eq_u32 s77, 10
  s_cselect_b32 s77, 0, s77
  v_mfma_f32_16x16x32_bf16 v[156:159], a[144:147], a[160:163], v[156:159]
  v_mfma_f32_16x16x32_bf16 v[140:143], a[144:147], a[156:159], v[140:143]
  buffer_load_dwordx4 v21, s[28:31], s57 offen offset:3072 lds
  v_mfma_f32_16x16x32_bf16 v[124:127], a[144:147], a[152:155], v[124:127]
  v_mfma_f32_16x16x32_bf16 v[108:111], a[144:147], a[148:151], v[108:111]
  s_waitcnt lgkmcnt(0)
  s_waitcnt vmcnt(8)
  s_barrier
  v_mfma_f32_16x16x32_bf16 v[96:99], a[164:167], a[180:183], v[96:99]
  ds_read_b128 a[132:135], v192 offset:32768
  ds_read_b64_tr_b16 a[148:149], v200 offset:49152
  v_mfma_f32_16x16x32_bf16 v[112:115], a[164:167], a[184:187], v[112:115]
  s_mov_b32 s75, 0
  buffer_load_dwordx4 v[160:163], v56, s[36:39], s75 offen offset:0 sc1
  v_mfma_f32_16x16x32_bf16 v[128:131], a[164:167], a[188:191], v[128:131]
  ds_read_b64_tr_b16 a[150:151], v200 offset:50176
  ds_read_b128 a[136:139], v192 offset:34816
  v_mfma_f32_16x16x32_bf16 v[144:147], a[164:167], a[192:195], v[144:147]
  ds_read_b64_tr_b16 a[152:153], v201 offset:49152
  v_mfma_f32_16x16x32_bf16 v[148:151], a[168:171], a[192:195], v[148:151]
  ds_read_b64_tr_b16 a[154:155], v201 offset:50176
  ds_read_b128 a[140:143], v194 offset:32768
  v_mfma_f32_16x16x32_bf16 v[132:135], a[168:171], a[188:191], v[132:135]
  buffer_load_dwordx4 v[164:167], v56, s[36:39], s75 offen offset:2048 sc1
  v_mfma_f32_16x16x32_bf16 v[116:119], a[168:171], a[184:187], v[116:119]
  ds_read_b64_tr_b16 a[156:157], v202 offset:49152
  ds_read_b64_tr_b16 a[158:159], v202 offset:50176
  v_mfma_f32_16x16x32_bf16 v[100:103], a[168:171], a[180:183], v[100:103]
  ds_read_b128 a[144:147], v194 offset:34816
  v_mfma_f32_16x16x32_bf16 v[104:107], a[172:175], a[180:183], v[104:107]
  ds_read_b64_tr_b16 a[160:161], v203 offset:49152
  v_mfma_f32_16x16x32_bf16 v[120:123], a[172:175], a[184:187], v[120:123]
  s_mov_b32 s75, 4096
  buffer_load_dwordx4 v[168:171], v56, s[36:39], s75 offen offset:0 sc1
  v_mfma_f32_16x16x32_bf16 v[136:139], a[172:175], a[188:191], v[136:139]
  ds_read_b64_tr_b16 a[162:163], v203 offset:50176
  v_mfma_f32_16x16x32_bf16 v[152:155], a[172:175], a[192:195], v[152:155]
  v_mfma_f32_16x16x32_bf16 v[156:159], a[176:179], a[192:195], v[156:159]
  buffer_load_dwordx4 v[172:175], v56, s[36:39], s75 offen offset:2048 sc1
  v_mfma_f32_16x16x32_bf16 v[140:143], a[176:179], a[188:191], v[140:143]
  v_mfma_f32_16x16x32_bf16 v[124:127], a[176:179], a[184:187], v[124:127]
  v_mfma_f32_16x16x32_bf16 v[108:111], a[176:179], a[180:183], v[108:111]
  s_mov_b32 s75, 8192
  buffer_load_dwordx4 v[176:179], v56, s[36:39], s75 offen offset:0 sc1
  s_waitcnt lgkmcnt(0)
  v_mfma_f32_16x16x32_bf16 v[96:99], a[132:135], a[148:151], v[96:99]
  ds_read_b128 a[164:167], v193 offset:32768
  ds_read_b64_tr_b16 a[180:181], v200 offset:57344
  v_mfma_f32_16x16x32_bf16 v[112:115], a[132:135], a[152:155], v[112:115]
  s_add_u32 m0, s79, 98304
  s_nop 0
  buffer_load_dwordx4 v14, s[24:27], s58 offen offset:0 lds
  v_mfma_f32_16x16x32_bf16 v[128:131], a[132:135], a[156:159], v[128:131]
  ds_read_b64_tr_b16 a[182:183], v200 offset:58368
  ds_read_b128 a[168:171], v193 offset:34816
  v_mfma_f32_16x16x32_bf16 v[144:147], a[132:135], a[160:163], v[144:147]
  ds_read_b64_tr_b16 a[184:185], v201 offset:57344
  s_xor_b32 s52, s77, s47
  v_mfma_f32_16x16x32_bf16 v[148:151], a[136:139], a[160:163], v[148:151]
  ds_read_b64_tr_b16 a[186:187], v201 offset:58368
  ds_read_b128 a[172:175], v195 offset:32768
  v_mfma_f32_16x16x32_bf16 v[132:135], a[136:139], a[156:159], v[132:135]
  buffer_load_dwordx4 v15, s[24:27], s58 offen offset:1024 lds
  s_mul_i32 s53, s52, 245760
  v_mfma_f32_16x16x32_bf16 v[116:119], a[136:139], a[152:155], v[116:119]
  ds_read_b64_tr_b16 a[188:189], v202 offset:57344
  ds_read_b64_tr_b16 a[190:191], v202 offset:58368
  v_mfma_f32_16x16x32_bf16 v[100:103], a[136:139], a[148:151], v[100:103]
  ds_read_b128 a[176:179], v195 offset:34816
  s_lshl_b32 s52, s52, 7
  v_mfma_f32_16x16x32_bf16 v[104:107], a[140:143], a[148:151], v[104:107]
  ds_read_b64_tr_b16 a[192:193], v203 offset:57344
  s_add_u32 s77, s77, 1
  v_mfma_f32_16x16x32_bf16 v[120:123], a[140:143], a[152:155], v[120:123]
  buffer_load_dwordx4 v16, s[24:27], s58 offen offset:2048 lds
  v_mfma_f32_16x16x32_bf16 v[136:139], a[140:143], a[156:159], v[136:139]
  ds_read_b64_tr_b16 a[194:195], v203 offset:58368
  v_mfma_f32_16x16x32_bf16 v[152:155], a[140:143], a[160:163], v[152:155]
  s_cmp_eq_u32 s77, 10
  s_cselect_b32 s77, 0, s77
  v_mfma_f32_16x16x32_bf16 v[156:159], a[144:147], a[160:163], v[156:159]
  buffer_load_dwordx4 v17, s[24:27], s58 offen offset:3072 lds
  v_mfma_f32_16x16x32_bf16 v[140:143], a[144:147], a[156:159], v[140:143]
  v_mfma_f32_16x16x32_bf16 v[124:127], a[144:147], a[152:155], v[124:127]
  v_mfma_f32_16x16x32_bf16 v[108:111], a[144:147], a[148:151], v[108:111]
  s_add_u32 m0, s79, 114688
  s_nop 0
  buffer_load_dwordx4 v18, s[28:31], s59 offen offset:0 lds
  s_waitcnt lgkmcnt(0)
  s_waitcnt vmcnt(10)
  s_barrier
  v_mfma_f32_16x16x32_bf16 v[96:99], a[164:167], a[180:183], v[96:99]
  ds_read_b128 a[132:135], v196 offset:0
  ds_read_b64_tr_b16 a[148:149], v204 offset:16384
  v_mfma_f32_16x16x32_bf16 v[112:115], a[164:167], a[184:187], v[112:115]
  buffer_load_dwordx4 v19, s[28:31], s59 offen offset:1024 lds
  v_mfma_f32_16x16x32_bf16 v[128:131], a[164:167], a[188:191], v[128:131]
  ds_read_b64_tr_b16 a[150:151], v204 offset:17408
  ds_read_b128 a[136:139], v196 offset:2048
  v_mfma_f32_16x16x32_bf16 v[144:147], a[164:167], a[192:195], v[144:147]
  ds_read_b64_tr_b16 a[152:153], v205 offset:16384
  v_mfma_f32_16x16x32_bf16 v[148:151], a[168:171], a[192:195], v[148:151]
  ds_read_b64_tr_b16 a[154:155], v205 offset:17408
  ds_read_b128 a[140:143], v198 offset:0
  v_mfma_f32_16x16x32_bf16 v[132:135], a[168:171], a[188:191], v[132:135]
  buffer_load_dwordx4 v20, s[28:31], s59 offen offset:2048 lds
  v_mfma_f32_16x16x32_bf16 v[116:119], a[168:171], a[184:187], v[116:119]
  ds_read_b64_tr_b16 a[156:157], v206 offset:16384
L_tc0_6:
  s_cbranch_execz L_tr0
  ds_read_b64_tr_b16 a[158:159], v206 offset:17408
  v_mfma_f32_16x16x32_bf16 v[100:103], a[168:171], a[180:183], v[100:103]
  ds_read_b128 a[144:147], v198 offset:2048
  v_mfma_f32_16x16x32_bf16 v[104:107], a[172:175], a[180:183], v[104:107]
  ds_read_b64_tr_b16 a[160:161], v207 offset:16384
  v_mfma_f32_16x16x32_bf16 v[120:123], a[172:175], a[184:187], v[120:123]
  buffer_load_dwordx4 v21, s[28:31], s59 offen offset:3072 lds
  v_mfma_f32_16x16x32_bf16 v[136:139], a[172:175], a[188:191], v[136:139]
  ds_read_b64_tr_b16 a[162:163], v207 offset:17408
  v_mfma_f32_16x16x32_bf16 v[152:155], a[172:175], a[192:195], v[152:155]
  v_mfma_f32_16x16x32_bf16 v[156:159], a[176:179], a[192:195], v[156:159]
  s_add_u32 m0, s79, 0
  s_nop 0
  buffer_load_dwordx4 v14, s[24:27], s52 offen offset:0 lds
  v_mfma_f32_16x16x32_bf16 v[140:143], a[176:179], a[188:191], v[140:143]
  v_mfma_f32_16x16x32_bf16 v[124:127], a[176:179], a[184:187], v[124:127]
  v_mfma_f32_16x16x32_bf16 v[108:111], a[176:179], a[180:183], v[108:111]
  buffer_load_dwordx4 v15, s[24:27], s52 offen offset:1024 lds
  s_waitcnt lgkmcnt(0)
  v_mfma_f32_16x16x32_bf16 v[96:99], a[132:135], a[148:151], v[96:99]
  ds_read_b128 a[164:167], v197 offset:0
  ds_read_b64_tr_b16 a[180:181], v204 offset:24576
  s_waitcnt vmcnt(10)
  v_cmp_eq_u64 s[4:5], s[10:11], v[178:179]
  v_mfma_f32_16x16x32_bf16 v[112:115], a[132:135], a[152:155], v[112:115]
  buffer_load_dwordx4 v16, s[24:27], s52 offen offset:2048 lds
  s_xor_b32 s54, s77, s47
  v_cmp_eq_u64 s[12:13], s[10:11], v[162:163]
  v_mfma_f32_16x16x32_bf16 v[128:131], a[132:135], a[156:159], v[128:131]
  ds_read_b64_tr_b16 a[182:183], v204 offset:25600
  ds_read_b128 a[168:171], v197 offset:2048
  v_cmp_eq_u64 s[14:15], s[10:11], v[166:167]
  v_mfma_f32_16x16x32_bf16 v[144:147], a[132:135], a[160:163], v[144:147]
  ds_read_b64_tr_b16 a[184:185], v205 offset:24576
  s_mul_i32 s55, s54, 245760
  v_cmp_eq_u64 s[16:17], s[10:11], v[170:171]
  v_mfma_f32_16x16x32_bf16 v[148:151], a[136:139], a[160:163], v[148:151]
  ds_read_b64_tr_b16 a[186:187], v205 offset:25600
  ds_read_b128 a[172:175], v199 offset:0
  v_cmp_eq_u64 s[18:19], s[10:11], v[174:175]
  v_mfma_f32_16x16x32_bf16 v[132:135], a[136:139], a[156:159], v[132:135]
  buffer_load_dwordx4 v17, s[24:27], s52 offen offset:3072 lds
  s_lshl_b32 s54, s54, 7
  s_and_b64 s[4:5], s[4:5], s[12:13]
  v_mfma_f32_16x16x32_bf16 v[116:119], a[136:139], a[152:155], v[116:119]
  ds_read_b64_tr_b16 a[188:189], v206 offset:24576
  ds_read_b64_tr_b16 a[190:191], v206 offset:25600
  s_and_b64 s[4:5], s[4:5], s[14:15]
  v_mfma_f32_16x16x32_bf16 v[100:103], a[136:139], a[148:151], v[100:103]
  ds_read_b128 a[176:179], v199 offset:2048
  s_and_b64 s[4:5], s[4:5], s[16:17]
  s_and_b64 s[4:5], s[4:5], s[18:19]
  v_mfma_f32_16x16x32_bf16 v[104:107], a[140:143], a[148:151], v[104:107]
  ds_read_b64_tr_b16 a[192:193], v207 offset:24576
  s_cmp_eq_u64 s[4:5], -1
  s_cbranch_scc0 L_retry_24
L_back_25:
  v_mfma_f32_16x16x32_bf16 v[120:123], a[140:143], a[152:155], v[120:123]
  s_add_u32 m0, s79, 16384
  s_nop 0
  buffer_load_dwordx4 v18, s[28:31], s53 offen offset:0 lds
  v_add_f32 v160, v160, v164
  v_mfma_f32_16x16x32_bf16 v[136:139], a[140:143], a[156:159], v[136:139]
  ds_read_b64_tr_b16 a[194:195], v207 offset:25600
  v_add_f32 v161, v161, v165
  v_add_f32 v160, v160, v168
  v_mfma_f32_16x16x32_bf16 v[152:155], a[140:143], a[160:163], v[152:155]
  v_add_f32 v161, v161, v169
  v_add_f32 v160, v160, v172
  v_add_f32 v161, v161, v173
  v_mfma_f32_16x16x32_bf16 v[156:159], a[144:147], a[160:163], v[156:159]
  buffer_load_dwordx4 v19, s[28:31], s53 offen offset:1024 lds
  v_add_f32 v160, v160, v176
  v_add_f32 v161, v161, v177
  v_mfma_f32_16x16x32_bf16 v[140:143], a[144:147], a[156:159], v[140:143]
  s_mov_b32 s72, 986500301
  s_cmp_lt_u32 s23, 5
  s_cselect_b32 s73, 1051011932, 1065353216
  v_mfma_f32_16x16x32_bf16 v[124:127], a[144:147], a[152:155], v[124:127]
  v_mul_f32 v54, 3133983949, v160
  v_mul_f32 v55, v54, v54
  v_fma_f32 v52, v161, s72, -v55
  v_mfma_f32_16x16x32_bf16 v[108:111], a[144:147], a[148:151], v[108:111]
  buffer_load_dwordx4 v20, s[28:31], s53 offen offset:2048 lds
  v_max_f32 v52, 0, v52
  s_waitcnt lgkmcnt(0)
  s_waitcnt vmcnt(7)
  s_barrier
  v_mfma_f32_16x16x32_bf16 v[96:99], a[164:167], a[180:183], v[96:99]
  ds_read_b128 a[132:135], v196 offset:32768
  ds_read_b64_tr_b16 a[148:149], v204 offset:49152
  v_add_f32 v52, 925353388, v52
  v_mfma_f32_16x16x32_bf16 v[112:115], a[164:167], a[184:187], v[112:115]
  buffer_load_dwordx2 v[58:59], v57, s[36:39], 0 offen offset:512 sc1
  v_rsq_f32 v52, v52
  v_mfma_f32_16x16x32_bf16 v[128:131], a[164:167], a[188:191], v[128:131]
  ds_read_b64_tr_b16 a[150:151], v204 offset:50176
  ds_read_b128 a[136:139], v196 offset:34816
  v_cndmask_b32 v54, v160, v54, s[8:9]
  v_mfma_f32_16x16x32_bf16 v[144:147], a[164:167], a[192:195], v[144:147]
  ds_read_b64_tr_b16 a[152:153], v205 offset:49152
  v_mul_f32 v52, s73, v52
  v_cvt_pk_bf16_f32 v164, v54, v54
  v_mfma_f32_16x16x32_bf16 v[148:151], a[168:171], a[192:195], v[148:151]
  ds_read_b64_tr_b16 a[154:155], v205 offset:50176
  ds_read_b128 a[140:143], v198 offset:32768
  v_mov_b32 v53, v52
  v_mfma_f32_16x16x32_bf16 v[132:135], a[168:171], a[188:191], v[132:135]
  buffer_load_dwordx4 v21, s[28:31], s53 offen offset:3072 lds
  v_and_b32 v55, s78, v164
  v_sub_f32 v55, v54, v55
  v_mfma_f32_16x16x32_bf16 v[116:119], a[168:171], a[184:187], v[116:119]
  ds_read_b64_tr_b16 a[156:157], v206 offset:49152
  ds_read_b64_tr_b16 a[158:159], v206 offset:50176
  v_mfma_f32_16x16x32_bf16 v[100:103], a[168:171], a[180:183], v[100:103]
  ds_read_b128 a[144:147], v198 offset:34816
  v_permlane32_swap_b32 v52, v53
  v_mfma_f32_16x16x32_bf16 v[104:107], a[172:175], a[180:183], v[104:107]
  ds_read_b64_tr_b16 a[160:161], v207 offset:49152
  v_cvt_pk_bf16_f32 v168, v54, v55
  v_cndmask_b32 v54, v54, v55, s[8:9]
  v_mfma_f32_16x16x32_bf16 v[120:123], a[172:175], a[184:187], v[120:123]
  s_add_u32 m0, s79, 32768
  s_nop 0
  buffer_load_dwordx4 v14, s[24:27], s54 offen offset:0 lds
  v_cndmask_b32 v164, v168, v164, s[8:9]
  v_mfma_f32_16x16x32_bf16 v[136:139], a[172:175], a[188:191], v[136:139]
  ds_read_b64_tr_b16 a[162:163], v207 offset:50176
  v_cvt_pk_bf16_f32 v165, v54, 0
  v_mfma_f32_16x16x32_bf16 v[152:155], a[172:175], a[192:195], v[152:155]
  v_mfma_f32_16x16x32_bf16 v[156:159], a[176:179], a[192:195], v[156:159]
  buffer_load_dwordx4 v15, s[24:27], s54 offen offset:1024 lds
  v_mfma_f32_16x16x32_bf16 v[140:143], a[176:179], a[188:191], v[140:143]
  v_mfma_f32_16x16x32_bf16 v[124:127], a[176:179], a[184:187], v[124:127]
  v_mfma_f32_16x16x32_bf16 v[108:111], a[176:179], a[180:183], v[108:111]
  buffer_load_dwordx4 v16, s[24:27], s54 offen offset:2048 lds
  s_waitcnt lgkmcnt(0)
  v_mfma_f32_16x16x32_bf16 v[96:99], a[132:135], a[148:151], v[96:99]
  ds_write_b32 v31, v52
  ds_write_b64 v30, v[164:165]
  ds_read_b128 a[164:167], v197 offset:32768
  ds_read_b64_tr_b16 a[180:181], v204 offset:57344
  v_mfma_f32_16x16x32_bf16 v[112:115], a[132:135], a[152:155], v[112:115]
  buffer_load_dwordx4 v17, s[24:27], s54 offen offset:3072 lds
  v_mfma_f32_16x16x32_bf16 v[128:131], a[132:135], a[156:159], v[128:131]
  ds_read_b64_tr_b16 a[182:183], v204 offset:58368
  ds_read_b128 a[168:171], v197 offset:34816
  v_mfma_f32_16x16x32_bf16 v[144:147], a[132:135], a[160:163], v[144:147]
  ds_read_b64_tr_b16 a[184:185], v205 offset:57344
  v_mfma_f32_16x16x32_bf16 v[148:151], a[136:139], a[160:163], v[148:151]
  ds_read_b64_tr_b16 a[186:187], v205 offset:58368
  ds_read_b128 a[172:175], v199 offset:32768
  v_mfma_f32_16x16x32_bf16 v[132:135], a[136:139], a[156:159], v[132:135]
  s_add_u32 m0, s79, 49152
  s_nop 0
  buffer_load_dwordx4 v18, s[28:31], s55 offen offset:0 lds
  v_mfma_f32_16x16x32_bf16 v[116:119], a[136:139], a[152:155], v[116:119]
  ds_read_b64_tr_b16 a[188:189], v206 offset:57344
  ds_read_b64_tr_b16 a[190:191], v206 offset:58368
  v_mfma_f32_16x16x32_bf16 v[100:103], a[136:139], a[148:151], v[100:103]
  ds_read_b128 a[176:179], v199 offset:34816
  v_mfma_f32_16x16x32_bf16 v[104:107], a[140:143], a[148:151], v[104:107]
  ds_read_b64_tr_b16 a[192:193], v207 offset:57344
  v_mfma_f32_16x16x32_bf16 v[120:123], a[140:143], a[152:155], v[120:123]
  buffer_load_dwordx4 v19, s[28:31], s55 offen offset:1024 lds
  v_mfma_f32_16x16x32_bf16 v[136:139], a[140:143], a[156:159], v[136:139]
  ds_read_b64_tr_b16 a[194:195], v207 offset:58368
  v_mfma_f32_16x16x32_bf16 v[152:155], a[140:143], a[160:163], v[152:155]
  v_mfma_f32_16x16x32_bf16 v[156:159], a[144:147], a[160:163], v[156:159]
  buffer_load_dwordx4 v20, s[28:31], s55 offen offset:2048 lds
  v_mfma_f32_16x16x32_bf16 v[140:143], a[144:147], a[156:159], v[140:143]
  v_mfma_f32_16x16x32_bf16 v[124:127], a[144:147], a[152:155], v[124:127]
  v_mfma_f32_16x16x32_bf16 v[108:111], a[144:147], a[148:151], v[108:111]
  buffer_load_dwordx4 v21, s[28:31], s55 offen offset:3072 lds
  s_waitcnt lgkmcnt(0)
  s_waitcnt vmcnt(8)
  s_barrier
  v_cmp_eq_u64 vcc, s[10:11], v[58:59]
  s_nop 1
  s_cmp_eq_u64 vcc, -1
  s_cbranch_scc0 L_ckr_26
L_ckb_27:
  v_mfma_f32_16x16x32_bf16 v[96:99], a[164:167], a[180:183], v[96:99]
  ds_read_b128 a[132:135], v192 offset:0
  ds_read_b64_tr_b16 a[148:149], v200 offset:16384
  v_mfma_f32_16x16x32_bf16 v[112:115], a[164:167], a[184:187], v[112:115]
  s_mul_i32 s19, s50, 5120
  s_add_u32 m0, s19, 65536
  s_add_u32 s68, s63, s50
  s_mul_i32 s68, s68, 21504
  s_add_u32 s68, s68, 23216128
  buffer_load_dwordx4 v2, s[36:39], s68 offen offset:0 sc1 lds
  v_mfma_f32_16x16x32_bf16 v[128:131], a[164:167], a[188:191], v[128:131]
  ds_read_b64_tr_b16 a[150:151], v200 offset:17408
  ds_read_b128 a[136:139], v192 offset:2048
  v_mfma_f32_16x16x32_bf16 v[144:147], a[164:167], a[192:195], v[144:147]
  ds_read_b64_tr_b16 a[152:153], v201 offset:16384
  ds_read_b64 v[40:41], v34 offset:0
  v_mfma_f32_16x16x32_bf16 v[148:151], a[168:171], a[192:195], v[148:151]
  ds_read_b64_tr_b16 a[154:155], v201 offset:17408
  ds_read_b128 a[140:143], v194 offset:0
  v_mfma_f32_16x16x32_bf16 v[132:135], a[168:171], a[188:191], v[132:135]
  buffer_load_dwordx4 v2, s[36:39], s68 offen offset:1024 sc1 lds
  ds_read_b64 v[222:223], v36 offset:0
  v_mfma_f32_16x16x32_bf16 v[116:119], a[168:171], a[184:187], v[116:119]
  ds_read_b64_tr_b16 a[156:157], v202 offset:16384
  ds_read_b64_tr_b16 a[158:159], v202 offset:17408
  v_mfma_f32_16x16x32_bf16 v[100:103], a[168:171], a[180:183], v[100:103]
  ds_read_b128 a[144:147], v194 offset:2048
  ds_read_b64 v[42:43], v34 offset:128
  v_mfma_f32_16x16x32_bf16 v[104:107], a[172:175], a[180:183], v[104:107]
  ds_read_b64_tr_b16 a[160:161], v203 offset:16384
  ds_read_b64 v[224:225], v36 offset:128
  v_mfma_f32_16x16x32_bf16 v[120:123], a[172:175], a[184:187], v[120:123]
  buffer_load_dwordx4 v2, s[36:39], s68 offen offset:2048 sc1 lds
  ds_read_b64 v[44:45], v35 offset:0
  v_mfma_f32_16x16x32_bf16 v[136:139], a[172:175], a[188:191], v[136:139]
  ds_read_b64_tr_b16 a[162:163], v203 offset:17408
  ds_read_b64 v[226:227], v37 offset:0
  v_mfma_f32_16x16x32_bf16 v[152:155], a[172:175], a[192:195], v[152:155]
  ds_read_b64 v[46:47], v35 offset:128
  ds_read_b64 v[228:229], v37 offset:128
  v_mfma_f32_16x16x32_bf16 v[156:159], a[176:179], a[192:195], v[156:159]
  ds_read_b128 v[160:163], v60 offset:0
  ds_read_b128 v[164:167], v60 offset:64
  v_mfma_f32_16x16x32_bf16 v[140:143], a[176:179], a[188:191], v[140:143]
  buffer_load_dwordx4 v2, s[36:39], s68 offen offset:3072 sc1 lds
  ds_read_b128 v[168:171], v61 offset:0
  v_mfma_f32_16x16x32_bf16 v[124:127], a[176:179], a[184:187], v[124:127]
  ds_read_b128 v[172:175], v61 offset:64
  v_mfma_f32_16x16x32_bf16 v[108:111], a[176:179], a[180:183], v[108:111]
  s_sub_u32 s52, s82, 2195456
  s_cselect_b32 s52, 2147483648, s52
  s_waitcnt lgkmcnt(0)
  v_mfma_f32_16x16x32_bf16 v[96:99], a[132:135], a[148:151], v[96:99]
  ds_read_b128 a[164:167], v193 offset:0
  ds_read_b64_tr_b16 a[180:181], v200 offset:24576
  v_mfma_f32_16x16x32_bf16 v[112:115], a[132:135], a[152:155], v[112:115]
  s_add_u32 m0, m0, 4096
  s_add_u32 s68, s68, 4096
  buffer_load_dwordx4 v2, s[36:39], s68 offen offset:0 sc1 lds
  v_mfma_f32_16x16x32_bf16 v[128:131], a[132:135], a[156:159], v[128:131]
  ds_read_b64_tr_b16 a[182:183], v200 offset:25600
  ds_read_b128 a[168:171], v193 offset:2048
  v_mfma_f32_16x16x32_bf16 v[144:147], a[132:135], a[160:163], v[144:147]
  ds_read_b64_tr_b16 a[184:185], v201 offset:24576
  v_mfma_f32_16x16x32_bf16 v[148:151], a[136:139], a[160:163], v[148:151]
  ds_read_b64_tr_b16 a[186:187], v201 offset:25600
  ds_read_b128 a[172:175], v195 offset:0
  v_mfma_f32_16x16x32_bf16 v[132:135], a[136:139], a[156:159], v[132:135]
  s_min_u32 s68, s50, 2
  s_mul_i32 s19, s68, 5120
  s_add_u32 m0, s19, 86016
  s_add_u32 s68, s68, s69
  s_mul_i32 s68, s68, 21504
  s_add_u32 s68, s68, 23216128
  buffer_load_dwordx4 v2, s[36:39], s68 offen offset:0 sc1 lds
  v_mfma_f32_16x16x32_bf16 v[116:119], a[136:139], a[152:155], v[116:119]
  ds_read_b64_tr_b16 a[188:189], v202 offset:24576
  ds_read_b64_tr_b16 a[190:191], v202 offset:25600
  v_mfma_f32_16x16x32_bf16 v[100:103], a[136:139], a[148:151], v[100:103]
  ds_read_b128 a[176:179], v195 offset:2048
  v_mfma_f32_16x16x32_bf16 v[104:107], a[140:143], a[148:151], v[104:107]
  ds_read_b64_tr_b16 a[192:193], v203 offset:24576
  v_mfma_f32_16x16x32_bf16 v[120:123], a[140:143], a[152:155], v[120:123]
  buffer_load_dwordx4 v2, s[36:39], s68 offen offset:1024 sc1 lds
  v_mfma_f32_16x16x32_bf16 v[136:139], a[140:143], a[156:159], v[136:139]
  ds_read_b64_tr_b16 a[194:195], v203 offset:25600
  v_mfma_f32_16x16x32_bf16 v[152:155], a[140:143], a[160:163], v[152:155]
  s_sub_u32 s53, s82, 1921024
  s_cselect_b32 s53, 2147483648, s53
  v_mfma_f32_16x16x32_bf16 v[156:159], a[144:147], a[160:163], v[156:159]
  s_sub_u32 s54, s82, 1646592
  s_cselect_b32 s54, 2147483648, s54
  v_mfma_f32_16x16x32_bf16 v[140:143], a[144:147], a[156:159], v[140:143]
  buffer_load_dwordx4 v2, s[36:39], s68 offen offset:2048 sc1 lds
  v_mfma_f32_16x16x32_bf16 v[124:127], a[144:147], a[152:155], v[124:127]
  s_sub_u32 s55, s82, 1372160
  s_cselect_b32 s55, 2147483648, s55
  v_mfma_f32_16x16x32_bf16 v[108:111], a[144:147], a[148:151], v[108:111]
  s_sub_u32 s56, s82, 1097728
  s_cselect_b32 s56, 2147483648, s56
  v_mfma_f32_16x16x16_bf16 v[96:99], v[40:41], v[222:223], v[96:99]
  s_sub_u32 s57, s82, 823296
  s_cselect_b32 s57, 2147483648, s57
  v_mfma_f32_16x16x16_bf16 v[100:103], v[42:43], v[222:223], v[100:103]
  s_sub_u32 s58, s82, 548864
  s_cselect_b32 s58, 2147483648, s58
  v_mfma_f32_16x16x16_bf16 v[104:107], v[44:45], v[222:223], v[104:107]
  s_sub_u32 s59, s82, 274432
  s_cselect_b32 s59, 2147483648, s59
  v_mfma_f32_16x16x16_bf16 v[108:111], v[46:47], v[222:223], v[108:111]
  s_add_u32 s60, s82, 0
  s_add_u32 s61, s82, 274432
  v_mfma_f32_16x16x16_bf16 v[112:115], v[40:41], v[224:225], v[112:115]
  v_mfma_f32_16x16x16_bf16 v[116:119], v[42:43], v[224:225], v[116:119]
  v_mfma_f32_16x16x16_bf16 v[120:123], v[44:45], v[224:225], v[120:123]
  v_mfma_f32_16x16x16_bf16 v[124:127], v[46:47], v[224:225], v[124:127]
  v_mfma_f32_16x16x16_bf16 v[128:131], v[40:41], v[226:227], v[128:131]
  v_mfma_f32_16x16x16_bf16 v[132:135], v[42:43], v[226:227], v[132:135]
  v_mfma_f32_16x16x16_bf16 v[136:139], v[44:45], v[226:227], v[136:139]
  v_mfma_f32_16x16x16_bf16 v[140:143], v[46:47], v[226:227], v[140:143]
  v_mfma_f32_16x16x16_bf16 v[144:147], v[40:41], v[228:229], v[144:147]
  v_mfma_f32_16x16x16_bf16 v[148:151], v[42:43], v[228:229], v[148:151]
  v_mfma_f32_16x16x16_bf16 v[152:155], v[44:45], v[228:229], v[152:155]
  v_mfma_f32_16x16x16_bf16 v[156:159], v[46:47], v[228:229], v[156:159]
  s_waitcnt lgkmcnt(0)
  s_waitcnt vmcnt(8)
  s_barrier
  v_mfma_f32_16x16x32_bf16 v[96:99], a[164:167], a[180:183], v[96:99]
  ds_read_b128 a[132:135], v192 offset:32768
  ds_read_b64_tr_b16 a[148:149], v200 offset:49152
  v_mfma_f32_16x16x32_bf16 v[112:115], a[164:167], a[184:187], v[112:115]
  ds_read_b64_tr_b16 a[150:151], v200 offset:50176
  ds_read_b64_tr_b16 a[152:153], v201 offset:49152
  v_mfma_f32_16x16x32_bf16 v[100:103], a[168:171], a[180:183], v[100:103]
  ds_read_b64_tr_b16 a[154:155], v201 offset:50176
  ds_read_b128 a[196:199], v193 offset:32768
  v_mfma_f32_16x16x32_bf16 v[116:119], a[168:171], a[184:187], v[116:119]
  ds_read_b64_tr_b16 a[212:213], v200 offset:57344
  ds_read_b64_tr_b16 a[214:215], v200 offset:58368
  s_waitcnt lgkmcnt(5)
  v_mfma_f32_16x16x32_bf16 v[96:99], a[132:135], a[148:151], v[96:99]
  ds_read_b64_tr_b16 a[216:217], v201 offset:57344
  ds_read_b64_tr_b16 a[218:219], v201 offset:58368
  s_waitcnt lgkmcnt(5)
  v_mfma_f32_16x16x32_bf16 v[112:115], a[132:135], a[152:155], v[112:115]
  ds_read_b128 a[136:139], v192 offset:34816
  ds_read_b128 a[200:203], v193 offset:34816
  s_waitcnt lgkmcnt(4)
  v_mfma_f32_16x16x32_bf16 v[96:99], a[196:199], a[212:215], v[96:99]
  buffer_load_dwordx2 v[58:59], v57, s[36:39], 0 offen offset:0 sc1
  ds_read_b128 a[140:143], v194 offset:32768
  s_waitcnt lgkmcnt(3)
  v_mfma_f32_16x16x32_bf16 v[112:115], a[196:199], a[216:219], v[112:115]
  ds_read_b128 a[204:207], v195 offset:32768
  ds_read_b128 a[144:147], v194 offset:34816
  v_mfma_f32_16x16x32_bf16 v[104:107], a[172:175], a[180:183], v[104:107]
  ds_read_b128 a[208:211], v195 offset:34816
  ds_read_b64_tr_b16 a[156:157], v202 offset:49152
  v_mfma_f32_16x16x32_bf16 v[120:123], a[172:175], a[184:187], v[120:123]
  ds_read_b64_tr_b16 a[158:159], v202 offset:50176
  v_mul_f32 v96, v96, v160
  v_mul_f32 v97, v97, v161
  v_mul_f32 v98, v98, v162
  v_mul_f32 v99, v99, v163
  s_waitcnt lgkmcnt(7)
  v_mfma_f32_16x16x32_bf16 v[100:103], a[136:139], a[148:151], v[100:103]
  ds_read_b64_tr_b16 a[220:221], v202 offset:57344
  v_mul_f32 v112, v112, v160
  v_mul_f32 v113, v113, v161
  v_mul_f32 v114, v114, v162
  v_mul_f32 v115, v115, v163
  v_mfma_f32_16x16x32_bf16 v[116:119], a[136:139], a[152:155], v[116:119]
  ds_read_b64_tr_b16 a[222:223], v202 offset:58368
  v_cvt_pk_bf16_f32 v64, v96, v97
  v_cvt_pk_bf16_f32 v65, v98, v99
  v_cvt_pk_bf16_f32 v66, v112, v113
  v_cvt_pk_bf16_f32 v67, v114, v115
  s_waitcnt lgkmcnt(8)
  v_mfma_f32_16x16x32_bf16 v[100:103], a[200:203], a[212:215], v[100:103]
  ds_read_b64_tr_b16 a[160:161], v203 offset:49152
  v_permlane16_swap_b32 v64, v66
  v_permlane16_swap_b32 v65, v67
  v_mfma_f32_16x16x32_bf16 v[116:119], a[200:203], a[216:219], v[116:119]
  ds_read_b64_tr_b16 a[162:163], v203 offset:50176
  buffer_store_dwordx4 v[64:67], v38, s[36:39], s0 offen offset:0 sc1
  v_mfma_f32_16x16x32_bf16 v[108:111], a[176:179], a[180:183], v[108:111]
  ds_read_b64_tr_b16 a[224:225], v203 offset:57344
  ds_read_b64_tr_b16 a[226:227], v203 offset:58368
  v_mfma_f32_16x16x32_bf16 v[124:127], a[176:179], a[184:187], v[124:127]
  v_mul_f32 v100, v100, v164
  v_mul_f32 v101, v101, v165
  v_mul_f32 v102, v102, v166
  v_mul_f32 v103, v103, v167
  v_mul_f32 v116, v116, v164
  s_waitcnt lgkmcnt(11)
  v_mfma_f32_16x16x32_bf16 v[104:107], a[140:143], a[148:151], v[104:107]
  v_mul_f32 v117, v117, v165
  v_mul_f32 v118, v118, v166
  v_mul_f32 v119, v119, v167
  v_cvt_pk_bf16_f32 v68, v100, v101
  v_cvt_pk_bf16_f32 v69, v102, v103
  v_mfma_f32_16x16x32_bf16 v[120:123], a[140:143], a[152:155], v[120:123]
  v_cvt_pk_bf16_f32 v70, v116, v117
  v_cvt_pk_bf16_f32 v71, v118, v119
  s_waitcnt lgkmcnt(10)
  v_mfma_f32_16x16x32_bf16 v[104:107], a[204:207], a[212:215], v[104:107]
  v_permlane16_swap_b32 v68, v70
  v_permlane16_swap_b32 v69, v71
  v_mfma_f32_16x16x32_bf16 v[120:123], a[204:207], a[216:219], v[120:123]
  buffer_store_dwordx4 v[68:71], v38, s[36:39], s0 offen offset:640 sc1
  v_mfma_f32_16x16x32_bf16 v[128:131], a[164:167], a[188:191], v[128:131]
  v_mfma_f32_16x16x32_bf16 v[144:147], a[164:167], a[192:195], v[144:147]
  s_nop 1
  v_mul_f32 v104, v104, v168
  v_mul_f32 v105, v105, v169
  v_mul_f32 v106, v106, v170
  v_mul_f32 v107, v107, v171
  v_mul_f32 v120, v120, v168
  s_waitcnt lgkmcnt(9)
  v_mfma_f32_16x16x32_bf16 v[108:111], a[144:147], a[148:151], v[108:111]
  v_mul_f32 v121, v121, v169
  v_mul_f32 v122, v122, v170
  v_mul_f32 v123, v123, v171
  v_cvt_pk_bf16_f32 v72, v104, v105
  v_cvt_pk_bf16_f32 v73, v106, v107
  v_mfma_f32_16x16x32_bf16 v[124:127], a[144:147], a[152:155], v[124:127]
  v_cvt_pk_bf16_f32 v74, v120, v121
  v_cvt_pk_bf16_f32 v75, v122, v123
  s_waitcnt lgkmcnt(8)
  v_mfma_f32_16x16x32_bf16 v[108:111], a[208:211], a[212:215], v[108:111]
  v_permlane16_swap_b32 v72, v74
  v_permlane16_swap_b32 v73, v75
  v_mfma_f32_16x16x32_bf16 v[124:127], a[208:211], a[216:219], v[124:127]
  buffer_store_dwordx4 v[72:75], v38, s[36:39], s1 offen offset:0 sc1
  v_mfma_f32_16x16x32_bf16 v[132:135], a[168:171], a[188:191], v[132:135]
  v_mfma_f32_16x16x32_bf16 v[148:151], a[168:171], a[192:195], v[148:151]
  s_nop 1
  v_mul_f32 v108, v108, v172
  v_mul_f32 v109, v109, v173
  v_mul_f32 v110, v110, v174
  v_mul_f32 v111, v111, v175
  v_mul_f32 v124, v124, v172
  s_waitcnt lgkmcnt(6)
  v_mfma_f32_16x16x32_bf16 v[128:131], a[132:135], a[156:159], v[128:131]
  v_mul_f32 v125, v125, v173
  v_mul_f32 v126, v126, v174
  v_mul_f32 v127, v127, v175
  v_cvt_pk_bf16_f32 v76, v108, v109
  v_cvt_pk_bf16_f32 v77, v110, v111
  s_waitcnt lgkmcnt(2)
  v_mfma_f32_16x16x32_bf16 v[144:147], a[132:135], a[160:163], v[144:147]
  v_cvt_pk_bf16_f32 v78, v124, v125
  v_cvt_pk_bf16_f32 v79, v126, v127
  v_mfma_f32_16x16x32_bf16 v[128:131], a[196:199], a[220:223], v[128:131]
  v_permlane16_swap_b32 v76, v78
  v_permlane16_swap_b32 v77, v79
  s_waitcnt lgkmcnt(0)
  v_mfma_f32_16x16x32_bf16 v[144:147], a[196:199], a[224:227], v[144:147]
  buffer_store_dwordx4 v[76:79], v38, s[36:39], s1 offen offset:640 sc1
  v_mfma_f32_16x16x32_bf16 v[136:139], a[172:175], a[188:191], v[136:139]
  v_mfma_f32_16x16x32_bf16 v[152:155], a[172:175], a[192:195], v[152:155]
  s_nop 0
  v_mul_f32 v128, v128, v160
  v_mul_f32 v129, v129, v161
  v_mul_f32 v130, v130, v162
  v_mul_f32 v131, v131, v163
  v_mul_f32 v144, v144, v160
  v_mul_f32 v145, v145, v161
  v_mul_f32 v146, v146, v162
  v_mfma_f32_16x16x32_bf16 v[132:135], a[136:139], a[156:159], v[132:135]
  v_mul_f32 v147, v147, v163
  v_cvt_pk_bf16_f32 v80, v128, v129
  v_cvt_pk_bf16_f32 v81, v130, v131
  v_cvt_pk_bf16_f32 v82, v144, v145
  v_cvt_pk_bf16_f32 v83, v146, v147
  v_mfma_f32_16x16x32_bf16 v[148:151], a[136:139], a[160:163], v[148:151]
  v_permlane16_swap_b32 v80, v82
  v_permlane16_swap_b32 v81, v83
  v_mfma_f32_16x16x32_bf16 v[132:135], a[200:203], a[220:223], v[132:135]
  buffer_store_dwordx4 v[80:83], v39, s[36:39], s0 offen offset:0 sc1
  v_mfma_f32_16x16x32_bf16 v[148:151], a[200:203], a[224:227], v[148:151]
  v_mfma_f32_16x16x32_bf16 v[140:143], a[176:179], a[188:191], v[140:143]
  v_mfma_f32_16x16x32_bf16 v[156:159], a[176:179], a[192:195], v[156:159]
  s_nop 3
  v_mul_f32 v132, v132, v164
  v_mul_f32 v133, v133, v165
  v_mul_f32 v134, v134, v166
  v_mul_f32 v135, v135, v167
  v_mul_f32 v148, v148, v164
  v_mul_f32 v149, v149, v165
  v_mul_f32 v150, v150, v166
  v_mfma_f32_16x16x32_bf16 v[136:139], a[140:143], a[156:159], v[136:139]
  v_mul_f32 v151, v151, v167
  v_cvt_pk_bf16_f32 v84, v132, v133
  v_cvt_pk_bf16_f32 v85, v134, v135
  v_cvt_pk_bf16_f32 v86, v148, v149
  v_cvt_pk_bf16_f32 v87, v150, v151
  v_mfma_f32_16x16x32_bf16 v[152:155], a[140:143], a[160:163], v[152:155]
  v_permlane16_swap_b32 v84, v86
  v_permlane16_swap_b32 v85, v87
  buffer_store_dwordx4 v[84:87], v39, s[36:39], s0 offen offset:640 sc1
  v_mfma_f32_16x16x32_bf16 v[136:139], a[204:207], a[220:223], v[136:139]
  v_mfma_f32_16x16x32_bf16 v[152:155], a[204:207], a[224:227], v[152:155]
  v_mfma_f32_16x16x32_bf16 v[140:143], a[144:147], a[156:159], v[140:143]
  v_mfma_f32_16x16x32_bf16 v[156:159], a[144:147], a[160:163], v[156:159]
  s_nop 4
  v_mul_f32 v136, v136, v168
  v_mul_f32 v137, v137, v169
  v_mul_f32 v138, v138, v170
  v_mul_f32 v139, v139, v171
  v_mul_f32 v152, v152, v168
  v_mul_f32 v153, v153, v169
  v_mul_f32 v154, v154, v170
  v_mfma_f32_16x16x32_bf16 v[140:143], a[208:211], a[220:223], v[140:143]
  v_mul_f32 v155, v155, v171
  v_cvt_pk_bf16_f32 v88, v136, v137
  v_cvt_pk_bf16_f32 v89, v138, v139
  v_cvt_pk_bf16_f32 v90, v152, v153
  v_cvt_pk_bf16_f32 v91, v154, v155
  v_mfma_f32_16x16x32_bf16 v[156:159], a[208:211], a[224:227], v[156:159]
  v_permlane16_swap_b32 v88, v90
  v_permlane16_swap_b32 v89, v91
  buffer_store_dwordx4 v[88:91], v39, s[36:39], s1 offen offset:0 sc1
  v_mul_f32 v140, v140, v172
  v_mul_f32 v141, v141, v173
  v_mul_f32 v142, v142, v174
  v_mul_f32 v143, v143, v175
  s_nop 0
  v_mul_f32 v156, v156, v172
  v_mul_f32 v157, v157, v173
  v_mul_f32 v158, v158, v174
  v_mul_f32 v159, v159, v175
  v_cvt_pk_bf16_f32 v92, v140, v141
  v_cvt_pk_bf16_f32 v93, v142, v143
  v_cvt_pk_bf16_f32 v94, v156, v157
  v_cvt_pk_bf16_f32 v95, v158, v159
  s_nop 0
  v_permlane16_swap_b32 v92, v94
  v_permlane16_swap_b32 v93, v95
  buffer_store_dwordx4 v[92:95], v39, s[36:39], s1 offen offset:640 sc1
L_p1j:
L_tc0_2:
  s_cbranch_execz L_tr0
  s_cmp_ge_u32 s23, 10
  s_cbranch_scc1 L_t1_28
  ds_read_b64_tr_b16 v[160:161], v220 offset:0
  ds_read_b64_tr_b16 v[162:163], v220 offset:2560
  ds_read_b64_tr_b16 v[164:165], v220 offset:8
  ds_read_b64_tr_b16 v[166:167], v220 offset:2568
  ds_read_b64_tr_b16 v[168:169], v220 offset:64
  ds_read_b64_tr_b16 v[170:171], v220 offset:2624
  ds_read_b64_tr_b16 v[172:173], v220 offset:72
  ds_read_b64_tr_b16 v[174:175], v220 offset:2632
  ds_read_b64_tr_b16 v[176:177], v221 offset:128
  ds_read_b64_tr_b16 v[178:179], v221 offset:2688
  s_branch L_t2_29
L_t1_28:
  ds_read_b64_tr_b16 v[160:161], v220 offset:0
  ds_read_b64_tr_b16 v[162:163], v220 offset:512
  ds_read_b64_tr_b16 v[164:165], v220 offset:4096
  ds_read_b64_tr_b16 v[166:167], v220 offset:4608
  ds_read_b64_tr_b16 v[168:169], v220 offset:8192
  ds_read_b64_tr_b16 v[170:171], v220 offset:8704
  ds_read_b64_tr_b16 v[172:173], v220 offset:12288
  ds_read_b64_tr_b16 v[174:175], v220 offset:12800
  ds_read_b64_tr_b16 v[176:177], v220 offset:16384
  ds_read_b64_tr_b16 v[178:179], v220 offset:16896
L_t2_29:
  v_mov_b32 v144, 1065369472
  v_mov_b32 v145, 1065369472
  v_mov_b32 v146, 1065369472
  v_mov_b32 v147, 1065369472
  v_mov_b32 v154, 0
  v_mov_b32 v155, 0
  s_waitcnt vmcnt(8)
  v_cmp_eq_u64 vcc, s[10:11], v[58:59]
  s_nop 1
  s_cmp_eq_u64 vcc, -1
  s_cbranch_scc0 L_ckr_30
L_ckb_31:
  v_add_u32 v217, 16384, v57
  s_waitcnt lgkmcnt(8)
  v_mfma_f32_16x16x32_bf16 v[148:151], v[144:147], v[160:163], 0
  s_waitcnt lgkmcnt(6)
  v_mfma_f32_16x16x32_bf16 v[148:151], v[144:147], v[164:167], v[148:151]
  s_waitcnt lgkmcnt(4)
  v_mfma_f32_16x16x32_bf16 v[148:151], v[144:147], v[168:171], v[148:151]
  s_waitcnt lgkmcnt(2)
  v_mfma_f32_16x16x32_bf16 v[148:151], v[144:147], v[172:175], v[148:151]
  s_waitcnt lgkmcnt(0)
  v_mfma_f32_16x16x32_bf16 v[148:151], v[144:147], v[176:179], v[148:151]
  v_mov_b32 v238, 989740928
  v_cndmask_b32 v238, 0, v238, s[8:9]
  v_mov_b32 v239, 0
  v_mov_b32 v241, 0
  v_mov_b32 v243, 0
  s_cmp_ge_u32 s82, 2195456
  s_cselect_b32 s74, 1065369472, 0
  v_mov_b32 v240, s74
  s_cmp_ge_u32 s82, 1646592
  s_cselect_b32 s74, 1065369472, 0
  v_mov_b32 v242, s74
  v_mfma_f32_32x32x8_bf16 a[50:65], v[238:239], v[240:241], 0
  s_cmp_ge_u32 s82, 1097728
  s_cselect_b32 s74, 1065369472, 0
  v_mov_b32 v240, s74
  v_mfma_f32_32x32x8_bf16 a[66:81], v[238:239], v[242:243], 0
  s_cmp_ge_u32 s82, 548864
  s_cselect_b32 s74, 1065369472, 0
  v_mov_b32 v242, s74
  v_mfma_f32_32x32x8_bf16 a[82:97], v[238:239], v[240:241], 0
  s_cmp_ge_u32 s82, 0
  s_cselect_b32 s74, 1065369472, 0
  v_mov_b32 v240, s74
  v_mfma_f32_32x32x8_bf16 a[98:113], v[238:239], v[242:243], 0
  s_nop 0
  v_mfma_f32_32x32x8_bf16 a[114:129], v[238:239], v[240:241], 0
  v_cvt_pk_bf16_f32 v153, v148, v154
  v_lshlrev_b32 v149, 16, v153
  v_sub_f32 v149, v148, v149
  v_cvt_pk_bf16_f32 v152, v148, v149
  v_mov_b32 v218, v27
  v_mov_b32 v219, v28
  s_waitcnt vmcnt(0)
  s_barrier
  buffer_store_dwordx2 v[254:255], v216, s[36:39], 0 offen sc1
  buffer_store_dwordx4 v[160:163], v2, s[36:39], s81 offen offset:0 sc1
  buffer_store_dwordx4 v[164:167], v2, s[36:39], s81 offen offset:1024 sc1
L_tc0_3:
  s_cbranch_execz L_tr0
  buffer_store_dwordx4 v[168:171], v2, s[36:39], s81 offen offset:2048 sc1
  buffer_store_dwordx4 v[172:175], v2, s[36:39], s81 offen offset:3072 sc1
  buffer_store_dwordx4 v[176:179], v219, s[36:39], s81 offen offset:0 sc1
  buffer_store_dwordx4 v[152:155], v218, s[36:39], s81 offen sc1
  s_cmp_eq_u32 s23, 15
  s_cbranch_scc1 L_hw_32
L_hwb_33:
  buffer_load_dwordx4 v2, s[36:39], s68 offen offset:3072 sc1 lds
  s_lshr_b32 s72, s49, 3
  s_lshl_b32 s72, s72, 1
  s_lshl_b32 s73, s48, 3
  s_add_u32 s72, s72, s73
  s_lshl_b32 s73, s72, 5
  s_lshl_b32 s74, s50, 4
  s_add_u32 s73, s73, s74
  s_mul_i32 s73, s73, 1280
  s_mul_i32 s74, s83, 160
  s_add_u32 s70, s73, s74
  v_and_b32 v238, 15, v1
  v_lshrrev_b32 v239, 4, v1
  v_lshlrev_b32 v239, 2, v239
  v_lshl_add_u32 v214, v238, 4, v239
  v_lshrrev_b32 v238, 2, v1
  v_mul_u32_u24 v238, 1280, v238
  v_and_b32 v239, 3, v1
  v_lshl_add_u32 v182, v239, 4, v238
  v_lshl_add_u32 v3, v239, 3, v238
  s_and_b32 s73, s2, 135
  s_lshl_b32 s73, s73, 7
  s_add_u32 s73, s73, 25690112
  v_and_b32 v238, 15, v1
  v_lshlrev_b32 v238, 10, v238
  v_add_u32 v213, s73, v238
  s_add_u32 m0, m0, 4096
  s_add_u32 s68, s68, 4096
  buffer_load_dwordx4 v2, s[36:39], s68 offen offset:0 sc1 lds
  buffer_load_dwordx4 v[4:7], v182, s[24:27], s70 offen
  buffer_load_dwordx4 v[8:11], v182, s[24:27], s70 offen offset:64
  buffer_load_dwordx2 v[12:13], v3, s[24:27], s70 offen offset:128
  buffer_load_dwordx4 v[244:247], v213, s[36:39], 0 offen sc1
  s_and_b32 s73, s50, 1
  s_mul_i32 s73, s73, 274432
  s_lshr_b32 s74, s50, 1
  s_mul_i32 s74, s74, 2560
  s_add_u32 s73, s73, s74
  s_mul_i32 s74, s83, 5120
  s_add_u32 s73, s73, s74
  s_add_u32 s73, s73, s82
  s_add_u32 s73, s73, 122880
  v_lshlrev_b32 v241, 7, v1
  v_add_u32 v238, s73, v241
  s_lshl_b32 s73, s72, 1
  s_add_u32 s73, s73, s50
  s_lshl_b32 s73, s73, 10
  s_lshl_b32 s74, s83, 7
  v_cmp_gt_u32 vcc, 20, v1
  s_add_u32 s73, s73, s74
  s_add_u32 s73, s73, 25559040
  v_mov_b32 v239, s73
  v_cndmask_b32 v238, v239, v238, vcc
  s_lshl_b32 s73, s2, 7
  s_mul_i32 s19, s50, 5120
  s_add_u32 m0, s19, 0
  s_add_u32 s68, s63, s50
  s_mul_i32 s68, s68, 21504
  s_add_u32 s68, s68, 23221248
  buffer_load_dwordx4 v2, s[36:39], s68 offen offset:0 sc1 lds
  s_add_u32 s73, s73, 25755648
  v_mov_b32 v239, s73
  v_cndmask_b32 v212, v239, v238, s[8:9]
  v_cmp_eq_u32 vcc, 0, v1
  s_lshl_b32 s74, s50, 3
  s_add_u32 s73, s73, s74
  v_mov_b32 v238, s73
  v_mov_b32 v239, 2147483648
  v_cndmask_b32 v215, v239, v238, vcc
  s_lshl_b32 s73, s23, 3
  s_lshr_b32 s74, s22, 1
  s_add_u32 s73, s73, s74
  s_and_b32 s74, s22, 1
  s_cmp_ge_u32 s23, 10
  s_cselect_b32 s71, -10, 0
  s_add_u32 s71, s71, s23
  s_sub_u32 s71, s71, s23
  s_lshl_b32 s71, s71, 3
  s_add_u32 s71, s71, s73
  s_lshl_b32 s7, s74, 2
  s_add_u32 s7, s7, s50
  s_mul_i32 s7, s7, 56
  s_add_u32 s7, s7, s71
  s_lshl_b32 s73, s73, 2
  s_add_u32 s73, s73, s50
  s_lshl_b32 s73, s73, 1
  buffer_load_dwordx4 v2, s[36:39], s68 offen offset:1024 sc1 lds
  s_add_u32 s73, s73, s74
  s_add_u32 s73, s73, -192
  s_cmp_ge_u32 s23, 10
  s_cselect_b32 s73, s73, s7
  s_lshl_b32 s73, s73, 5
  s_add_u32 s73, s73, 25788416
  s_cmp_eq_u32 s81, 2147483648
  s_cselect_b32 s73, 2147483648, s73
  v_mov_b32 v238, s73
  v_cndmask_b32 v190, v239, v238, vcc
  v_and_b32 v239, 15, v1
  v_min_u32 v239, 13, v239
  v_cmp_gt_u32 vcc, 16, v1
  v_add_u32 v238, s67, v239
  v_min_u32 v238, 53, v238
  s_mul_i32 s72, s83, 56
  v_add_u32 v238, s72, v238
  s_lshl_b32 s72, s66, 1
  s_add_u32 s72, s72, 448
  v_add_u32 v239, s72, v239
  v_cndmask_b32 v238, v239, v238, vcc
  v_lshlrev_b32 v238, 5, v238
  v_add_u32 v191, 25788416, v238
  s_lshl_b32 s72, s83, 2
  s_add_u32 s72, s72, s50
  s_lshr_b32 s73, s72, 1
  s_mul_i32 s73, s73, 2560
  buffer_load_dwordx4 v2, s[36:39], s68 offen offset:2048 sc1 lds
  s_and_b32 s74, s50, 1
  s_mul_i32 s7, s74, 1536
  s_add_u32 s7, s7, s73
  s_lshl_b32 s71, s74, 3
  s_add_u32 s71, s71, s73
  s_add_u32 s71, s71, 1024
  v_lshrrev_b32 v238, 1, v1
  v_and_b32 v238, 4, v238
  v_lshlrev_b32 v240, 1, v1
  v_and_b32 v240, 8, v240
  v_or_b32 v240, v240, v238
  v_and_b32 v238, 19, v1
  v_or_b32 v240, v240, v238
  v_lshrrev_b32 v241, 5, v1
  v_add_u32 v183, s7, v2
  v_and_b32 v238, 31, v1
  v_lshlrev_b32 v238, 4, v238
  v_add_u32 v184, s71, v238
  v_mul_u32_u24 v239, 274432, v241
  v_add_u32 v184, v184, v239
  v_lshlrev_b32 v238, 4, v240
  v_lshl_add_u32 v239, v241, 9, v238
  s_add_u32 s7, s7, 40960
  v_add_u32 v185, s7, v239
  v_mul_u32_u24 v239, 274432, v241
  buffer_load_dwordx4 v2, s[36:39], s68 offen offset:3072 sc1 lds
  v_add_u32 v239, v239, v238
  s_add_u32 s71, s71, 40960
  v_add_u32 v186, s71, v239
  v_and_b32 v239, 31, v1
  v_cmp_gt_u32 vcc, 16, v239
  s_lshl_b32 s7, s74, 2
  v_add_u32 v238, s7, v240
  s_lshl_b32 s7, s74, 4
  v_subrev_u32 v239, s7, v239
  v_cndmask_b32 v238, v239, v238, vcc
  v_mul_u32_u24 v239, 320, v241
  v_lshl_add_u32 v238, v238, 4, v239
  s_mul_i32 s72, s72, 1280
  s_add_u32 s72, s72, 81920
  v_add_u32 v187, s72, v238
  s_lshl_b32 s72, s83, 2
  s_add_u32 s72, s72, s50
  s_mul_i32 s72, s72, 20
  v_and_b32 v238, 1, v1
  v_mul_u32_u24 v238, 19, v238
  v_add_u32 v238, s72, v238
  v_lshrrev_b32 v238, 7, v238
  v_bfe_u32 v241, v1, 3, 2
  v_min_u32 v241, 2, v241
  v_mad_u32_u24 v238, v241, 5, v238
  s_add_u32 m0, m0, 4096
  s_add_u32 s68, s68, 4096
  buffer_load_dwordx4 v2, s[36:39], s68 offen offset:0 sc1 lds
  v_cmp_eq_u32 vcc, 0, v241
  v_bfe_u32 v239, v1, 1, 2
  v_min_u32 v239, 2, v239
  s_lshl_b32 s72, s48, 1
  s_lshr_b32 s73, s49, 4
  s_add_u32 s72, s72, s73
  s_sub_u32 s72, s72, 2
  v_cndmask_b32 v239, v239, 2, vcc
  v_add_u32 v239, s72, v239
  v_max_i32 v239, 0, v239
  v_and_b32 v241, 3, v239
  v_lshlrev_b32 v241, 6, v241
  v_lshrrev_b32 v239, 2, v239
  v_lshl_add_u32 v241, v239, 1, v241
  v_and_b32 v239, 7, v238
  v_lshl_add_u32 v241, v239, 3, v241
  v_lshrrev_b32 v238, 3, v238
  v_add_u32 v238, v238, v241
  v_lshlrev_b32 v238, 7, v238
  v_add_u32 v189, 25722880, v238
  v_and_b32 v238, 31, v1
  v_lshrrev_b32 v239, 5, v1
  v_lshlrev_b32 v239, 3, v239
  v_sub_u32 v238, v238, v239
  v_mov_b32 v239, 4286578688
  v_mov_b32 v156, 0
  v_cmp_le_i32 s[12:13], 0, v238
  v_cmp_le_i32 s[14:15], 1, v238
  s_nop 0
  v_cndmask_b32 v32, v239, v156, s[12:13]
  v_cndmask_b32 v48, v156, v239, s[12:13]
  v_cmp_le_i32 s[12:13], 2, v238
  v_cndmask_b32 v33, v239, v156, s[14:15]
  v_cndmask_b32 v49, v156, v239, s[14:15]
  v_cmp_le_i32 s[14:15], 3, v238
  v_cndmask_b32 v34, v239, v156, s[12:13]
  v_cndmask_b32 v50, v156, v239, s[12:13]
  v_cmp_le_i32 s[12:13], 4, v238
  v_cndmask_b32 v35, v239, v156, s[14:15]
  v_cndmask_b32 v51, v156, v239, s[14:15]
  v_cmp_le_i32 s[14:15], 5, v238
  v_cndmask_b32 v36, v239, v156, s[12:13]
  v_cndmask_b32 v52, v156, v239, s[12:13]
  v_cmp_le_i32 s[12:13], 6, v238
  v_cndmask_b32 v37, v239, v156, s[14:15]
  v_cndmask_b32 v53, v156, v239, s[14:15]
  v_cmp_le_i32 s[14:15], 7, v238
  v_cndmask_b32 v38, v239, v156, s[12:13]
  v_cndmask_b32 v54, v156, v239, s[12:13]
  v_cmp_le_i32 s[12:13], 16, v238
  v_cndmask_b32 v39, v239, v156, s[14:15]
  v_cndmask_b32 v55, v156, v239, s[14:15]
  v_cmp_le_i32 s[14:15], 17, v238
  v_cndmask_b32 v40, v239, v156, s[12:13]
  v_cndmask_b32 v56, v156, v239, s[12:13]
  v_cmp_le_i32 s[12:13], 18, v238
  v_cndmask_b32 v41, v239, v156, s[14:15]
  v_cndmask_b32 v57, v156, v239, s[14:15]
  v_cmp_le_i32 s[14:15], 19, v238
  v_cndmask_b32 v42, v239, v156, s[12:13]
  v_cndmask_b32 v58, v156, v239, s[12:13]
  v_cmp_le_i32 s[12:13], 20, v238
  v_cndmask_b32 v43, v239, v156, s[14:15]
  v_cndmask_b32 v59, v156, v239, s[14:15]
  v_cmp_le_i32 s[14:15], 21, v238
  v_cndmask_b32 v44, v239, v156, s[12:13]
  v_cndmask_b32 v60, v156, v239, s[12:13]
  v_cmp_le_i32 s[12:13], 22, v238
  v_cndmask_b32 v45, v239, v156, s[14:15]
  v_cndmask_b32 v61, v156, v239, s[14:15]
  v_cmp_le_i32 s[14:15], 23, v238
  v_cndmask_b32 v46, v239, v156, s[12:13]
  v_cndmask_b32 v62, v156, v239, s[12:13]
  v_cndmask_b32 v47, v239, v156, s[14:15]
  v_cndmask_b32 v63, v156, v239, s[14:15]
  s_mov_b64 exec, 0
  s_cmp_eq_u32 s50, 0
  s_cbranch_scc1 L_tc1_0
  s_cmp_eq_u32 s50, 1
  s_cbranch_scc1 L_tc1_1
  s_cmp_eq_u32 s50, 2
  s_cbranch_scc1 L_tc1_2
  s_branch L_tc1_3
L_tr1:
  s_mov_b64 exec, -1
  v_cndmask_b32 v191, v217, v191, s[8:9]
  s_waitcnt vmcnt(8)
  ds_bpermute_b32 v4, v214, v4
  ds_bpermute_b32 v5, v214, v5
  ds_bpermute_b32 v6, v214, v6
  ds_bpermute_b32 v7, v214, v7
  s_waitcnt vmcnt(7)
  ds_bpermute_b32 v8, v214, v8
  ds_bpermute_b32 v9, v214, v9
  ds_bpermute_b32 v10, v214, v10
  ds_bpermute_b32 v11, v214, v11
  s_waitcnt vmcnt(6)
  ds_bpermute_b32 v12, v214, v12
  ds_bpermute_b32 v13, v214, v13
  v_mov_b32 v14, v215
  s_getreg_b32 s72, hwreg(HW_REG_XCC_ID, 0, 4)
  s_waitcnt vmcnt(5)
  v_cmp_eq_u64 s[4:5], s[10:11], v[244:245]
  v_cmp_eq_u32 vcc, s72, v246
  s_nop 1
  s_and_b64 vcc, vcc, s[4:5]
  s_cmp_eq_u64 vcc, -1
  s_cselect_b32 s51, 1, 0
  s_cselect_b32 s7, 0, 2147483648
  s_mov_b32 s4, 1048575
  s_mov_b32 s5, 1048575
  buffer_load_dwordx2 v[150:151], v189, s[36:39], 0 offen sc1
  buffer_store_dwordx2 v[254:255], v190, s[36:39], 0 offen sc1
  s_waitcnt vmcnt(1)
  v_cmp_eq_u64 vcc, s[10:11], v[150:151]
  s_nop 1
  s_cmp_eq_u64 vcc, -1
  s_cbranch_scc0 L_ckr_34
L_ckb_35:
  s_waitcnt lgkmcnt(0)
  buffer_load_dwordx4 v[20:23], v183, s[36:39], s61 offen sc1
  buffer_load_dwordx2 v[24:25], v184, s[36:39], s60 offen sc1
  buffer_load_dwordx4 a[36:39], v185, s[36:39], s61 offen sc1
  buffer_load_dwordx2 a[48:49], v186, s[36:39], s60 offen sc1
  buffer_load_dwordx4 a[32:35], v185, s[36:39], s60 offen sc1
  s_mov_b64 exec, s[4:5]
  buffer_load_dwordx4 a[122:125], v187, s[36:39], s61 offen offset:0 sc1
  buffer_load_dwordx4 a[126:129], v187, s[36:39], s61 offen offset:640 sc1
  s_mov_b64 exec, -1
  buffer_load_dwordx4 v[16:19], v183, s[36:39], s60 offen sc1
  s_mov_b64 exec, s[4:5]
  buffer_load_dwordx4 a[114:117], v187, s[36:39], s60 offen offset:0 sc1
  buffer_load_dwordx4 a[118:121], v187, s[36:39], s60 offen offset:640 sc1
  s_mov_b64 exec, -1
  v_mov_b32 v26, 0
  v_mov_b32 v27, 0
  v_mov_b32 v28, 0
  v_mov_b32 v29, 0
  s_waitcnt vmcnt(8)
  v_mov_b32 v30, v24
  v_mov_b32 v31, v25
  v_permlane32_swap_b32 v24, v28
  v_permlane32_swap_b32 v25, v29
  v_permlane32_swap_b32 v26, v30
  v_permlane32_swap_b32 v27, v31
  s_waitcnt vmcnt(7)
  v_mfma_f32_32x32x16_bf16 v[64:79], a[36:39], v[20:23], v[32:47]
  s_waitcnt vmcnt(6)
  v_mfma_f32_32x32x8_bf16 v[64:79], a[48:49], v[30:31], v[64:79]
  s_waitcnt vmcnt(5)
  v_mfma_f32_32x32x16_bf16 v[80:95], a[32:35], v[20:23], 0
  s_nop 9
  v_exp_f32 v64, v64
  v_exp_f32 v65, v65
  v_exp_f32 v66, v66
  v_exp_f32 v67, v67
  buffer_load_dwordx4 a[28:31], v185, s[36:39], s59 offen sc1
  buffer_load_dwordx2 a[46:47], v186, s[36:39], s58 offen sc1
  v_exp_f32 v68, v68
  v_exp_f32 v69, v69
  v_exp_f32 v70, v70
  v_exp_f32 v71, v71
  v_cvt_pk_bf16_f32 v96, v64, v65
  v_cvt_pk_bf16_f32 v97, v66, v67
  v_mfma_f32_32x32x8_bf16 v[80:95], a[48:49], v[28:29], v[80:95]
  v_cvt_pk_bf16_f32 v98, v68, v69
  v_cvt_pk_bf16_f32 v99, v70, v71
  v_exp_f32 v72, v72
  v_exp_f32 v73, v73
  v_exp_f32 v74, v74
  v_exp_f32 v75, v75
  s_waitcnt vmcnt(6)
  v_mfma_f32_32x32x16_bf16 v[128:143], a[122:125], v[96:99], 0
  s_mov_b64 exec, s[4:5]
  buffer_load_dwordx4 a[106:109], v187, s[36:39], s59 offen offset:0 sc1
  buffer_load_dwordx4 a[110:113], v187, s[36:39], s59 offen offset:640 sc1
  s_mov_b64 exec, -1
  v_exp_f32 v76, v76
  v_exp_f32 v77, v77
  v_exp_f32 v78, v78
  v_exp_f32 v79, v79
  v_cvt_pk_bf16_f32 v100, v72, v73
  v_cvt_pk_bf16_f32 v101, v74, v75
  v_cvt_pk_bf16_f32 v102, v76, v77
  v_cvt_pk_bf16_f32 v103, v78, v79
  s_waitcnt vmcnt(6)
  v_mfma_f32_32x32x16_bf16 v[64:79], a[32:35], v[16:19], v[32:47]
  v_exp_f32 v80, v80
  v_exp_f32 v81, v81
  v_exp_f32 v82, v82
  v_exp_f32 v83, v83
  v_mfma_f32_32x32x16_bf16 v[128:143], a[126:129], v[100:103], v[128:143]
  buffer_load_dwordx4 a[24:27], v185, s[36:39], s58 offen sc1
  v_exp_f32 v84, v84
  v_exp_f32 v85, v85
  v_exp_f32 v86, v86
  v_exp_f32 v87, v87
  v_cvt_pk_bf16_f32 v104, v80, v81
  v_cvt_pk_bf16_f32 v105, v82, v83
  v_mfma_f32_32x32x8_bf16 v[64:79], a[48:49], v[24:25], v[64:79]
  v_cvt_pk_bf16_f32 v106, v84, v85
  v_cvt_pk_bf16_f32 v107, v86, v87
  v_exp_f32 v88, v88
  v_exp_f32 v89, v89
  v_exp_f32 v90, v90
  v_exp_f32 v91, v91
  s_waitcnt vmcnt(6)
  v_mfma_f32_32x32x16_bf16 v[128:143], a[114:117], v[104:107], v[128:143]
  s_mov_b64 exec, s[4:5]
  buffer_load_dwordx4 a[98:101], v187, s[36:39], s58 offen offset:0 sc1
  buffer_load_dwordx4 a[102:105], v187, s[36:39], s58 offen offset:640 sc1
  s_mov_b64 exec, -1
  v_exp_f32 v92, v92
  v_exp_f32 v93, v93
  v_exp_f32 v94, v94
  v_exp_f32 v95, v95
  v_cvt_pk_bf16_f32 v108, v88, v89
  v_cvt_pk_bf16_f32 v109, v90, v91
  v_cvt_pk_bf16_f32 v110, v92, v93
  v_cvt_pk_bf16_f32 v111, v94, v95
  s_waitcnt vmcnt(6)
  v_mfma_f32_32x32x16_bf16 v[80:95], a[28:31], v[20:23], 0
  v_exp_f32 v64, v64
  v_exp_f32 v65, v65
  v_exp_f32 v66, v66
  v_exp_f32 v67, v67
  v_mfma_f32_32x32x16_bf16 v[128:143], a[118:121], v[108:111], v[128:143]
  buffer_load_dwordx4 a[20:23], v185, s[36:39], s57 offen sc1
  buffer_load_dwordx2 a[44:45], v186, s[36:39], s56 offen sc1
  v_exp_f32 v68, v68
  v_exp_f32 v69, v69
  v_exp_f32 v70, v70
  v_exp_f32 v71, v71
  v_cvt_pk_bf16_f32 v96, v64, v65
  v_cvt_pk_bf16_f32 v97, v66, v67
  s_waitcnt vmcnt(7)
  v_mfma_f32_32x32x8_bf16 v[80:95], a[46:47], v[30:31], v[80:95]
  v_cvt_pk_bf16_f32 v98, v68, v69
  v_cvt_pk_bf16_f32 v99, v70, v71
  v_exp_f32 v72, v72
  v_exp_f32 v73, v73
  v_exp_f32 v74, v74
  v_exp_f32 v75, v75
  v_mfma_f32_32x32x16_bf16 v[112:127], a[114:117], v[96:99], 0
  s_mov_b64 exec, s[4:5]
  buffer_load_dwordx4 a[90:93], v187, s[36:39], s57 offen offset:0 sc1
  buffer_load_dwordx4 a[94:97], v187, s[36:39], s57 offen offset:640 sc1
  s_mov_b64 exec, -1
  v_exp_f32 v76, v76
  v_exp_f32 v77, v77
  v_exp_f32 v78, v78
  v_exp_f32 v79, v79
  v_cvt_pk_bf16_f32 v100, v72, v73
  v_cvt_pk_bf16_f32 v101, v74, v75
  v_cvt_pk_bf16_f32 v102, v76, v77
  v_cvt_pk_bf16_f32 v103, v78, v79
  v_mfma_f32_32x32x16_bf16 v[64:79], a[28:31], v[16:19], 0
  v_exp_f32 v80, v80
  v_exp_f32 v81, v81
  v_exp_f32 v82, v82
  v_exp_f32 v83, v83
  v_mfma_f32_32x32x16_bf16 v[112:127], a[118:121], v[100:103], v[112:127]
  buffer_load_dwordx4 a[16:19], v185, s[36:39], s56 offen sc1
  v_exp_f32 v84, v84
  v_exp_f32 v85, v85
  v_exp_f32 v86, v86
  v_exp_f32 v87, v87
  v_cvt_pk_bf16_f32 v104, v80, v81
  v_cvt_pk_bf16_f32 v105, v82, v83
  v_mfma_f32_32x32x8_bf16 v[64:79], a[46:47], v[26:27], v[64:79]
  v_cvt_pk_bf16_f32 v106, v84, v85
  v_cvt_pk_bf16_f32 v107, v86, v87
  v_exp_f32 v88, v88
  v_exp_f32 v89, v89
  v_exp_f32 v90, v90
  v_exp_f32 v91, v91
  s_waitcnt vmcnt(9)
  v_mfma_f32_32x32x16_bf16 v[128:143], a[106:109], v[104:107], v[128:143]
  s_mov_b64 exec, s[4:5]
  buffer_load_dwordx4 a[82:85], v187, s[36:39], s56 offen offset:0 sc1
  buffer_load_dwordx4 a[86:89], v187, s[36:39], s56 offen offset:640 sc1
  s_mov_b64 exec, -1
  v_exp_f32 v92, v92
  v_exp_f32 v93, v93
  v_exp_f32 v94, v94
  v_exp_f32 v95, v95
  v_cvt_pk_bf16_f32 v108, v88, v89
  v_cvt_pk_bf16_f32 v109, v90, v91
  v_cvt_pk_bf16_f32 v110, v92, v93
  v_cvt_pk_bf16_f32 v111, v94, v95
  s_waitcnt vmcnt(9)
  v_mfma_f32_32x32x16_bf16 v[80:95], a[24:27], v[20:23], 0
  v_exp_f32 v64, v64
  v_exp_f32 v65, v65
  v_exp_f32 v66, v66
  v_exp_f32 v67, v67
  v_mfma_f32_32x32x16_bf16 v[128:143], a[110:113], v[108:111], v[128:143]
  buffer_load_dwordx4 a[12:15], v185, s[36:39], s55 offen sc1
  buffer_load_dwordx2 a[42:43], v186, s[36:39], s54 offen sc1
  v_exp_f32 v68, v68
  v_exp_f32 v69, v69
  v_exp_f32 v70, v70
  v_exp_f32 v71, v71
  v_cvt_pk_bf16_f32 v96, v64, v65
  v_cvt_pk_bf16_f32 v97, v66, v67
  v_mfma_f32_32x32x8_bf16 v[80:95], a[46:47], v[28:29], v[80:95]
  v_cvt_pk_bf16_f32 v98, v68, v69
  v_cvt_pk_bf16_f32 v99, v70, v71
  v_exp_f32 v72, v72
  v_exp_f32 v73, v73
  v_exp_f32 v74, v74
  v_exp_f32 v75, v75
  v_mfma_f32_32x32x16_bf16 v[112:127], a[106:109], v[96:99], v[112:127]
  s_mov_b64 exec, s[4:5]
  buffer_load_dwordx4 a[74:77], v187, s[36:39], s55 offen offset:0 sc1
  buffer_load_dwordx4 a[78:81], v187, s[36:39], s55 offen offset:640 sc1
  s_mov_b64 exec, -1
  v_exp_f32 v76, v76
  v_exp_f32 v77, v77
  v_exp_f32 v78, v78
  v_exp_f32 v79, v79
  v_cvt_pk_bf16_f32 v100, v72, v73
  v_cvt_pk_bf16_f32 v101, v74, v75
  v_cvt_pk_bf16_f32 v102, v76, v77
  v_cvt_pk_bf16_f32 v103, v78, v79
  v_mfma_f32_32x32x16_bf16 v[64:79], a[24:27], v[16:19], 0
  v_exp_f32 v80, v80
  v_exp_f32 v81, v81
  v_exp_f32 v82, v82
  v_exp_f32 v83, v83
  v_mfma_f32_32x32x16_bf16 v[112:127], a[110:113], v[100:103], v[112:127]
  buffer_load_dwordx4 a[8:11], v185, s[36:39], s54 offen sc1
  v_exp_f32 v84, v84
  v_exp_f32 v85, v85
  v_exp_f32 v86, v86
  v_exp_f32 v87, v87
  v_cvt_pk_bf16_f32 v104, v80, v81
  v_cvt_pk_bf16_f32 v105, v82, v83
  v_mfma_f32_32x32x8_bf16 v[64:79], a[46:47], v[24:25], v[64:79]
  v_cvt_pk_bf16_f32 v106, v84, v85
  v_cvt_pk_bf16_f32 v107, v86, v87
  v_exp_f32 v88, v88
  v_exp_f32 v89, v89
  v_exp_f32 v90, v90
  v_exp_f32 v91, v91
  s_waitcnt vmcnt(13)
  v_mfma_f32_32x32x16_bf16 v[128:143], a[98:101], v[104:107], v[128:143]
  s_mov_b64 exec, s[4:5]
  buffer_load_dwordx4 a[66:69], v187, s[36:39], s54 offen offset:0 sc1
  buffer_load_dwordx4 a[70:73], v187, s[36:39], s54 offen offset:640 sc1
  s_mov_b64 exec, -1
  v_exp_f32 v92, v92
  v_exp_f32 v93, v93
  v_exp_f32 v94, v94
  v_exp_f32 v95, v95
  v_cvt_pk_bf16_f32 v108, v88, v89
  v_cvt_pk_bf16_f32 v109, v90, v91
  v_cvt_pk_bf16_f32 v110, v92, v93
  v_cvt_pk_bf16_f32 v111, v94, v95
  buffer_load_dwordx2 v[158:159], v191, s[36:39], 0 offen sc1
  s_waitcnt vmcnt(14)
  v_mfma_f32_32x32x16_bf16 v[80:95], a[20:23], v[20:23], 0
  v_exp_f32 v64, v64
  v_exp_f32 v65, v65
  v_exp_f32 v66, v66
  v_exp_f32 v67, v67
  v_mfma_f32_32x32x16_bf16 v[128:143], a[102:105], v[108:111], v[128:143]
  buffer_load_dwordx4 a[4:7], v185, s[36:39], s53 offen sc1
  buffer_load_dwordx2 a[40:41], v186, s[36:39], s52 offen sc1
  v_exp_f32 v68, v68
  v_exp_f32 v69, v69
  v_exp_f32 v70, v70
  v_exp_f32 v71, v71
  v_cvt_pk_bf16_f32 v96, v64, v65
  v_cvt_pk_bf16_f32 v97, v66, v67
  s_waitcnt vmcnt(15)
  v_mfma_f32_32x32x8_bf16 v[80:95], a[44:45], v[30:31], v[80:95]
  v_cvt_pk_bf16_f32 v98, v68, v69
  v_cvt_pk_bf16_f32 v99, v70, v71
  v_exp_f32 v72, v72
  v_exp_f32 v73, v73
  v_exp_f32 v74, v74
  v_exp_f32 v75, v75
  v_mfma_f32_32x32x16_bf16 v[112:127], a[98:101], v[96:99], v[112:127]
  s_mov_b64 exec, s[4:5]
  buffer_load_dwordx4 a[58:61], v187, s[36:39], s53 offen offset:0 sc1
  buffer_load_dwordx4 a[62:65], v187, s[36:39], s53 offen offset:640 sc1
  s_mov_b64 exec, -1
  v_exp_f32 v76, v76
  v_exp_f32 v77, v77
  v_exp_f32 v78, v78
  v_exp_f32 v79, v79
  v_cvt_pk_bf16_f32 v100, v72, v73
  v_cvt_pk_bf16_f32 v101, v74, v75
  v_cvt_pk_bf16_f32 v102, v76, v77
  v_cvt_pk_bf16_f32 v103, v78, v79
  v_mfma_f32_32x32x16_bf16 v[64:79], a[20:23], v[16:19], 0
  v_exp_f32 v80, v80
  v_exp_f32 v81, v81
  v_exp_f32 v82, v82
  v_exp_f32 v83, v83
  v_mfma_f32_32x32x16_bf16 v[112:127], a[102:105], v[100:103], v[112:127]
  buffer_load_dwordx4 a[0:3], v185, s[36:39], s52 offen sc1
  v_exp_f32 v84, v84
  v_exp_f32 v85, v85
  v_exp_f32 v86, v86
  v_exp_f32 v87, v87
  v_cvt_pk_bf16_f32 v104, v80, v81
  v_cvt_pk_bf16_f32 v105, v82, v83
  v_mfma_f32_32x32x8_bf16 v[64:79], a[44:45], v[26:27], v[64:79]
  v_cvt_pk_bf16_f32 v106, v84, v85
  v_cvt_pk_bf16_f32 v107, v86, v87
  v_exp_f32 v88, v88
  v_exp_f32 v89, v89
  v_exp_f32 v90, v90
  v_exp_f32 v91, v91
  s_waitcnt vmcnt(17)
  v_mfma_f32_32x32x16_bf16 v[128:143], a[90:93], v[104:107], v[128:143]
  s_mov_b64 exec, s[4:5]
  buffer_load_dwordx4 a[50:53], v187, s[36:39], s52 offen offset:0 sc1
  buffer_load_dwordx4 a[54:57], v187, s[36:39], s52 offen offset:640 sc1
  s_mov_b64 exec, -1
  v_exp_f32 v92, v92
  v_exp_f32 v93, v93
  v_exp_f32 v94, v94
  v_exp_f32 v95, v95
  v_cvt_pk_bf16_f32 v108, v88, v89
  v_cvt_pk_bf16_f32 v109, v90, v91
  v_cvt_pk_bf16_f32 v110, v92, v93
  v_cvt_pk_bf16_f32 v111, v94, v95
  s_waitcnt vmcnt(17)
  v_mfma_f32_32x32x16_bf16 v[80:95], a[16:19], v[20:23], 0
  v_exp_f32 v64, v64
  v_exp_f32 v65, v65
  v_exp_f32 v66, v66
  v_exp_f32 v67, v67
  v_mfma_f32_32x32x16_bf16 v[128:143], a[94:97], v[108:111], v[128:143]
  s_min_u32 s68, s50, 2
  s_mul_i32 s19, s68, 5120
  s_add_u32 m0, s19, 20480
  s_add_u32 s68, s68, s69
  s_mul_i32 s68, s68, 21504
  s_add_u32 s68, s68, 23221248
  buffer_load_dwordx4 v2, s[36:39], s68 offen offset:0 sc1 lds
  v_exp_f32 v68, v68
  v_exp_f32 v69, v69
  v_exp_f32 v70, v70
  v_exp_f32 v71, v71
  v_cvt_pk_bf16_f32 v96, v64, v65
  v_cvt_pk_bf16_f32 v97, v66, v67
  v_mfma_f32_32x32x8_bf16 v[80:95], a[44:45], v[28:29], v[80:95]
  v_cvt_pk_bf16_f32 v98, v68, v69
  v_cvt_pk_bf16_f32 v99, v70, v71
  v_exp_f32 v72, v72
  v_exp_f32 v73, v73
  v_exp_f32 v74, v74
  v_exp_f32 v75, v75
  v_mfma_f32_32x32x16_bf16 v[112:127], a[90:93], v[96:99], v[112:127]
  buffer_load_dwordx4 v2, s[36:39], s68 offen offset:1024 sc1 lds
  v_exp_f32 v76, v76
  v_exp_f32 v77, v77
  v_exp_f32 v78, v78
  v_exp_f32 v79, v79
  v_cvt_pk_bf16_f32 v100, v72, v73
  v_cvt_pk_bf16_f32 v101, v74, v75
  v_cvt_pk_bf16_f32 v102, v76, v77
  v_cvt_pk_bf16_f32 v103, v78, v79
  s_waitcnt vmcnt(9)
  v_cmp_eq_u64 vcc, s[10:11], v[158:159]
  s_nop 1
  s_cmp_eq_u64 vcc, -1
  s_cbranch_scc0 L_ckr_36
L_ckb_37:
  v_mfma_f32_32x32x16_bf16 v[64:79], a[16:19], v[16:19], 0
  v_exp_f32 v80, v80
  v_exp_f32 v81, v81
  v_exp_f32 v82, v82
  v_exp_f32 v83, v83
  v_mfma_f32_32x32x16_bf16 v[112:127], a[94:97], v[100:103], v[112:127]
  s_add_u32 s75, s62, 0
  buffer_load_dwordx4 a[132:135], v2, s[36:39], s75 offen offset:0 sc1
  v_exp_f32 v84, v84
  v_exp_f32 v85, v85
  v_exp_f32 v86, v86
  v_exp_f32 v87, v87
  v_cvt_pk_bf16_f32 v104, v80, v81
  v_cvt_pk_bf16_f32 v105, v82, v83
  v_mfma_f32_32x32x8_bf16 v[64:79], a[44:45], v[24:25], v[64:79]
  v_cvt_pk_bf16_f32 v106, v84, v85
  v_cvt_pk_bf16_f32 v107, v86, v87
  v_exp_f32 v88, v88
  v_exp_f32 v89, v89
  v_exp_f32 v90, v90
  v_exp_f32 v91, v91
  v_mfma_f32_32x32x16_bf16 v[128:143], a[82:85], v[104:107], v[128:143]
  buffer_load_dwordx4 a[136:139], v2, s[36:39], s75 offen offset:1024 sc1
  v_exp_f32 v92, v92
  v_exp_f32 v93, v93
  v_exp_f32 v94, v94
  v_exp_f32 v95, v95
  v_cvt_pk_bf16_f32 v108, v88, v89
  v_cvt_pk_bf16_f32 v109, v90, v91
  v_cvt_pk_bf16_f32 v110, v92, v93
  v_cvt_pk_bf16_f32 v111, v94, v95
  buffer_load_dword v157, v212, s[36:39], s7 offen sc1
  v_mfma_f32_32x32x16_bf16 v[80:95], a[12:15], v[20:23], 0
  v_exp_f32 v64, v64
  v_exp_f32 v65, v65
  v_exp_f32 v66, v66
  v_exp_f32 v67, v67
  v_mfma_f32_32x32x16_bf16 v[128:143], a[86:89], v[108:111], v[128:143]
  buffer_load_dwordx4 a[140:143], v2, s[36:39], s75 offen offset:2048 sc1
  v_exp_f32 v68, v68
  v_exp_f32 v69, v69
  v_exp_f32 v70, v70
  v_exp_f32 v71, v71
  v_cvt_pk_bf16_f32 v96, v64, v65
  v_cvt_pk_bf16_f32 v97, v66, v67
  v_mfma_f32_32x32x8_bf16 v[80:95], a[42:43], v[30:31], v[80:95]
  v_cvt_pk_bf16_f32 v98, v68, v69
  v_cvt_pk_bf16_f32 v99, v70, v71
  v_exp_f32 v72, v72
  v_exp_f32 v73, v73
  v_exp_f32 v74, v74
  v_exp_f32 v75, v75
  v_mfma_f32_32x32x16_bf16 v[112:127], a[82:85], v[96:99], v[112:127]
  buffer_load_dwordx4 v2, s[36:39], s68 offen offset:2048 sc1 lds
  v_exp_f32 v76, v76
  v_exp_f32 v77, v77
  v_exp_f32 v78, v78
  v_exp_f32 v79, v79
  v_cvt_pk_bf16_f32 v100, v72, v73
  v_cvt_pk_bf16_f32 v101, v74, v75
  v_cvt_pk_bf16_f32 v102, v76, v77
  v_cvt_pk_bf16_f32 v103, v78, v79
  v_mfma_f32_32x32x16_bf16 v[64:79], a[12:15], v[16:19], 0
  v_exp_f32 v80, v80
L_tc1_0:
  s_cbranch_execz L_tr1
  v_exp_f32 v81, v81
  v_exp_f32 v82, v82
  v_exp_f32 v83, v83
  v_mfma_f32_32x32x16_bf16 v[112:127], a[86:89], v[100:103], v[112:127]
  buffer_load_dwordx4 a[144:147], v2, s[36:39], s75 offen offset:3072 sc1
  v_exp_f32 v84, v84
  v_exp_f32 v85, v85
  v_exp_f32 v86, v86
  v_exp_f32 v87, v87
  v_cvt_pk_bf16_f32 v104, v80, v81
  v_cvt_pk_bf16_f32 v105, v82, v83
  v_mfma_f32_32x32x8_bf16 v[64:79], a[42:43], v[26:27], v[64:79]
  v_cvt_pk_bf16_f32 v106, v84, v85
  v_cvt_pk_bf16_f32 v107, v86, v87
  v_exp_f32 v88, v88
  v_exp_f32 v89, v89
  v_exp_f32 v90, v90
  v_exp_f32 v91, v91
  v_mfma_f32_32x32x16_bf16 v[128:143], a[74:77], v[104:107], v[128:143]
  s_add_u32 s75, s62, 4096
  buffer_load_dwordx4 a[148:151], v2, s[36:39], s75 offen offset:0 sc1
  v_exp_f32 v92, v92
  v_exp_f32 v93, v93
  v_exp_f32 v94, v94
  v_exp_f32 v95, v95
  v_cvt_pk_bf16_f32 v108, v88, v89
  v_cvt_pk_bf16_f32 v109, v90, v91
  v_cvt_pk_bf16_f32 v110, v92, v93
  v_cvt_pk_bf16_f32 v111, v94, v95
  v_mfma_f32_32x32x16_bf16 v[80:95], a[8:11], v[20:23], 0
  v_exp_f32 v64, v64
  v_exp_f32 v65, v65
  v_exp_f32 v66, v66
  v_exp_f32 v67, v67
  v_mfma_f32_32x32x16_bf16 v[128:143], a[78:81], v[108:111], v[128:143]
  buffer_load_dwordx4 a[152:155], v2, s[36:39], s75 offen offset:1024 sc1
  v_exp_f32 v68, v68
  v_exp_f32 v69, v69
  v_exp_f32 v70, v70
  v_exp_f32 v71, v71
  v_cvt_pk_bf16_f32 v96, v64, v65
  v_cvt_pk_bf16_f32 v97, v66, v67
  v_mfma_f32_32x32x8_bf16 v[80:95], a[42:43], v[28:29], v[80:95]
  v_cvt_pk_bf16_f32 v98, v68, v69
  v_cvt_pk_bf16_f32 v99, v70, v71
  v_exp_f32 v72, v72
  v_exp_f32 v73, v73
  v_exp_f32 v74, v74
  v_exp_f32 v75, v75
  v_mfma_f32_32x32x16_bf16 v[112:127], a[74:77], v[96:99], v[112:127]
  buffer_load_dwordx4 v2, s[36:39], s68 offen offset:3072 sc1 lds
  v_exp_f32 v76, v76
  v_exp_f32 v77, v77
  v_exp_f32 v78, v78
  v_exp_f32 v79, v79
  v_cvt_pk_bf16_f32 v100, v72, v73
  v_cvt_pk_bf16_f32 v101, v74, v75
  v_cvt_pk_bf16_f32 v102, v76, v77
  v_cvt_pk_bf16_f32 v103, v78, v79
  v_mfma_f32_32x32x16_bf16 v[64:79], a[8:11], v[16:19], 0
  v_exp_f32 v80, v80
  v_exp_f32 v81, v81
  v_exp_f32 v82, v82
  v_exp_f32 v83, v83
  v_mfma_f32_32x32x16_bf16 v[112:127], a[78:81], v[100:103], v[112:127]
  buffer_load_dwordx4 a[156:159], v2, s[36:39], s75 offen offset:2048 sc1
  v_exp_f32 v84, v84
  v_exp_f32 v85, v85
  v_exp_f32 v86, v86
  v_exp_f32 v87, v87
  v_cvt_pk_bf16_f32 v104, v80, v81
  v_cvt_pk_bf16_f32 v105, v82, v83
  v_mfma_f32_32x32x8_bf16 v[64:79], a[42:43], v[24:25], v[64:79]
  v_cvt_pk_bf16_f32 v106, v84, v85
  v_cvt_pk_bf16_f32 v107, v86, v87
  v_exp_f32 v88, v88
  v_exp_f32 v89, v89
  v_exp_f32 v90, v90
  v_exp_f32 v91, v91
  v_mfma_f32_32x32x16_bf16 v[128:143], a[66:69], v[104:107], v[128:143]
  buffer_load_dwordx4 a[160:163], v2, s[36:39], s75 offen offset:3072 sc1
  v_exp_f32 v92, v92
  v_exp_f32 v93, v93
  v_exp_f32 v94, v94
  v_exp_f32 v95, v95
  v_cvt_pk_bf16_f32 v108, v88, v89
  v_cvt_pk_bf16_f32 v109, v90, v91
  v_cvt_pk_bf16_f32 v110, v92, v93
  v_cvt_pk_bf16_f32 v111, v94, v95
  s_waitcnt vmcnt(19)
  v_mfma_f32_32x32x16_bf16 v[80:95], a[4:7], v[20:23], v[48:63]
  v_exp_f32 v64, v64
  v_exp_f32 v65, v65
  v_exp_f32 v66, v66
  v_exp_f32 v67, v67
  v_mfma_f32_32x32x16_bf16 v[128:143], a[70:73], v[108:111], v[128:143]
  s_add_u32 s75, s62, 8192
  buffer_load_dwordx4 a[164:167], v2, s[36:39], s75 offen offset:0 sc1
  v_exp_f32 v68, v68
  v_exp_f32 v69, v69
  v_exp_f32 v70, v70
  v_exp_f32 v71, v71
  v_cvt_pk_bf16_f32 v96, v64, v65
  v_cvt_pk_bf16_f32 v97, v66, v67
  s_waitcnt vmcnt(19)
  v_mfma_f32_32x32x8_bf16 v[80:95], a[40:41], v[30:31], v[80:95]
  v_cvt_pk_bf16_f32 v98, v68, v69
  v_cvt_pk_bf16_f32 v99, v70, v71
  v_exp_f32 v72, v72
  v_exp_f32 v73, v73
  v_exp_f32 v74, v74
  v_exp_f32 v75, v75
  v_mfma_f32_32x32x16_bf16 v[112:127], a[66:69], v[96:99], v[112:127]
  s_add_u32 m0, m0, 4096
  s_add_u32 s68, s68, 4096
  buffer_load_dwordx4 v2, s[36:39], s68 offen offset:0 sc1 lds
  v_exp_f32 v76, v76
  v_exp_f32 v77, v77
  v_exp_f32 v78, v78
  v_exp_f32 v79, v79
  v_cvt_pk_bf16_f32 v100, v72, v73
  v_cvt_pk_bf16_f32 v101, v74, v75
  v_cvt_pk_bf16_f32 v102, v76, v77
  v_cvt_pk_bf16_f32 v103, v78, v79
  v_mfma_f32_32x32x16_bf16 v[64:79], a[4:7], v[16:19], 0
  v_exp_f32 v80, v80
  v_exp_f32 v81, v81
  v_exp_f32 v82, v82
  v_exp_f32 v83, v83
  v_mfma_f32_32x32x16_bf16 v[112:127], a[70:73], v[100:103], v[112:127]
  buffer_load_dwordx4 a[168:171], v2, s[36:39], s75 offen offset:1024 sc1
  v_exp_f32 v84, v84
  v_exp_f32 v85, v85
  v_exp_f32 v86, v86
  v_exp_f32 v87, v87
  v_cvt_pk_bf16_f32 v104, v80, v81
  v_cvt_pk_bf16_f32 v105, v82, v83
  v_mfma_f32_32x32x8_bf16 v[64:79], a[40:41], v[26:27], v[64:79]
  v_cvt_pk_bf16_f32 v106, v84, v85
  v_cvt_pk_bf16_f32 v107, v86, v87
  v_exp_f32 v88, v88
  v_exp_f32 v89, v89
  v_exp_f32 v90, v90
  v_exp_f32 v91, v91
  s_waitcnt vmcnt(20)
  v_mfma_f32_32x32x16_bf16 v[128:143], a[58:61], v[104:107], v[128:143]
  buffer_load_dwordx4 a[172:175], v2, s[36:39], s75 offen offset:2048 sc1
  v_exp_f32 v92, v92
  v_exp_f32 v93, v93
  v_exp_f32 v94, v94
  v_exp_f32 v95, v95
  v_cvt_pk_bf16_f32 v108, v88, v89
  v_cvt_pk_bf16_f32 v109, v90, v91
  v_cvt_pk_bf16_f32 v110, v92, v93
  v_cvt_pk_bf16_f32 v111, v94, v95
  s_waitcnt vmcnt(19)
  v_mfma_f32_32x32x16_bf16 v[80:95], a[0:3], v[16:19], v[48:63]
  v_exp_f32 v64, v64
  v_exp_f32 v65, v65
  v_exp_f32 v66, v66
  v_exp_f32 v67, v67
  v_mfma_f32_32x32x16_bf16 v[128:143], a[62:65], v[108:111], v[128:143]
  buffer_load_dwordx4 a[176:179], v2, s[36:39], s75 offen offset:3072 sc1
  v_exp_f32 v68, v68
  v_exp_f32 v69, v69
  v_exp_f32 v70, v70
  v_exp_f32 v71, v71
  v_cvt_pk_bf16_f32 v96, v64, v65
  v_cvt_pk_bf16_f32 v97, v66, v67
  v_mfma_f32_32x32x8_bf16 v[80:95], a[40:41], v[24:25], v[80:95]
  v_cvt_pk_bf16_f32 v98, v68, v69
  v_cvt_pk_bf16_f32 v99, v70, v71
  v_exp_f32 v72, v72
  v_exp_f32 v73, v73
  v_exp_f32 v74, v74
  v_exp_f32 v75, v75
  v_mfma_f32_32x32x16_bf16 v[112:127], a[58:61], v[96:99], v[112:127]
  s_mul_i32 s19, s50, 7168
  s_add_u32 m0, s19, 35840
  s_add_u32 s68, s63, s50
  s_mul_i32 s68, s68, 21504
  s_add_u32 s68, s68, 23226368
  buffer_load_dwordx4 v2, s[36:39], s68 offen offset:0 sc1 lds
  v_exp_f32 v76, v76
  v_exp_f32 v77, v77
  v_exp_f32 v78, v78
  v_exp_f32 v79, v79
  v_cvt_pk_bf16_f32 v100, v72, v73
  v_cvt_pk_bf16_f32 v101, v74, v75
  v_cvt_pk_bf16_f32 v102, v76, v77
  v_cvt_pk_bf16_f32 v103, v78, v79
  v_exp_f32 v80, v80
  v_exp_f32 v81, v81
  v_exp_f32 v82, v82
  v_exp_f32 v83, v83
  v_mfma_f32_32x32x16_bf16 v[112:127], a[62:65], v[100:103], v[112:127]
  s_add_u32 s75, s62, 12288
  buffer_load_dwordx4 a[180:183], v2, s[36:39], s75 offen offset:0 sc1
  v_exp_f32 v84, v84
  v_exp_f32 v85, v85
  v_exp_f32 v86, v86
  v_exp_f32 v87, v87
  v_cvt_pk_bf16_f32 v104, v80, v81
  v_cvt_pk_bf16_f32 v105, v82, v83
  v_cvt_pk_bf16_f32 v106, v84, v85
  v_cvt_pk_bf16_f32 v107, v86, v87
  v_exp_f32 v88, v88
  v_exp_f32 v89, v89
  v_exp_f32 v90, v90
  v_exp_f32 v91, v91
  s_waitcnt vmcnt(21)
  v_mfma_f32_32x32x16_bf16 v[112:127], a[50:53], v[104:107], v[112:127]
  buffer_load_dwordx4 a[184:187], v2, s[36:39], s75 offen offset:1024 sc1
  v_exp_f32 v92, v92
  v_exp_f32 v93, v93
  v_exp_f32 v94, v94
  v_exp_f32 v95, v95
  v_cvt_pk_bf16_f32 v108, v88, v89
  v_cvt_pk_bf16_f32 v109, v90, v91
  v_cvt_pk_bf16_f32 v110, v92, v93
  v_cvt_pk_bf16_f32 v111, v94, v95
  s_waitcnt vmcnt(21)
  s_nop 0
  v_mfma_f32_32x32x16_bf16 v[112:127], a[54:57], v[108:111], v[112:127]
  s_mov_b32 s72, 671088640
  v_subrev_u32 v150, 729808896, v140
  s_nop 9
  v_subrev_u32 v151, 729808896, v124
  v_max_u32 v150, v150, v151
  v_cmp_lt_u32 vcc, s72, v150
  s_nop 1
  s_cbranch_vccnz L_max_38
L_maxd_39:
  s_nop 10
  v_rcp_f32 v142, v140
  s_nop 0
  v_pk_mul_f32 v[128:129], v[128:129], v[142:143] op_sel_hi:[1,0]
  v_pk_mul_f32 v[130:131], v[130:131], v[142:143] op_sel_hi:[1,0]
  v_pk_mul_f32 v[132:133], v[132:133], v[142:143] op_sel_hi:[1,0]
  v_pk_mul_f32 v[134:135], v[134:135], v[142:143] op_sel_hi:[1,0]
  v_pk_mul_f32 v[136:137], v[136:137], v[142:143] op_sel_hi:[1,0]
  v_pk_mul_f32 v[138:139], v[138:139], v[142:143] op_sel_hi:[1,0]
  v_cvt_pk_bf16_f32 v72, v128, v129
  v_cvt_pk_bf16_f32 v73, v130, v131
  v_cvt_pk_bf16_f32 v74, v132, v133
  v_cvt_pk_bf16_f32 v75, v134, v135
  v_cvt_pk_bf16_f32 v76, v136, v137
  v_cvt_pk_bf16_f32 v77, v138, v139
  v_rcp_f32 v126, v124
  s_nop 0
  v_pk_mul_f32 v[112:113], v[112:113], v[126:127] op_sel_hi:[1,0]
  v_pk_mul_f32 v[114:115], v[114:115], v[126:127] op_sel_hi:[1,0]
  v_pk_mul_f32 v[116:117], v[116:117], v[126:127] op_sel_hi:[1,0]
  v_pk_mul_f32 v[118:119], v[118:119], v[126:127] op_sel_hi:[1,0]
  v_pk_mul_f32 v[120:121], v[120:121], v[126:127] op_sel_hi:[1,0]
  v_pk_mul_f32 v[122:123], v[122:123], v[126:127] op_sel_hi:[1,0]
  v_cvt_pk_bf16_f32 v64, v112, v113
  v_cvt_pk_bf16_f32 v65, v114, v115
  v_cvt_pk_bf16_f32 v66, v116, v117
  v_cvt_pk_bf16_f32 v67, v118, v119
  v_cvt_pk_bf16_f32 v68, v120, v121
  v_cvt_pk_bf16_f32 v69, v122, v123
  s_nop 0
  v_permlane32_swap_b32 v68, v76
  v_permlane32_swap_b32 v69, v77
  s_cmp_lg_u32 s51, 0
  s_cbranch_scc0 L_stw_40
  buffer_store_dwordx4 v[72:75], v183, s[36:39], s61 offen offset:0
  buffer_store_dwordx4 v[64:67], v183, s[36:39], s60 offen offset:0
  buffer_store_dwordx2 v[68:69], v184, s[36:39], s60 offen offset:0
L_ste_41:
  buffer_load_dwordx4 a[188:191], v2, s[36:39], s75 offen offset:2048 sc1
  buffer_load_dwordx4 v2, s[36:39], s68 offen offset:1024 sc1 lds
  buffer_load_dwordx4 a[192:195], v2, s[36:39], s75 offen offset:3072 sc1
  v_mov_b32 v222, s10
  v_mov_b32 v223, s11
  s_and_b32 s72, s49, 24
  s_lshl_b32 s73, s50, 1
  s_add_u32 s72, s72, s73
  v_bfe_u32 v16, v1, 2, 1
  v_add_u32 v16, s72, v16
  v_lshlrev_b32 v16, 3, v16
  v_add_u32 v16, s48, v16
  v_and_b32 v17, 3, v1
  v_lshlrev_b32 v17, 3, v17
  v_lshl_add_u32 v16, v16, 7, v17
  v_add_u32 v18, 25755648, v16
  s_mul_i32 s71, s50, 10240
  s_add_u32 s72, s50, 1
  s_and_b32 s72, s72, 3
  s_mul_i32 s73, s72, 15360
  s_add_u32 s12, s73, 102400
  s_lshr_b32 s73, s72, 1
  s_mul_i32 s73, s73, 274432
  s_and_b32 s72, s72, 1
  s_lshl_b32 s72, s72, 8
  s_add_u32 s72, s72, s73
  s_add_u32 s72, s72, s82
  s_add_u32 s52, s72, s71
  s_add_u32 s72, s50, 2
  s_and_b32 s72, s72, 3
  s_mul_i32 s73, s72, 15360
  s_add_u32 s13, s73, 107520
  s_lshr_b32 s73, s72, 1
  s_mul_i32 s73, s73, 274432
  s_and_b32 s72, s72, 1
  s_lshl_b32 s72, s72, 8
  s_add_u32 s72, s72, s73
  s_add_u32 s72, s72, s82
  s_add_u32 s53, s72, s71
  s_add_u32 s72, s50, 3
  s_and_b32 s72, s72, 3
  s_mul_i32 s73, s72, 15360
  s_add_u32 s14, s73, 112640
  s_lshr_b32 s73, s72, 1
  s_mul_i32 s73, s73, 274432
  s_and_b32 s72, s72, 1
  s_lshl_b32 s72, s72, 8
  s_add_u32 s72, s72, s73
  s_add_u32 s72, s72, s82
  s_add_u32 s54, s72, s71
  s_add_u32 s72, s50, 4
  s_and_b32 s72, s72, 3
  s_lshr_b32 s73, s72, 1
  s_mul_i32 s73, s73, 274432
  s_and_b32 s72, s72, 1
  s_lshl_b32 s72, s72, 8
  s_add_u32 s72, s72, s73
  s_add_u32 s72, s72, s82
  s_add_u32 s55, s72, s71
  s_mul_i32 s73, s50, 15360
  s_add_u32 s15, s73, 102400
  s_waitcnt vmcnt(3)
  s_cmp_lg_u32 s51, 0
  s_cbranch_scc0 L_stw_42
  buffer_store_dwordx2 v[222:223], v14, s[36:39], 0 offen offset:0
L_ste_43:
  s_add_u32 s75, s62, 16384
  buffer_load_dwordx4 a[196:199], v2, s[36:39], s75 offen offset:0 sc1
  v_add_u32 v28, s12, v2
  v_add_u32 v29, s13, v2
  v_add_u32 v30, s14, v2
  v_add_u32 v31, s15, v2
  buffer_load_dwordx4 a[200:203], v2, s[36:39], s75 offen offset:1024 sc1
  v_lshrrev_b32 v16, 4, v1
  v_lshlrev_b32 v16, 9, v16
  v_and_b32 v17, 15, v1
  v_lshl_add_u32 v20, v17, 4, v16
  buffer_load_dwordx4 v2, s[36:39], s68 offen offset:2048 sc1 lds
  v_add_u32 v21, 4096, v20
  v_add_u32 v22, 8192, v20
  v_lshlrev_b32 v160, 16, v4
  v_and_b32 v161, s78, v4
  buffer_load_dwordx4 a[204:207], v2, s[36:39], s75 offen offset:2048 sc1
  v_lshlrev_b32 v162, 16, v5
  v_and_b32 v163, s78, v5
  v_lshlrev_b32 v164, 16, v6
  v_and_b32 v165, s78, v6
  buffer_load_dwordx4 a[208:211], v2, s[36:39], s75 offen offset:3072 sc1
  v_lshlrev_b32 v166, 16, v7
  v_and_b32 v167, s78, v7
  v_lshlrev_b32 v168, 16, v8
  v_and_b32 v169, s78, v8
  s_add_u32 s75, s62, 20480
  buffer_load_dwordx4 a[212:215], v2, s[36:39], s75 offen offset:0 sc1
  v_lshlrev_b32 v170, 16, v9
  v_and_b32 v171, s78, v9
  v_lshlrev_b32 v172, 16, v10
  v_and_b32 v173, s78, v10
  buffer_load_dwordx4 v2, s[36:39], s68 offen offset:3072 sc1 lds
  v_lshlrev_b32 v174, 16, v11
  v_and_b32 v175, s78, v11
  v_lshlrev_b32 v176, 16, v12
  v_and_b32 v177, s78, v12
  buffer_load_dwordx4 a[216:219], v2, s[36:39], s75 offen offset:1024 sc1
  v_lshlrev_b32 v178, 16, v13
  v_and_b32 v179, s78, v13
  s_mul_i32 s76, s83, 5120
  s_add_u32 s76, s76, 122880
  buffer_load_dwordx4 a[220:223], v2, s[36:39], s75 offen offset:2048 sc1
  s_add_u32 s76, s76, s55
  s_sub_u32 s76, s76, s71
  v_lshrrev_b32 v26, 5, v1
  v_lshlrev_b32 v26, 9, v26
  v_bfe_u32 v16, v1, 4, 1
  v_lshl_add_u32 v26, v16, 3, v26
  v_lshl_add_u32 v26, v17, 4, v26
  v_add_u32 v26, 4096, v26
  s_lshl_b32 s73, s48, 4
  s_lshr_b32 s74, s49, 3
  s_lshl_b32 s74, s74, 2
  s_add_u32 s73, s73, s74
  s_add_u32 s73, s73, s50
  s_lshl_b32 s73, s73, 10
  s_lshr_b32 s74, s83, 1
  s_lshl_b32 s74, s74, 8
  s_add_u32 s73, s73, s74
  s_and_b32 s74, s83, 1
  s_lshl_b32 s74, s74, 3
  s_add_u32 s73, s73, s74
  s_add_u32 s77, s73, 25559040
  v_mov_b32 v27, 2147483648
  v_cmp_gt_u32 vcc, 16, v1
  s_nop 1
  v_cndmask_b32 v27, v27, v2, vcc
  v_mov_b32 v24, 0
  v_mov_b32 v25, 0
  v_mov_b32 v23, 1065369472
  buffer_load_dwordx2 v[16:17], v18, s[36:39], 0 offen sc1
  buffer_load_dwordx4 a[224:227], v2, s[36:39], s75 offen offset:3072 sc1
  s_add_u32 m0, m0, 4096
  s_add_u32 s68, s68, 4096
  buffer_load_dwordx4 v2, s[36:39], s68 offen offset:0 sc1 lds
  s_add_u32 s75, s62, 24576
  buffer_load_dwordx4 a[228:231], v2, s[36:39], s75 offen offset:0 sc1
  buffer_load_dwordx4 v2, s[36:39], s68 offen offset:1024 sc1 lds
  buffer_load_dwordx4 v2, s[36:39], s68 offen offset:2048 sc1 lds
  s_add_u32 s68, s68, 3072
  buffer_load_dwordx4 v[224:227], v2, s[36:39], s68 offen offset:0 sc1
  s_waitcnt vmcnt(6)
  v_cmp_eq_u64 vcc, s[10:11], v[16:17]
  s_nop 1
  s_cmp_eq_u64 vcc, -1
  s_cbranch_scc0 L_ckr_44
L_ckb_45:
  buffer_load_dwordx4 v[32:35], v20, s[36:39], s52 offen offset:0 sc1
  buffer_load_dwordx4 v[36:39], v20, s[36:39], s52 offen offset:2048 sc1
  buffer_load_dwordx4 v[40:43], v21, s[36:39], s52 offen offset:0 sc1
  buffer_load_dwordx4 v[44:47], v21, s[36:39], s52 offen offset:2048 sc1
  buffer_load_dwordx4 v[48:51], v22, s[36:39], s52 offen offset:0 sc1
  buffer_load_dwordx4 v[52:55], v20, s[36:39], s53 offen offset:0 sc1
  buffer_load_dwordx4 v[56:59], v20, s[36:39], s53 offen offset:2048 sc1
  buffer_load_dwordx4 v[60:63], v21, s[36:39], s53 offen offset:0 sc1
  s_waitcnt vmcnt(7)
  v_mfma_f32_16x16x32_bf16 v[80:83], a[132:135], v[32:35], 0
  buffer_load_dwordx4 v[64:67], v21, s[36:39], s53 offen offset:2048 sc1
  v_mfma_f32_16x16x32_bf16 v[84:87], a[136:139], v[32:35], 0
  v_mfma_f32_16x16x32_bf16 v[88:91], a[140:143], v[32:35], 0
  v_mfma_f32_16x16x32_bf16 v[92:95], a[144:147], v[32:35], 0
  v_mfma_f32_16x16x32_bf16 v[96:99], a[148:151], v[32:35], 0
  s_waitcnt vmcnt(7)
  v_mfma_f32_16x16x32_bf16 v[80:83], a[152:155], v[36:39], v[80:83]
  buffer_load_dwordx4 v[68:71], v22, s[36:39], s53 offen offset:0 sc1
  v_mfma_f32_16x16x32_bf16 v[84:87], a[156:159], v[36:39], v[84:87]
  v_mfma_f32_16x16x32_bf16 v[88:91], a[160:163], v[36:39], v[88:91]
  v_mfma_f32_16x16x32_bf16 v[92:95], a[164:167], v[36:39], v[92:95]
  v_mfma_f32_16x16x32_bf16 v[96:99], a[168:171], v[36:39], v[96:99]
  s_waitcnt vmcnt(7)
  v_mfma_f32_16x16x32_bf16 v[80:83], a[172:175], v[40:43], v[80:83]
  buffer_load_dwordx4 v[72:75], v20, s[36:39], s54 offen offset:0 sc1
  v_mfma_f32_16x16x32_bf16 v[84:87], a[176:179], v[40:43], v[84:87]
  v_mfma_f32_16x16x32_bf16 v[88:91], a[180:183], v[40:43], v[88:91]
  v_mfma_f32_16x16x32_bf16 v[92:95], a[184:187], v[40:43], v[92:95]
  v_mfma_f32_16x16x32_bf16 v[96:99], a[188:191], v[40:43], v[96:99]
  s_waitcnt vmcnt(7)
  v_mfma_f32_16x16x32_bf16 v[80:83], a[192:195], v[44:47], v[80:83]
  buffer_load_dwordx4 v[76:79], v20, s[36:39], s54 offen offset:2048 sc1
  v_mfma_f32_16x16x32_bf16 v[84:87], a[196:199], v[44:47], v[84:87]
  v_mfma_f32_16x16x32_bf16 v[88:91], a[200:203], v[44:47], v[88:91]
  v_mfma_f32_16x16x32_bf16 v[92:95], a[204:207], v[44:47], v[92:95]
  v_mfma_f32_16x16x32_bf16 v[96:99], a[208:211], v[44:47], v[96:99]
  s_waitcnt vmcnt(7)
  v_mfma_f32_16x16x32_bf16 v[80:83], a[212:215], v[48:51], v[80:83]
  buffer_load_dwordx4 v[32:35], v21, s[36:39], s54 offen offset:0 sc1
  v_mfma_f32_16x16x32_bf16 v[84:87], a[216:219], v[48:51], v[84:87]
  v_mfma_f32_16x16x32_bf16 v[88:91], a[220:223], v[48:51], v[88:91]
  v_mfma_f32_16x16x32_bf16 v[92:95], a[224:227], v[48:51], v[92:95]
  v_mfma_f32_16x16x32_bf16 v[96:99], a[228:231], v[48:51], v[96:99]
  s_waitcnt vmcnt(7)
  v_mfma_f32_16x16x32_bf16 v[100:103], a[132:135], v[52:55], 0
  buffer_load_dwordx4 v[36:39], v21, s[36:39], s54 offen offset:2048 sc1
  v_mfma_f32_16x16x32_bf16 v[104:107], a[136:139], v[52:55], 0
  v_mfma_f32_16x16x32_bf16 v[108:111], a[140:143], v[52:55], 0
  ds_write_b128 v28, v[80:83] offset:0
  v_mfma_f32_16x16x32_bf16 v[112:115], a[144:147], v[52:55], 0
  v_mfma_f32_16x16x32_bf16 v[116:119], a[148:151], v[52:55], 0
  s_waitcnt vmcnt(7)
  v_mfma_f32_16x16x32_bf16 v[100:103], a[152:155], v[56:59], v[100:103]
  buffer_load_dwordx4 v[40:43], v22, s[36:39], s54 offen offset:0 sc1
  v_mfma_f32_16x16x32_bf16 v[104:107], a[156:159], v[56:59], v[104:107]
  v_mfma_f32_16x16x32_bf16 v[108:111], a[160:163], v[56:59], v[108:111]
  ds_write_b128 v28, v[84:87] offset:1024
  v_mfma_f32_16x16x32_bf16 v[112:115], a[164:167], v[56:59], v[112:115]
  v_mfma_f32_16x16x32_bf16 v[116:119], a[168:171], v[56:59], v[116:119]
  s_waitcnt vmcnt(7)
  v_mfma_f32_16x16x32_bf16 v[100:103], a[172:175], v[60:63], v[100:103]
  buffer_load_dwordx4 v[44:47], v20, s[36:39], s55 offen offset:0 sc1
  v_mfma_f32_16x16x32_bf16 v[104:107], a[176:179], v[60:63], v[104:107]
  v_mfma_f32_16x16x32_bf16 v[108:111], a[180:183], v[60:63], v[108:111]
  ds_write_b128 v28, v[88:91] offset:2048
  v_mfma_f32_16x16x32_bf16 v[112:115], a[184:187], v[60:63], v[112:115]
  v_mfma_f32_16x16x32_bf16 v[116:119], a[188:191], v[60:63], v[116:119]
  s_waitcnt vmcnt(7)
  v_mfma_f32_16x16x32_bf16 v[100:103], a[192:195], v[64:67], v[100:103]
  buffer_load_dwordx4 v[48:51], v20, s[36:39], s55 offen offset:2048 sc1
  v_mfma_f32_16x16x32_bf16 v[104:107], a[196:199], v[64:67], v[104:107]
  v_mfma_f32_16x16x32_bf16 v[108:111], a[200:203], v[64:67], v[108:111]
  ds_write_b128 v28, v[92:95] offset:3072
  v_mfma_f32_16x16x32_bf16 v[112:115], a[204:207], v[64:67], v[112:115]
  v_mfma_f32_16x16x32_bf16 v[116:119], a[208:211], v[64:67], v[116:119]
  s_waitcnt vmcnt(7)
  v_mfma_f32_16x16x32_bf16 v[100:103], a[212:215], v[68:71], v[100:103]
  buffer_load_dwordx4 v[52:55], v21, s[36:39], s55 offen offset:0 sc1
  v_mfma_f32_16x16x32_bf16 v[104:107], a[216:219], v[68:71], v[104:107]
  v_mfma_f32_16x16x32_bf16 v[108:111], a[220:223], v[68:71], v[108:111]
  ds_write_b128 v28, v[96:99] offset:4096
  v_mfma_f32_16x16x32_bf16 v[112:115], a[224:227], v[68:71], v[112:115]
  v_mfma_f32_16x16x32_bf16 v[116:119], a[228:231], v[68:71], v[116:119]
  s_waitcnt vmcnt(7)
  s_waitcnt lgkmcnt(0)
  s_barrier
  v_mfma_f32_16x16x32_bf16 v[120:123], a[132:135], v[72:75], 0
  buffer_load_dwordx4 v[56:59], v21, s[36:39], s55 offen offset:2048 sc1
  ds_read_b128 v[180:183], v31 offset:0
  v_mfma_f32_16x16x32_bf16 v[124:127], a[136:139], v[72:75], 0
  ds_read_b128 v[184:187], v31 offset:1024
  ds_read_b128 v[188:191], v31 offset:2048
  v_mfma_f32_16x16x32_bf16 v[128:131], a[140:143], v[72:75], 0
  ds_write_b128 v29, v[100:103] offset:0
  v_mfma_f32_16x16x32_bf16 v[132:135], a[144:147], v[72:75], 0
  ds_read_b128 v[192:195], v31 offset:3072
  ds_read_b128 v[196:199], v31 offset:4096
  v_mfma_f32_16x16x32_bf16 v[136:139], a[148:151], v[72:75], 0
  s_waitcnt vmcnt(7)
  v_mfma_f32_16x16x32_bf16 v[120:123], a[152:155], v[76:79], v[120:123]
  buffer_load_dwordx4 v[60:63], v22, s[36:39], s55 offen offset:0 sc1
  v_mfma_f32_16x16x32_bf16 v[124:127], a[156:159], v[76:79], v[124:127]
  s_waitcnt lgkmcnt(5)
  v_add_f32 v160, v160, v180
  v_mfma_f32_16x16x32_bf16 v[128:131], a[160:163], v[76:79], v[128:131]
  ds_write_b128 v29, v[104:107] offset:1024
  v_mfma_f32_16x16x32_bf16 v[132:135], a[164:167], v[76:79], v[132:135]
  v_add_f32 v161, v161, v181
  v_add_f32 v162, v162, v182
  v_mfma_f32_16x16x32_bf16 v[136:139], a[168:171], v[76:79], v[136:139]
  s_waitcnt vmcnt(7)
  v_add_f32 v163, v163, v183
  v_mfma_f32_16x16x32_bf16 v[120:123], a[172:175], v[32:35], v[120:123]
  buffer_load_dwordx4 v[228:231], v2, s[36:39], s68 offen offset:1024 sc1
  s_waitcnt lgkmcnt(5)
  v_add_f32 v164, v164, v184
  v_mfma_f32_16x16x32_bf16 v[124:127], a[176:179], v[32:35], v[124:127]
  v_add_f32 v165, v165, v185
  v_add_f32 v166, v166, v186
  v_mfma_f32_16x16x32_bf16 v[128:131], a[180:183], v[32:35], v[128:131]
  ds_write_b128 v29, v[108:111] offset:2048
  v_mfma_f32_16x16x32_bf16 v[132:135], a[184:187], v[32:35], v[132:135]
  buffer_load_dwordx4 v[232:235], v2, s[36:39], s68 offen offset:2048 sc1
  v_add_f32 v167, v167, v187
  v_mfma_f32_16x16x32_bf16 v[136:139], a[188:191], v[32:35], v[136:139]
  s_waitcnt vmcnt(8)
  s_waitcnt lgkmcnt(5)
  v_add_f32 v168, v168, v188
  v_mfma_f32_16x16x32_bf16 v[120:123], a[192:195], v[36:39], v[120:123]
  buffer_load_dwordx4 v[236:239], v2, s[36:39], s68 offen offset:3072 sc1
  v_add_f32 v169, v169, v189
  v_mfma_f32_16x16x32_bf16 v[124:127], a[196:199], v[36:39], v[124:127]
  v_add_f32 v170, v170, v190
  v_add_f32 v171, v171, v191
  v_mfma_f32_16x16x32_bf16 v[128:131], a[200:203], v[36:39], v[128:131]
  ds_write_b128 v29, v[112:115] offset:3072
  v_mfma_f32_16x16x32_bf16 v[132:135], a[204:207], v[36:39], v[132:135]
  s_add_u32 s68, s44, 0
  buffer_load_dwordx4 v[240:243], v2, s[36:39], s68 offen offset:0 sc1
  v_mfma_f32_16x16x32_bf16 v[136:139], a[208:211], v[36:39], v[136:139]
  s_waitcnt vmcnt(9)
  s_waitcnt lgkmcnt(4)
  v_add_f32 v172, v172, v192
  v_mfma_f32_16x16x32_bf16 v[120:123], a[212:215], v[40:43], v[120:123]
  buffer_load_dwordx4 v[244:247], v2, s[36:39], s68 offen offset:1024 sc1
  v_add_f32 v173, v173, v193
  v_mfma_f32_16x16x32_bf16 v[124:127], a[216:219], v[40:43], v[124:127]
  v_add_f32 v174, v174, v194
  v_add_f32 v175, v175, v195
  v_mfma_f32_16x16x32_bf16 v[128:131], a[220:223], v[40:43], v[128:131]
  ds_write_b128 v29, v[116:119] offset:4096
  v_mfma_f32_16x16x32_bf16 v[132:135], a[224:227], v[40:43], v[132:135]
  buffer_load_dwordx4 v[248:251], v2, s[36:39], s68 offen offset:2048 sc1
  s_waitcnt lgkmcnt(4)
  v_add_f32 v176, v176, v196
  v_mfma_f32_16x16x32_bf16 v[136:139], a[228:231], v[40:43], v[136:139]
  s_waitcnt vmcnt(10)
  v_add_f32 v177, v177, v197
  s_waitcnt lgkmcnt(0)
  s_barrier
  v_mfma_f32_16x16x32_bf16 v[140:143], a[132:135], v[44:47], 0
  s_add_u32 s68, s44, 21504
  buffer_load_dwordx4 a[232:235], v2, s[36:39], s68 offen offset:0 sc1
  v_mfma_f32_16x16x32_bf16 v[144:147], a[136:139], v[44:47], 0
  v_add_f32 v178, v178, v198
  v_add_f32 v179, v179, v199
  v_mfma_f32_16x16x32_bf16 v[148:151], a[140:143], v[44:47], 0
  ds_write_b128 v30, v[120:123] offset:0
  v_mfma_f32_16x16x32_bf16 v[152:155], a[144:147], v[44:47], 0
  buffer_load_dwordx4 a[236:239], v2, s[36:39], s68 offen offset:1024 sc1
  ds_read_b128 v[200:203], v31 offset:5120
  v_mfma_f32_16x16x32_bf16 v[156:159], a[148:151], v[44:47], 0
  s_waitcnt vmcnt(11)
  ds_read_b128 v[204:207], v31 offset:6144
  v_mfma_f32_16x16x32_bf16 v[140:143], a[152:155], v[48:51], v[140:143]
  ds_write_b128 v30, v[124:127] offset:1024
  v_mfma_f32_16x16x32_bf16 v[144:147], a[156:159], v[48:51], v[144:147]
  buffer_load_dwordx4 a[240:243], v2, s[36:39], s68 offen offset:2048 sc1
  ds_read_b128 v[208:211], v31 offset:7168
  v_mfma_f32_16x16x32_bf16 v[148:151], a[160:163], v[48:51], v[148:151]
  ds_read_b128 v[212:215], v31 offset:8192
  ds_read_b128 v[216:219], v31 offset:9216
  v_mfma_f32_16x16x32_bf16 v[152:155], a[164:167], v[48:51], v[152:155]
  ds_write_b128 v30, v[128:131] offset:2048
  v_mfma_f32_16x16x32_bf16 v[156:159], a[168:171], v[48:51], v[156:159]
  s_waitcnt vmcnt(11)
  s_add_u32 s68, s44, 43008
  buffer_load_dwordx4 a[244:247], v2, s[36:39], s68 offen offset:0 sc1
  v_mfma_f32_16x16x32_bf16 v[140:143], a[172:175], v[52:55], v[140:143]
  buffer_load_dwordx4 a[248:251], v2, s[36:39], s68 offen offset:1024 sc1
  v_mfma_f32_16x16x32_bf16 v[144:147], a[176:179], v[52:55], v[144:147]
  ds_write_b128 v30, v[132:135] offset:3072
  v_mfma_f32_16x16x32_bf16 v[148:151], a[180:183], v[52:55], v[148:151]
  s_waitcnt lgkmcnt(7)
  v_add_f32 v160, v160, v200
  v_mfma_f32_16x16x32_bf16 v[152:155], a[184:187], v[52:55], v[152:155]
  buffer_load_dwordx4 a[252:255], v2, s[36:39], s68 offen offset:2048 sc1
  v_add_f32 v161, v161, v201
  v_mfma_f32_16x16x32_bf16 v[156:159], a[188:191], v[52:55], v[156:159]
  s_waitcnt vmcnt(13)
  ds_write_b128 v30, v[136:139] offset:4096
  v_mfma_f32_16x16x32_bf16 v[140:143], a[192:195], v[56:59], v[140:143]
  v_add_f32 v162, v162, v202
  v_add_f32 v163, v163, v203
  v_mfma_f32_16x16x32_bf16 v[144:147], a[196:199], v[56:59], v[144:147]
  s_waitcnt lgkmcnt(7)
  v_add_f32 v164, v164, v204
  v_mfma_f32_16x16x32_bf16 v[148:151], a[200:203], v[56:59], v[148:151]
  s_waitcnt lgkmcnt(0)
  s_barrier
  ds_read_b128 v[180:183], v31 offset:10240
  ds_read_b128 v[184:187], v31 offset:11264
  ds_read_b128 v[188:191], v31 offset:12288
  ds_read_b128 v[192:195], v31 offset:13312
  ds_read_b128 v[196:199], v31 offset:14336
  v_mfma_f32_16x16x32_bf16 v[152:155], a[204:207], v[56:59], v[152:155]
  v_add_f32 v165, v165, v205
  v_add_f32 v166, v166, v206
  v_mfma_f32_16x16x32_bf16 v[156:159], a[208:211], v[56:59], v[156:159]
  s_waitcnt vmcnt(12)
  v_add_f32 v167, v167, v207
  v_mfma_f32_16x16x32_bf16 v[140:143], a[212:215], v[60:63], v[140:143]
  v_add_f32 v168, v168, v208
  v_add_f32 v169, v169, v209
  v_mfma_f32_16x16x32_bf16 v[144:147], a[216:219], v[60:63], v[144:147]
  v_add_f32 v170, v170, v210
  v_add_f32 v171, v171, v211
  v_mfma_f32_16x16x32_bf16 v[148:151], a[220:223], v[60:63], v[148:151]
  v_add_f32 v172, v172, v212
  v_add_f32 v173, v173, v213
  v_mfma_f32_16x16x32_bf16 v[152:155], a[224:227], v[60:63], v[152:155]
  v_add_f32 v174, v174, v214
  v_add_f32 v175, v175, v215
  v_mfma_f32_16x16x32_bf16 v[156:159], a[228:231], v[60:63], v[156:159]
  v_add_f32 v176, v176, v216
  v_add_f32 v177, v177, v217
  v_add_f32 v178, v178, v218
  v_add_f32 v179, v179, v219
  s_waitcnt lgkmcnt(4)
  v_pk_add_f32 v[140:141], v[140:141], v[180:181]
  v_pk_add_f32 v[142:143], v[142:143], v[182:183]
  s_waitcnt lgkmcnt(3)
  v_pk_add_f32 v[144:145], v[144:145], v[184:185]
  v_pk_add_f32 v[146:147], v[146:147], v[186:187]
  s_waitcnt lgkmcnt(2)
L_tc1_1:
  s_cbranch_execz L_tr1
  v_pk_add_f32 v[148:149], v[148:149], v[188:189]
  v_pk_add_f32 v[150:151], v[150:151], v[190:191]
  s_waitcnt lgkmcnt(1)
  v_pk_add_f32 v[152:153], v[152:153], v[192:193]
  v_pk_add_f32 v[154:155], v[154:155], v[194:195]
  s_waitcnt lgkmcnt(0)
  v_pk_add_f32 v[156:157], v[156:157], v[196:197]
  v_pk_add_f32 v[158:159], v[158:159], v[198:199]
  v_pk_add_f32 v[140:141], v[140:141], v[160:161]
  v_pk_add_f32 v[142:143], v[142:143], v[162:163]
  v_pk_add_f32 v[144:145], v[144:145], v[164:165]
  v_pk_add_f32 v[146:147], v[146:147], v[166:167]
  v_pk_add_f32 v[148:149], v[148:149], v[168:169]
  v_pk_add_f32 v[150:151], v[150:151], v[170:171]
  v_pk_add_f32 v[152:153], v[152:153], v[172:173]
  v_pk_add_f32 v[154:155], v[154:155], v[174:175]
  v_pk_add_f32 v[156:157], v[156:157], v[176:177]
  v_pk_add_f32 v[158:159], v[158:159], v[178:179]
  v_cvt_pk_bf16_f32 v4, v140, v141
  v_cvt_pk_bf16_f32 v5, v142, v143
  v_cvt_pk_bf16_f32 v6, v144, v145
  v_cvt_pk_bf16_f32 v7, v146, v147
  v_cvt_pk_bf16_f32 v8, v148, v149
  v_cvt_pk_bf16_f32 v9, v150, v151
  v_cvt_pk_bf16_f32 v10, v152, v153
  v_cvt_pk_bf16_f32 v11, v154, v155
  v_cvt_pk_bf16_f32 v12, v156, v157
  v_cvt_pk_bf16_f32 v13, v158, v159
  s_cmp_lg_u32 s51, 0
  s_cbranch_scc0 L_stw_46
  buffer_store_dwordx4 v[4:7], v20, s[36:39], s76 offen offset:0
  buffer_store_dwordx4 v[8:11], v20, s[36:39], s76 offen offset:2048
  buffer_store_dwordx2 v[12:13], v26, s[36:39], s76 offen offset:0
L_ste_47:
  v_dot2c_f32_bf16 v24, v4, v23
  v_dot2c_f32_bf16 v25, v4, v4
  v_dot2c_f32_bf16 v24, v5, v23
  v_dot2c_f32_bf16 v25, v5, v5
  v_dot2c_f32_bf16 v24, v6, v23
  v_dot2c_f32_bf16 v25, v6, v6
  v_dot2c_f32_bf16 v24, v7, v23
  v_dot2c_f32_bf16 v25, v7, v7
  v_dot2c_f32_bf16 v24, v8, v23
  v_dot2c_f32_bf16 v25, v8, v8
  v_dot2c_f32_bf16 v24, v9, v23
  v_dot2c_f32_bf16 v25, v9, v9
  v_dot2c_f32_bf16 v24, v10, v23
  v_dot2c_f32_bf16 v25, v10, v10
  v_dot2c_f32_bf16 v24, v11, v23
  v_dot2c_f32_bf16 v25, v11, v11
  v_dot2c_f32_bf16 v24, v12, v23
  v_dot2c_f32_bf16 v25, v12, v12
  v_dot2c_f32_bf16 v24, v13, v23
  v_dot2c_f32_bf16 v25, v13, v13
  s_nop 2
  v_permlane32_swap_b32 v24, v25
  v_add_f32 v24, v24, v25
  v_mov_b32 v25, v24
  s_nop 1
  v_permlane16_swap_b32 v24, v25
  v_add_f32 v24, v24, v25
  v_mov_b32 v25, v24
  s_nop 1
  v_permlane32_swap_b32 v24, v25
  s_cmp_lg_u32 s51, 0
  s_cbranch_scc0 L_stw_48
  buffer_store_dwordx2 v[24:25], v27, s[36:39], s77 offen offset:0
L_ste_49:
  s_add_u32 s75, s64, 0
  buffer_load_dwordx4 a[0:3], v2, s[36:39], s75 offen offset:0 sc1
  buffer_load_dwordx4 a[4:7], v2, s[36:39], s75 offen offset:1024 sc1
  buffer_load_dwordx4 a[8:11], v2, s[36:39], s75 offen offset:2048 sc1
  buffer_load_dwordx4 a[12:15], v2, s[36:39], s75 offen offset:3072 sc1
  s_add_u32 s75, s64, 4096
  buffer_load_dwordx4 a[16:19], v2, s[36:39], s75 offen offset:0 sc1
  buffer_load_dwordx4 a[20:23], v2, s[36:39], s75 offen offset:1024 sc1
  s_add_u32 s72, s79, 102400
  v_add_u32 v15, s72, v2
  s_add_u32 s72, s45, 118784
  v_add_u32 v3, s72, v2
  v_mov_b32 v254, v20
  v_add_u32 v252, 57344, v2
  v_add_u32 v253, 114688, v2
  s_lshl_b32 s72, s48, 3
  s_lshr_b32 s73, s49, 4
  s_lshl_b32 s73, s73, 2
  s_add_u32 s72, s72, s73
  s_add_u32 s74, s72, s50
  s_mul_i32 s72, s74, 274432
  s_add_u32 s52, s72, 122880
  s_add_u32 s53, s72, 126976
  s_add_u32 s54, s72, 131072
  s_add_u32 s55, s72, 135168
  s_add_u32 s56, s72, 139264
  s_add_u32 s57, s72, 143360
  s_add_u32 s58, s72, 147456
  s_add_u32 s59, s72, 151552
  s_add_u32 s60, s72, 155648
  s_add_u32 s61, s72, 159744
  s_and_b32 s73, s49, 16
  s_lshr_b32 s7, s50, 1
  s_lshl_b32 s7, s7, 3
  s_add_u32 s73, s73, s7
  v_and_b32 v144, 7, v1
  v_add_u32 v144, s73, v144
  v_lshlrev_b32 v144, 3, v144
  v_add_u32 v144, s48, v144
  s_and_b32 s73, s50, 1
  s_lshl_b32 s73, s73, 4
  s_add_u32 s73, s73, 25755648
  v_and_b32 v145, 8, v1
  v_lshl_add_u32 v144, v144, 7, v145
  v_add_u32 v146, s73, v144
  s_waitcnt vmcnt(6)
  s_cmp_lg_u32 s51, 0
  s_cbranch_scc0 L_stw_50
  buffer_store_dwordx2 v[222:223], v14, s[36:39], 0 offen offset:32
L_ste_51:
  buffer_load_dwordx4 a[24:27], v2, s[36:39], s75 offen offset:2048 sc1
  buffer_load_dwordx4 a[28:31], v2, s[36:39], s75 offen offset:3072 sc1
  s_add_u32 s75, s64, 8192
  buffer_load_dwordx4 a[32:35], v2, s[36:39], s75 offen offset:0 sc1
  buffer_load_dwordx4 a[36:39], v2, s[36:39], s75 offen offset:1024 sc1
  s_add_u32 s75, s64, 24576
  buffer_load_dwordx4 a[40:43], v2, s[36:39], s75 offen offset:1024 sc1
  buffer_load_dwordx4 a[44:47], v2, s[36:39], s75 offen offset:2048 sc1
  s_barrier
  ds_write_b128 v3, a[232:235] offset:11264
  s_lshl_b32 s73, s74, 11
  s_add_u32 s76, s73, 25559040
  s_add_u32 s72, s72, 163840
  s_lshl_b32 s73, s63, 10
  ds_write_b128 v3, a[236:239] offset:12288
  s_add_u32 s71, s73, s72
  s_lshl_b32 s73, s69, 10
  s_add_u32 s77, s73, s72
  s_and_b32 s73, s49, 16
  ds_write_b128 v3, a[240:243] offset:13312
  s_lshl_b32 s74, s50, 2
  s_add_u32 s73, s73, s74
  v_and_b32 v144, 3, v1
  v_add_u32 v144, s73, v144
  ds_write_b128 v3, a[244:247] offset:22528
  v_lshlrev_b32 v144, 3, v144
  v_add_u32 v144, s48, v144
  s_and_b32 s73, s49, 8
  s_lshl_b32 s73, s73, 1
  ds_write_b128 v3, a[248:251] offset:23552
  s_add_u32 s73, s73, 25755648
  v_and_b32 v145, 8, v1
  v_lshl_add_u32 v144, v144, 7, v145
  v_add_u32 v220, s73, v144
  ds_write_b128 v3, a[252:255] offset:24576
  ds_read_b128 v[192:195], v252 offset:8192
  ds_read_b128 v[196:199], v252 offset:13312
  ds_read_b128 v[200:203], v252 offset:18432
  ds_read_b128 v[204:207], v252 offset:23552
  ds_read_b128 v[208:211], v252 offset:9216
  ds_read_b128 v[212:215], v252 offset:14336
  s_mov_b32 s80, 65536
L_poll_52:
  buffer_load_dwordx2 v[148:149], v146, s[36:39], 0 offen offset:32 sc1
  s_waitcnt vmcnt(0)
  v_cmp_eq_u64 vcc, s[10:11], v[148:149]
  s_nop 1
  s_cmp_eq_u64 vcc, -1
  s_cbranch_scc1 L_polld_53
  s_sub_u32 s80, s80, 1
  s_cmp_lg_u32 s80, 0
  s_cbranch_scc1 L_poll_52
L_polld_53:
  buffer_load_dwordx4 a[224:227], v254, s[36:39], s52 offen offset:0 sc1
  buffer_load_dwordx4 a[228:231], v254, s[36:39], s52 offen offset:256 sc1
  buffer_load_dwordx4 a[232:235], v254, s[36:39], s52 offen offset:2048 sc1
  buffer_load_dwordx4 a[236:239], v254, s[36:39], s52 offen offset:2304 sc1
  buffer_load_dwordx4 a[240:243], v254, s[36:39], s53 offen offset:0 sc1
  buffer_load_dwordx4 a[244:247], v254, s[36:39], s53 offen offset:256 sc1
  buffer_load_dwordx4 a[248:251], v254, s[36:39], s53 offen offset:2048 sc1
  buffer_load_dwordx4 a[252:255], v254, s[36:39], s53 offen offset:2304 sc1
  s_cmp_lg_u32 s50, 3
  s_cselect_b64 vcc, -1, 0
  s_waitcnt vmcnt(7) lgkmcnt(5)
  v_mfma_f32_16x16x32_bf16 v[152:155], v[192:195], a[224:227], 0
  ds_read_b128 v[216:219], v252 offset:19456
  buffer_load_dwordx4 v[16:19], v254, s[36:39], s54 offen offset:0 sc1
  s_waitcnt vmcnt(7)
  v_mfma_f32_16x16x32_bf16 v[156:159], v[192:195], a[228:231], 0
  ds_write_b128 v15, v[224:227] offset:0
  s_waitcnt lgkmcnt(6)
  v_mfma_f32_16x16x32_bf16 v[160:163], v[196:199], a[224:227], 0
  ds_read_b128 v[192:195], v252 offset:24576
  v_mfma_f32_16x16x32_bf16 v[164:167], v[196:199], a[228:231], 0
  s_waitcnt lgkmcnt(5)
  v_mfma_f32_16x16x32_bf16 v[168:171], v[200:203], a[224:227], 0
  ds_read_b128 v[196:199], v252 offset:10240
  buffer_load_dwordx4 v[20:23], v254, s[36:39], s54 offen offset:256 sc1
  v_mfma_f32_16x16x32_bf16 v[172:175], v[200:203], a[228:231], 0
  ds_write_b128 v15, v[228:231] offset:1024
  v_mfma_f32_16x16x32_bf16 v[176:179], v[204:207], a[224:227], 0
  ds_read_b128 v[200:203], v252 offset:15360
  v_mfma_f32_16x16x32_bf16 v[180:183], v[204:207], a[228:231], 0
  s_waitcnt vmcnt(6) lgkmcnt(6)
  v_mfma_f32_16x16x32_bf16 v[152:155], v[208:211], a[232:235], v[152:155]
  ds_read_b128 v[204:207], v252 offset:20480
  buffer_load_dwordx4 v[24:27], v254, s[36:39], s54 offen offset:2048 sc1
  v_mfma_f32_16x16x32_bf16 v[156:159], v[208:211], a[236:239], v[156:159]
  ds_write_b128 v15, v[232:235] offset:2048
  v_mfma_f32_16x16x32_bf16 v[160:163], v[212:215], a[232:235], v[160:163]
  ds_read_b128 v[208:211], v252 offset:25600
  v_mfma_f32_16x16x32_bf16 v[164:167], v[212:215], a[236:239], v[164:167]
  s_waitcnt lgkmcnt(6)
  v_mfma_f32_16x16x32_bf16 v[168:171], v[216:219], a[232:235], v[168:171]
  ds_read_b128 v[212:215], v252 offset:11264
  buffer_load_dwordx4 v[28:31], v254, s[36:39], s54 offen offset:2304 sc1
  v_mfma_f32_16x16x32_bf16 v[172:175], v[216:219], a[236:239], v[172:175]
  ds_write_b128 v15, v[236:239] offset:3072
  v_mfma_f32_16x16x32_bf16 v[176:179], v[192:195], a[232:235], v[176:179]
  ds_read_b128 v[216:219], v252 offset:16384
  v_mfma_f32_16x16x32_bf16 v[180:183], v[192:195], a[236:239], v[180:183]
  s_waitcnt vmcnt(6) lgkmcnt(6)
  v_mfma_f32_16x16x32_bf16 v[152:155], v[196:199], a[240:243], v[152:155]
  ds_read_b128 v[192:195], v252 offset:21504
  buffer_load_dwordx4 v[32:35], v254, s[36:39], s55 offen offset:0 sc1
  v_mfma_f32_16x16x32_bf16 v[156:159], v[196:199], a[244:247], v[156:159]
  ds_write_b128 v3, v[240:243] offset:0
  v_mfma_f32_16x16x32_bf16 v[160:163], v[200:203], a[240:243], v[160:163]
  ds_read_b128 v[196:199], v252 offset:26624
  v_mfma_f32_16x16x32_bf16 v[164:167], v[200:203], a[244:247], v[164:167]
  s_waitcnt lgkmcnt(6)
  v_mfma_f32_16x16x32_bf16 v[168:171], v[204:207], a[240:243], v[168:171]
  ds_read_b128 v[200:203], v252 offset:12288
  buffer_load_dwordx4 v[36:39], v254, s[36:39], s55 offen offset:256 sc1
  v_mfma_f32_16x16x32_bf16 v[172:175], v[204:207], a[244:247], v[172:175]
  ds_write_b128 v3, v[244:247] offset:1024
  v_mfma_f32_16x16x32_bf16 v[176:179], v[208:211], a[240:243], v[176:179]
  ds_read_b128 v[204:207], v252 offset:17408
  v_mfma_f32_16x16x32_bf16 v[180:183], v[208:211], a[244:247], v[180:183]
  s_waitcnt vmcnt(6) lgkmcnt(6)
  v_mfma_f32_16x16x32_bf16 v[152:155], v[212:215], a[248:251], v[152:155]
  ds_read_b128 v[208:211], v252 offset:22528
  buffer_load_dwordx4 v[40:43], v254, s[36:39], s55 offen offset:2048 sc1
  v_mfma_f32_16x16x32_bf16 v[156:159], v[212:215], a[252:255], v[156:159]
  ds_write_b128 v3, v[248:251] offset:2048
  v_mfma_f32_16x16x32_bf16 v[160:163], v[216:219], a[248:251], v[160:163]
  ds_read_b128 v[212:215], v252 offset:27648
  v_mfma_f32_16x16x32_bf16 v[164:167], v[216:219], a[252:255], v[164:167]
  s_waitcnt lgkmcnt(6)
  v_mfma_f32_16x16x32_bf16 v[168:171], v[192:195], a[248:251], v[168:171]
  ds_read_b128 v[216:219], v2 offset:0
  buffer_load_dwordx4 v[44:47], v254, s[36:39], s55 offen offset:2304 sc1
  v_mfma_f32_16x16x32_bf16 v[172:175], v[192:195], a[252:255], v[172:175]
  v_mfma_f32_16x16x32_bf16 v[176:179], v[196:199], a[248:251], v[176:179]
  ds_read_b128 v[192:195], v2 offset:5120
  v_mfma_f32_16x16x32_bf16 v[180:183], v[196:199], a[252:255], v[180:183]
  s_waitcnt vmcnt(6) lgkmcnt(5)
  v_mfma_f32_16x16x32_bf16 v[152:155], v[200:203], v[16:19], v[152:155]
  ds_read_b128 v[196:199], v2 offset:10240
  buffer_load_dwordx4 v[48:51], v254, s[36:39], s56 offen offset:0 sc1
  v_mfma_f32_16x16x32_bf16 v[156:159], v[200:203], v[20:23], v[156:159]
  v_mfma_f32_16x16x32_bf16 v[160:163], v[204:207], v[16:19], v[160:163]
  ds_read_b128 v[200:203], v2 offset:15360
  v_mfma_f32_16x16x32_bf16 v[164:167], v[204:207], v[20:23], v[164:167]
  s_waitcnt lgkmcnt(4)
  v_mfma_f32_16x16x32_bf16 v[168:171], v[208:211], v[16:19], v[168:171]
  ds_read_b128 v[204:207], v2 offset:1024
  buffer_load_dwordx4 v[52:55], v254, s[36:39], s56 offen offset:256 sc1
  v_mfma_f32_16x16x32_bf16 v[172:175], v[208:211], v[20:23], v[172:175]
  v_mfma_f32_16x16x32_bf16 v[176:179], v[212:215], v[16:19], v[176:179]
  ds_read_b128 v[208:211], v2 offset:6144
  v_mfma_f32_16x16x32_bf16 v[180:183], v[212:215], v[20:23], v[180:183]
  s_waitcnt vmcnt(6) lgkmcnt(4)
  v_mfma_f32_16x16x32_bf16 v[152:155], v[216:219], v[24:27], v[152:155]
  ds_read_b128 v[212:215], v2 offset:11264
  buffer_load_dwordx4 v[56:59], v254, s[36:39], s56 offen offset:2048 sc1
  v_mfma_f32_16x16x32_bf16 v[156:159], v[216:219], v[28:31], v[156:159]
  v_mfma_f32_16x16x32_bf16 v[160:163], v[192:195], v[24:27], v[160:163]
  ds_read_b128 v[216:219], v2 offset:16384
  v_mfma_f32_16x16x32_bf16 v[164:167], v[192:195], v[28:31], v[164:167]
  s_waitcnt lgkmcnt(4)
  v_mfma_f32_16x16x32_bf16 v[168:171], v[196:199], v[24:27], v[168:171]
  ds_read_b128 v[192:195], v2 offset:2048
  buffer_load_dwordx4 v[60:63], v254, s[36:39], s56 offen offset:2304 sc1
  v_mfma_f32_16x16x32_bf16 v[172:175], v[196:199], v[28:31], v[172:175]
  v_mfma_f32_16x16x32_bf16 v[176:179], v[200:203], v[24:27], v[176:179]
  ds_read_b128 v[196:199], v2 offset:7168
  v_mfma_f32_16x16x32_bf16 v[180:183], v[200:203], v[28:31], v[180:183]
  s_waitcnt vmcnt(6) lgkmcnt(4)
  v_mfma_f32_16x16x32_bf16 v[152:155], v[204:207], v[32:35], v[152:155]
  ds_read_b128 v[200:203], v2 offset:12288
  buffer_load_dwordx4 v[64:67], v254, s[36:39], s57 offen offset:0 sc1
  v_mfma_f32_16x16x32_bf16 v[156:159], v[204:207], v[36:39], v[156:159]
  v_mfma_f32_16x16x32_bf16 v[160:163], v[208:211], v[32:35], v[160:163]
  ds_read_b128 v[204:207], v2 offset:17408
  buffer_load_dwordx4 v[224:227], v2, s[36:39], s76 offen offset:0 sc1
  v_mfma_f32_16x16x32_bf16 v[164:167], v[208:211], v[36:39], v[164:167]
  s_waitcnt lgkmcnt(4)
  v_mfma_f32_16x16x32_bf16 v[168:171], v[212:215], v[32:35], v[168:171]
  ds_read_b128 v[208:211], v2 offset:3072
  buffer_load_dwordx4 v[68:71], v254, s[36:39], s57 offen offset:256 sc1
  v_mfma_f32_16x16x32_bf16 v[172:175], v[212:215], v[36:39], v[172:175]
  v_mfma_f32_16x16x32_bf16 v[176:179], v[216:219], v[32:35], v[176:179]
  ds_read_b128 v[212:215], v2 offset:8192
  buffer_load_dwordx4 v[228:231], v2, s[36:39], s76 offen offset:1024 sc1
  v_mfma_f32_16x16x32_bf16 v[180:183], v[216:219], v[36:39], v[180:183]
  s_waitcnt vmcnt(8) lgkmcnt(4)
  v_mfma_f32_16x16x32_bf16 v[152:155], v[192:195], v[40:43], v[152:155]
  ds_read_b128 v[216:219], v2 offset:13312
  buffer_load_dwordx4 v[72:75], v254, s[36:39], s57 offen offset:2048 sc1
  v_mfma_f32_16x16x32_bf16 v[156:159], v[192:195], v[44:47], v[156:159]
  v_mfma_f32_16x16x32_bf16 v[160:163], v[196:199], v[40:43], v[160:163]
  ds_read_b128 v[192:195], v2 offset:18432
  v_mfma_f32_16x16x32_bf16 v[164:167], v[196:199], v[44:47], v[164:167]
  s_waitcnt lgkmcnt(4)
  v_mfma_f32_16x16x32_bf16 v[168:171], v[200:203], v[40:43], v[168:171]
  ds_read_b128 v[196:199], v2 offset:4096
  buffer_load_dwordx4 v[76:79], v254, s[36:39], s57 offen offset:2304 sc1
  v_mfma_f32_16x16x32_bf16 v[172:175], v[200:203], v[44:47], v[172:175]
  v_mfma_f32_16x16x32_bf16 v[176:179], v[204:207], v[40:43], v[176:179]
  ds_read_b128 v[200:203], v2 offset:9216
  v_mfma_f32_16x16x32_bf16 v[180:183], v[204:207], v[44:47], v[180:183]
  s_waitcnt vmcnt(8) lgkmcnt(4)
  v_mfma_f32_16x16x32_bf16 v[152:155], v[208:211], v[48:51], v[152:155]
  ds_read_b128 v[204:207], v2 offset:14336
  buffer_load_dwordx4 v[80:83], v254, s[36:39], s58 offen offset:0 sc1
  v_mfma_f32_16x16x32_bf16 v[156:159], v[208:211], v[52:55], v[156:159]
  v_mfma_f32_16x16x32_bf16 v[160:163], v[212:215], v[48:51], v[160:163]
  ds_read_b128 v[208:211], v2 offset:19456
  v_mfma_f32_16x16x32_bf16 v[164:167], v[212:215], v[52:55], v[164:167]
  s_waitcnt lgkmcnt(4)
  s_barrier
  v_mfma_f32_16x16x32_bf16 v[168:171], v[216:219], v[48:51], v[168:171]
  ds_read_b128 v[212:215], v2 offset:35840
  buffer_load_dwordx4 v[84:87], v254, s[36:39], s58 offen offset:256 sc1
  v_mfma_f32_16x16x32_bf16 v[172:175], v[216:219], v[52:55], v[172:175]
  v_mfma_f32_16x16x32_bf16 v[176:179], v[192:195], v[48:51], v[176:179]
  ds_read_b128 v[216:219], v2 offset:43008
  v_mfma_f32_16x16x32_bf16 v[180:183], v[192:195], v[52:55], v[180:183]
  s_waitcnt vmcnt(8) lgkmcnt(4)
  v_mfma_f32_16x16x32_bf16 v[152:155], v[196:199], v[56:59], v[152:155]
  ds_read_b128 v[192:195], v2 offset:50176
  buffer_load_dwordx4 v[88:91], v254, s[36:39], s58 offen offset:2048 sc1
  v_mfma_f32_16x16x32_bf16 v[156:159], v[196:199], v[60:63], v[156:159]
  s_waitcnt vmcnt(7)
  v_add_f32 v224, v224, v226
  v_mfma_f32_16x16x32_bf16 v[160:163], v[200:203], v[56:59], v[160:163]
  ds_read_b128 v[196:199], v252 offset:0
  v_add_f32 v225, v225, v227
  v_mfma_f32_16x16x32_bf16 v[164:167], v[200:203], v[60:63], v[164:167]
  s_waitcnt lgkmcnt(4)
  s_waitcnt vmcnt(5)
  v_add_f32 v228, v228, v230
  v_mfma_f32_16x16x32_bf16 v[168:171], v[204:207], v[56:59], v[168:171]
  ds_read_b128 v[200:203], v2 offset:36864
  buffer_load_dwordx4 v[92:95], v254, s[36:39], s58 offen offset:2304 sc1
  v_mfma_f32_16x16x32_bf16 v[172:175], v[204:207], v[60:63], v[172:175]
  v_add_f32 v229, v229, v231
  v_mov_b32 v226, v224
  v_mfma_f32_16x16x32_bf16 v[176:179], v[208:211], v[56:59], v[176:179]
  ds_read_b128 v[204:207], v2 offset:44032
  v_mov_b32 v227, v225
  v_mfma_f32_16x16x32_bf16 v[180:183], v[208:211], v[60:63], v[180:183]
  s_waitcnt lgkmcnt(4)
  v_mov_b32 v230, v228
  v_mfma_f32_16x16x32_bf16 v[152:155], v[212:215], v[64:67], v[152:155]
  ds_read_b128 v[208:211], v2 offset:51200
  buffer_load_dwordx4 v[96:99], v254, s[36:39], s59 offen offset:0 sc1
  v_mfma_f32_16x16x32_bf16 v[156:159], v[212:215], v[68:71], v[156:159]
  v_mov_b32 v231, v229
  v_mfma_f32_16x16x32_bf16 v[160:163], v[216:219], v[64:67], v[160:163]
  ds_read_b128 v[212:215], v252 offset:1024
  v_mfma_f32_16x16x32_bf16 v[164:167], v[216:219], v[68:71], v[164:167]
  s_waitcnt lgkmcnt(4)
  v_mfma_f32_16x16x32_bf16 v[168:171], v[192:195], v[64:67], v[168:171]
  ds_read_b128 v[216:219], v2 offset:37888
  buffer_load_dwordx4 v[100:103], v254, s[36:39], s59 offen offset:256 sc1
  v_mfma_f32_16x16x32_bf16 v[172:175], v[192:195], v[68:71], v[172:175]
  v_permlane16_swap_b32 v224, v226
  v_mfma_f32_16x16x32_bf16 v[176:179], v[196:199], v[64:67], v[176:179]
  ds_read_b128 v[192:195], v2 offset:45056
  v_mfma_f32_16x16x32_bf16 v[180:183], v[196:199], v[68:71], v[180:183]
  s_waitcnt vmcnt(6) lgkmcnt(4)
  v_mfma_f32_16x16x32_bf16 v[152:155], v[200:203], v[72:75], v[152:155]
  ds_read_b128 v[196:199], v2 offset:52224
  buffer_load_dwordx4 v[104:107], v254, s[36:39], s59 offen offset:2048 sc1
  v_mfma_f32_16x16x32_bf16 v[156:159], v[200:203], v[76:79], v[156:159]
  v_permlane16_swap_b32 v225, v227
  v_mfma_f32_16x16x32_bf16 v[160:163], v[204:207], v[72:75], v[160:163]
  ds_read_b128 v[200:203], v252 offset:2048
  v_mfma_f32_16x16x32_bf16 v[164:167], v[204:207], v[76:79], v[164:167]
  s_waitcnt lgkmcnt(4)
  v_mfma_f32_16x16x32_bf16 v[168:171], v[208:211], v[72:75], v[168:171]
  ds_read_b128 v[204:207], v2 offset:38912
  buffer_load_dwordx4 v[108:111], v254, s[36:39], s59 offen offset:2304 sc1
  v_mfma_f32_16x16x32_bf16 v[172:175], v[208:211], v[76:79], v[172:175]
  v_permlane16_swap_b32 v228, v230
  v_mfma_f32_16x16x32_bf16 v[176:179], v[212:215], v[72:75], v[176:179]
  ds_read_b128 v[208:211], v2 offset:46080
  v_mfma_f32_16x16x32_bf16 v[180:183], v[212:215], v[76:79], v[180:183]
  s_waitcnt vmcnt(6) lgkmcnt(4)
  v_mfma_f32_16x16x32_bf16 v[152:155], v[216:219], v[80:83], v[152:155]
  ds_read_b128 v[212:215], v2 offset:53248
  buffer_load_dwordx4 v[112:115], v254, s[36:39], s60 offen offset:0 sc1
  v_mfma_f32_16x16x32_bf16 v[156:159], v[216:219], v[84:87], v[156:159]
  v_permlane16_swap_b32 v229, v231
  v_mfma_f32_16x16x32_bf16 v[160:163], v[192:195], v[80:83], v[160:163]
  ds_read_b128 v[216:219], v252 offset:3072
  v_add_f32 v224, v224, v226
  v_mfma_f32_16x16x32_bf16 v[164:167], v[192:195], v[84:87], v[164:167]
  s_waitcnt lgkmcnt(4)
  v_add_f32 v225, v225, v227
  v_mfma_f32_16x16x32_bf16 v[168:171], v[196:199], v[80:83], v[168:171]
  ds_read_b128 v[192:195], v2 offset:39936
  buffer_load_dwordx4 v[116:119], v254, s[36:39], s60 offen offset:256 sc1
  v_mfma_f32_16x16x32_bf16 v[172:175], v[196:199], v[84:87], v[172:175]
  v_add_f32 v228, v228, v230
  v_add_f32 v229, v229, v231
  v_mfma_f32_16x16x32_bf16 v[176:179], v[200:203], v[80:83], v[176:179]
  ds_read_b128 v[196:199], v2 offset:47104
  v_mov_b32 v226, v224
  v_mfma_f32_16x16x32_bf16 v[180:183], v[200:203], v[84:87], v[180:183]
  s_waitcnt vmcnt(6) lgkmcnt(4)
  v_mov_b32 v227, v225
  v_mfma_f32_16x16x32_bf16 v[152:155], v[204:207], v[88:91], v[152:155]
  ds_read_b128 v[200:203], v2 offset:54272
  buffer_load_dwordx4 v[120:123], v254, s[36:39], s60 offen offset:2048 sc1
  v_mfma_f32_16x16x32_bf16 v[156:159], v[204:207], v[92:95], v[156:159]
  v_mov_b32 v230, v228
  v_mov_b32 v231, v229
  v_mfma_f32_16x16x32_bf16 v[160:163], v[208:211], v[88:91], v[160:163]
  ds_read_b128 v[204:207], v252 offset:4096
  v_mfma_f32_16x16x32_bf16 v[164:167], v[208:211], v[92:95], v[164:167]
  s_waitcnt lgkmcnt(4)
  v_mfma_f32_16x16x32_bf16 v[168:171], v[212:215], v[88:91], v[168:171]
  ds_read_b128 v[208:211], v2 offset:40960
  buffer_load_dwordx4 v[124:127], v254, s[36:39], s60 offen offset:2304 sc1
  v_mfma_f32_16x16x32_bf16 v[172:175], v[212:215], v[92:95], v[172:175]
  v_permlane32_swap_b32 v224, v226
  v_mfma_f32_16x16x32_bf16 v[176:179], v[216:219], v[88:91], v[176:179]
  ds_read_b128 v[212:215], v2 offset:48128
  v_mfma_f32_16x16x32_bf16 v[180:183], v[216:219], v[92:95], v[180:183]
  s_waitcnt vmcnt(6) lgkmcnt(4)
  v_mfma_f32_16x16x32_bf16 v[152:155], v[192:195], v[96:99], v[152:155]
  ds_read_b128 v[216:219], v2 offset:55296
  buffer_load_dwordx4 v[128:131], v254, s[36:39], s61 offen offset:0 sc1
  v_mfma_f32_16x16x32_bf16 v[156:159], v[192:195], v[100:103], v[156:159]
  v_permlane32_swap_b32 v225, v227
  v_mfma_f32_16x16x32_bf16 v[160:163], v[196:199], v[96:99], v[160:163]
  ds_read_b128 v[192:195], v252 offset:5120
  v_mfma_f32_16x16x32_bf16 v[164:167], v[196:199], v[100:103], v[164:167]
  s_waitcnt lgkmcnt(4)
  v_mfma_f32_16x16x32_bf16 v[168:171], v[200:203], v[96:99], v[168:171]
  ds_read_b128 v[196:199], v2 offset:41984
  buffer_load_dwordx4 v[132:135], v254, s[36:39], s61 offen offset:256 sc1
  v_mfma_f32_16x16x32_bf16 v[172:175], v[200:203], v[100:103], v[172:175]
  v_permlane32_swap_b32 v228, v230
  v_mfma_f32_16x16x32_bf16 v[176:179], v[204:207], v[96:99], v[176:179]
  ds_read_b128 v[200:203], v2 offset:49152
  v_mfma_f32_16x16x32_bf16 v[180:183], v[204:207], v[100:103], v[180:183]
  s_waitcnt vmcnt(6) lgkmcnt(4)
  v_mfma_f32_16x16x32_bf16 v[152:155], v[208:211], v[104:107], v[152:155]
  ds_read_b128 v[204:207], v2 offset:56320
  buffer_load_dwordx4 v[136:139], v254, s[36:39], s61 offen offset:2048 sc1
  v_mfma_f32_16x16x32_bf16 v[156:159], v[208:211], v[108:111], v[156:159]
  v_permlane32_swap_b32 v229, v231
  v_mfma_f32_16x16x32_bf16 v[160:163], v[212:215], v[104:107], v[160:163]
  ds_read_b128 v[208:211], v252 offset:6144
  v_add_f32 v224, v224, v226
  v_mfma_f32_16x16x32_bf16 v[164:167], v[212:215], v[108:111], v[164:167]
  s_waitcnt lgkmcnt(4)
  v_add_f32 v225, v225, v227
  v_mfma_f32_16x16x32_bf16 v[168:171], v[216:219], v[104:107], v[168:171]
  ds_read_b128 v[212:215], v252 offset:45056
  buffer_load_dwordx4 v[140:143], v254, s[36:39], s61 offen offset:2304 sc1
  v_mfma_f32_16x16x32_bf16 v[172:175], v[216:219], v[108:111], v[172:175]
  v_add_f32 v228, v228, v230
  v_add_f32 v229, v229, v231
  v_mfma_f32_16x16x32_bf16 v[176:179], v[192:195], v[104:107], v[176:179]
  ds_read_b128 v[216:219], v252 offset:49152
  v_mul_f32 v224, 3133983949, v224
  v_mfma_f32_16x16x32_bf16 v[180:183], v[192:195], v[108:111], v[180:183]
  s_waitcnt vmcnt(6) lgkmcnt(4)
  v_mul_f32 v225, 986500301, v225
  v_mfma_f32_16x16x32_bf16 v[152:155], v[196:199], v[112:115], v[152:155]
  ds_read_b128 v[192:195], v252 offset:53248
  buffer_load_dwordx4 a[48:51], v2, s[36:39], s75 offen offset:3072 sc1
  v_mfma_f32_16x16x32_bf16 v[156:159], v[196:199], v[116:119], v[156:159]
  v_fma_f32 v225, -v224, v224, v225
  v_max_f32 v225, 0, v225
  v_mfma_f32_16x16x32_bf16 v[160:163], v[200:203], v[112:115], v[160:163]
  ds_read_b128 v[196:199], v253 offset:0
  v_add_f32 v225, 925353388, v225
  v_mfma_f32_16x16x32_bf16 v[164:167], v[200:203], v[116:119], v[164:167]
  s_waitcnt lgkmcnt(4)
  v_mfma_f32_16x16x32_bf16 v[168:171], v[204:207], v[112:115], v[168:171]
  ds_read_b128 v[200:203], v252 offset:46080
  s_add_u32 s75, s64, 28672
  buffer_load_dwordx4 a[52:55], v2, s[36:39], s75 offen offset:0 sc1
  v_mfma_f32_16x16x32_bf16 v[172:175], v[204:207], v[116:119], v[172:175]
  v_rsq_f32 v225, v225
  v_mfma_f32_16x16x32_bf16 v[176:179], v[208:211], v[112:115], v[176:179]
  ds_read_b128 v[204:207], v252 offset:50176
  v_cvt_pk_bf16_f32 v144, v224, v224
  v_mfma_f32_16x16x32_bf16 v[180:183], v[208:211], v[116:119], v[180:183]
  s_waitcnt vmcnt(6) lgkmcnt(4)
  v_mul_f32 v248, 3216550459, v225
  v_mfma_f32_16x16x32_bf16 v[152:155], v[212:215], v[120:123], v[152:155]
  ds_read_b128 v[208:211], v252 offset:54272
  buffer_load_dwordx4 a[56:59], v2, s[36:39], s75 offen offset:1024 sc1
  v_mfma_f32_16x16x32_bf16 v[156:159], v[212:215], v[124:127], v[156:159]
  v_and_b32 v226, s78, v144
  v_sub_f32 v226, v224, v226
  v_mfma_f32_16x16x32_bf16 v[160:163], v[216:219], v[120:123], v[160:163]
  ds_read_b128 v[212:215], v253 offset:1024
  v_mov_b32 v146, 0
  v_mfma_f32_16x16x32_bf16 v[164:167], v[216:219], v[124:127], v[164:167]
  s_waitcnt lgkmcnt(4)
  v_mov_b32 v147, 0
  v_mfma_f32_16x16x32_bf16 v[168:171], v[192:195], v[120:123], v[168:171]
  ds_read_b128 v[216:219], v252 offset:47104
  buffer_load_dwordx4 a[60:63], v2, s[36:39], s75 offen offset:2048 sc1
  v_mfma_f32_16x16x32_bf16 v[172:175], v[192:195], v[124:127], v[172:175]
  v_cvt_pk_bf16_f32 v145, v226, v146
  v_mul_f32 v228, 3133983949, v228
  v_mfma_f32_16x16x32_bf16 v[176:179], v[196:199], v[120:123], v[176:179]
  ds_read_b128 v[192:195], v252 offset:51200
  v_mul_f32 v229, 986500301, v229
  v_mfma_f32_16x16x32_bf16 v[180:183], v[196:199], v[124:127], v[180:183]
  s_waitcnt vmcnt(6) lgkmcnt(4)
  v_fma_f32 v229, -v228, v228, v229
  v_mfma_f32_16x16x32_bf16 v[152:155], v[200:203], v[128:131], v[152:155]
  ds_read_b128 v[196:199], v252 offset:55296
  buffer_load_dwordx4 a[64:67], v2, s[36:39], s75 offen offset:3072 sc1
  v_mfma_f32_16x16x32_bf16 v[156:159], v[200:203], v[132:135], v[156:159]
  v_max_f32 v229, 0, v229
  v_add_f32 v229, 925353388, v229
  v_mfma_f32_16x16x32_bf16 v[160:163], v[204:207], v[128:131], v[160:163]
  ds_read_b128 v[200:203], v253 offset:2048
  v_mfma_f32_16x16x32_bf16 v[164:167], v[204:207], v[132:135], v[164:167]
  s_waitcnt lgkmcnt(4)
  v_mfma_f32_16x16x32_bf16 v[168:171], v[208:211], v[128:131], v[168:171]
  ds_read_b128 v[204:207], v252 offset:48128
  s_add_u32 s75, s64, 32768
  buffer_load_dwordx4 a[68:71], v2, s[36:39], s75 offen offset:0 sc1
  v_mfma_f32_16x16x32_bf16 v[172:175], v[208:211], v[132:135], v[172:175]
  v_rsq_f32 v229, v229
  v_mfma_f32_16x16x32_bf16 v[176:179], v[212:215], v[128:131], v[176:179]
  ds_read_b128 v[208:211], v252 offset:52224
  v_cvt_pk_bf16_f32 v148, v228, v228
  v_mfma_f32_16x16x32_bf16 v[180:183], v[212:215], v[132:135], v[180:183]
  s_waitcnt vmcnt(6) lgkmcnt(4)
  v_mul_f32 v249, 3216550459, v229
  v_mfma_f32_16x16x32_bf16 v[152:155], v[216:219], v[136:139], v[152:155]
  ds_read_b128 v[212:215], v252 offset:56320
  buffer_load_dwordx4 a[72:75], v2, s[36:39], s75 offen offset:1024 sc1
  v_mfma_f32_16x16x32_bf16 v[156:159], v[216:219], v[140:143], v[156:159]
  v_and_b32 v230, s78, v148
  v_sub_f32 v230, v228, v230
  v_mfma_f32_16x16x32_bf16 v[160:163], v[192:195], v[136:139], v[160:163]
  ds_read_b128 v[216:219], v253 offset:3072
  v_mov_b32 v150, 0
  v_mfma_f32_16x16x32_bf16 v[164:167], v[192:195], v[140:143], v[164:167]
  s_waitcnt lgkmcnt(4)
  v_mov_b32 v151, 0
  v_mfma_f32_16x16x32_bf16 v[168:171], v[196:199], v[136:139], v[168:171]
  ds_read_b128 v[192:195], v252 offset:28672
  buffer_load_dwordx4 a[76:79], v2, s[36:39], s75 offen offset:2048 sc1
  v_mfma_f32_16x16x32_bf16 v[172:175], v[196:199], v[140:143], v[172:175]
  v_cvt_pk_bf16_f32 v149, v230, v150
  v_mfma_f32_16x16x32_bf16 v[176:179], v[200:203], v[136:139], v[176:179]
  ds_read_b128 v[196:199], v252 offset:29696
  v_mfma_f32_16x16x32_bf16 v[180:183], v[200:203], v[140:143], v[180:183]
  s_waitcnt lgkmcnt(4)
  v_mfma_f32_16x16x32_bf16 v[152:155], v[204:207], v[144:147], v[152:155]
  ds_read_b128 v[200:203], v252 offset:30720
  buffer_load_dwordx4 a[80:83], v2, s[36:39], s75 offen offset:3072 sc1
  v_mfma_f32_16x16x32_bf16 v[156:159], v[204:207], v[148:151], v[156:159]
  v_mfma_f32_16x16x32_bf16 v[160:163], v[208:211], v[144:147], v[160:163]
  ds_read_b128 v[204:207], v252 offset:31744
  v_mfma_f32_16x16x32_bf16 v[164:167], v[208:211], v[148:151], v[164:167]
  s_waitcnt lgkmcnt(4)
  v_mfma_f32_16x16x32_bf16 v[168:171], v[212:215], v[144:147], v[168:171]
  ds_read_b128 v[208:211], v252 offset:32768
  s_add_u32 s75, s64, 36864
  buffer_load_dwordx4 a[84:87], v2, s[36:39], s75 offen offset:0 sc1
  v_mfma_f32_16x16x32_bf16 v[172:175], v[212:215], v[148:151], v[172:175]
  v_mfma_f32_16x16x32_bf16 v[176:179], v[216:219], v[144:147], v[176:179]
  ds_read_b128 v[212:215], v2 offset:20480
  v_mfma_f32_16x16x32_bf16 v[180:183], v[216:219], v[148:151], v[180:183]
  s_waitcnt lgkmcnt(4)
  v_mfma_f32_16x16x32_bf16 v[184:187], v[192:195], a[224:227], 0
  ds_read_b128 v[216:219], v2 offset:21504
  buffer_load_dwordx4 a[88:91], v2, s[36:39], s75 offen offset:1024 sc1
  v_mfma_f32_16x16x32_bf16 v[188:191], v[192:195], a[228:231], 0
  v_mfma_f32_16x16x32_bf16 v[184:187], v[196:199], a[232:235], v[184:187]
  ds_read_b128 v[192:195], v2 offset:22528
  v_mul_f32 v152, v152, v248
  v_mul_f32 v153, v153, v248
  v_mul_f32 v154, v154, v248
  v_mul_f32 v155, v155, v248
  v_exp_f32 v232, v152
  v_mfma_f32_16x16x32_bf16 v[188:191], v[196:199], a[236:239], v[188:191]
  s_waitcnt lgkmcnt(4)
  v_exp_f32 v233, v153
  v_exp_f32 v234, v154
  v_exp_f32 v235, v155
  v_add_f32 v232, 1.0, v232
  v_mfma_f32_16x16x32_bf16 v[184:187], v[200:203], a[240:243], v[184:187]
  ds_read_b128 v[196:199], v2 offset:23552
  buffer_load_dwordx4 a[92:95], v2, s[36:39], s75 offen offset:2048 sc1
L_tc1_2:
  s_cbranch_execz L_tr1
  v_add_f32 v233, 1.0, v233
  v_add_f32 v234, 1.0, v234
  v_add_f32 v235, 1.0, v235
  v_rcp_f32 v232, v232
  v_mfma_f32_16x16x32_bf16 v[188:191], v[200:203], a[244:247], v[188:191]
  v_rcp_f32 v233, v233
  v_rcp_f32 v234, v234
  v_rcp_f32 v235, v235
  v_mul_f32 v232, v152, v232
  v_mul_f32 v233, v153, v233
  v_mfma_f32_16x16x32_bf16 v[184:187], v[204:207], a[248:251], v[184:187]
  ds_read_b128 v[200:203], v2 offset:24576
  v_mul_f32 v234, v154, v234
  v_mul_f32 v235, v155, v235
  v_cvt_pk_bf16_f32 v240, v232, v233
  v_cvt_pk_bf16_f32 v241, v234, v235
  v_mul_f32 v156, v156, v249
  v_mul_f32 v157, v157, v249
  v_mul_f32 v158, v158, v249
  v_mfma_f32_16x16x32_bf16 v[188:191], v[204:207], a[252:255], v[188:191]
  s_waitcnt lgkmcnt(4)
  v_mul_f32 v159, v159, v249
  v_exp_f32 v236, v156
  v_exp_f32 v237, v157
  v_exp_f32 v238, v158
  v_mfma_f32_16x16x32_bf16 v[184:187], v[208:211], v[16:19], v[184:187]
  ds_read_b128 v[204:207], v253 offset:4096
  buffer_load_dwordx4 a[96:99], v2, s[36:39], s75 offen offset:3072 sc1
  v_exp_f32 v239, v159
  v_add_f32 v236, 1.0, v236
  v_add_f32 v237, 1.0, v237
  v_add_f32 v238, 1.0, v238
  v_add_f32 v239, 1.0, v239
  v_mfma_f32_16x16x32_bf16 v[188:191], v[208:211], v[20:23], v[188:191]
  v_rcp_f32 v236, v236
  v_rcp_f32 v237, v237
  v_rcp_f32 v238, v238
  v_rcp_f32 v239, v239
  v_mfma_f32_16x16x32_bf16 v[184:187], v[212:215], v[24:27], v[184:187]
  ds_read_b128 v[208:211], v253 offset:5120
  v_mul_f32 v236, v156, v236
  v_mul_f32 v237, v157, v237
  v_mul_f32 v238, v158, v238
  v_mul_f32 v239, v159, v239
  v_cvt_pk_bf16_f32 v242, v236, v237
  v_cvt_pk_bf16_f32 v243, v238, v239
  v_mfma_f32_16x16x32_bf16 v[188:191], v[212:215], v[28:31], v[188:191]
  s_waitcnt lgkmcnt(4)
  v_permlane16_swap_b32 v240, v242
  v_permlane16_swap_b32 v241, v243
  buffer_store_dwordx4 v[240:243], v2, s[36:39], s71 offen offset:0 sc1
  v_mfma_f32_16x16x32_bf16 v[184:187], v[216:219], v[32:35], v[184:187]
  ds_read_b128 v[212:215], v253 offset:6144
  s_add_u32 s75, s64, 40960
  buffer_load_dwordx4 a[100:103], v2, s[36:39], s75 offen offset:0 sc1
  v_mul_f32 v160, v160, v248
  v_mul_f32 v161, v161, v248
  v_mul_f32 v162, v162, v248
  v_mul_f32 v163, v163, v248
  v_mfma_f32_16x16x32_bf16 v[188:191], v[216:219], v[36:39], v[188:191]
  v_exp_f32 v232, v160
  v_exp_f32 v233, v161
  v_exp_f32 v234, v162
  v_exp_f32 v235, v163
  v_mfma_f32_16x16x32_bf16 v[184:187], v[192:195], v[40:43], v[184:187]
  ds_read_b128 v[216:219], v253 offset:7168
  v_add_f32 v232, 1.0, v232
  v_add_f32 v233, 1.0, v233
  v_add_f32 v234, 1.0, v234
  v_add_f32 v235, 1.0, v235
  v_rcp_f32 v232, v232
  v_mfma_f32_16x16x32_bf16 v[188:191], v[192:195], v[44:47], v[188:191]
  s_waitcnt lgkmcnt(4)
  v_rcp_f32 v233, v233
  v_rcp_f32 v234, v234
  v_rcp_f32 v235, v235
  v_mul_f32 v232, v160, v232
  v_mfma_f32_16x16x32_bf16 v[184:187], v[196:199], v[48:51], v[184:187]
  ds_read_b128 v[192:195], v253 offset:8192
  buffer_load_dwordx4 a[104:107], v2, s[36:39], s75 offen offset:1024 sc1
  v_mul_f32 v233, v161, v233
  v_mul_f32 v234, v162, v234
  v_mul_f32 v235, v163, v235
  v_cvt_pk_bf16_f32 v244, v232, v233
  v_cvt_pk_bf16_f32 v245, v234, v235
  v_mul_f32 v164, v164, v249
  v_mfma_f32_16x16x32_bf16 v[188:191], v[196:199], v[52:55], v[188:191]
  v_mul_f32 v165, v165, v249
  v_mul_f32 v166, v166, v249
  v_mul_f32 v167, v167, v249
  v_exp_f32 v236, v164
  v_exp_f32 v237, v165
  v_mfma_f32_16x16x32_bf16 v[184:187], v[200:203], v[56:59], v[184:187]
  ds_read_b128 v[196:199], v253 offset:9216
  v_exp_f32 v238, v166
  v_exp_f32 v239, v167
  v_add_f32 v236, 1.0, v236
  v_add_f32 v237, 1.0, v237
  v_add_f32 v238, 1.0, v238
  v_mfma_f32_16x16x32_bf16 v[188:191], v[200:203], v[60:63], v[188:191]
  s_waitcnt lgkmcnt(4)
  v_add_f32 v239, 1.0, v239
  v_rcp_f32 v236, v236
  v_rcp_f32 v237, v237
  v_rcp_f32 v238, v238
  v_mfma_f32_16x16x32_bf16 v[184:187], v[204:207], v[64:67], v[184:187]
  ds_read_b128 v[200:203], v253 offset:10240
  buffer_load_dwordx4 a[108:111], v2, s[36:39], s75 offen offset:2048 sc1
  v_rcp_f32 v239, v239
  v_mul_f32 v236, v164, v236
  v_mul_f32 v237, v165, v237
  v_mul_f32 v238, v166, v238
  v_mul_f32 v239, v167, v239
  v_mfma_f32_16x16x32_bf16 v[188:191], v[204:207], v[68:71], v[188:191]
  v_cvt_pk_bf16_f32 v246, v236, v237
  v_cvt_pk_bf16_f32 v247, v238, v239
  v_mfma_f32_16x16x32_bf16 v[184:187], v[208:211], v[72:75], v[184:187]
  ds_read_b128 v[204:207], v253 offset:11264
  v_permlane16_swap_b32 v244, v246
  v_permlane16_swap_b32 v245, v247
  buffer_store_dwordx4 v[244:247], v2, s[36:39], s71 offen offset:1024 sc1
  v_mfma_f32_16x16x32_bf16 v[188:191], v[208:211], v[76:79], v[188:191]
  s_waitcnt lgkmcnt(4)
  v_mul_f32 v168, v168, v248
  v_mul_f32 v169, v169, v248
  v_mul_f32 v170, v170, v248
  v_mul_f32 v171, v171, v248
  v_exp_f32 v232, v168
  v_mfma_f32_16x16x32_bf16 v[184:187], v[212:215], v[80:83], v[184:187]
  ds_read_b128 v[208:211], v253 offset:12288
  buffer_load_dwordx4 a[112:115], v2, s[36:39], s75 offen offset:3072 sc1
  v_exp_f32 v233, v169
  v_exp_f32 v234, v170
  v_exp_f32 v235, v171
  v_mfma_f32_16x16x32_bf16 v[188:191], v[212:215], v[84:87], v[188:191]
  v_add_f32 v232, 1.0, v232
  v_add_f32 v233, 1.0, v233
  v_add_f32 v234, 1.0, v234
  v_add_f32 v235, 1.0, v235
  v_rcp_f32 v232, v232
  v_rcp_f32 v233, v233
  v_mfma_f32_16x16x32_bf16 v[184:187], v[216:219], v[88:91], v[184:187]
  ds_read_b128 v[212:215], v253 offset:13312
  v_rcp_f32 v234, v234
  v_rcp_f32 v235, v235
  v_mul_f32 v232, v168, v232
  v_mul_f32 v233, v169, v233
  v_mul_f32 v234, v170, v234
  v_mfma_f32_16x16x32_bf16 v[188:191], v[216:219], v[92:95], v[188:191]
  s_waitcnt lgkmcnt(4)
  v_mul_f32 v235, v171, v235
  v_cvt_pk_bf16_f32 v240, v232, v233
  v_cvt_pk_bf16_f32 v241, v234, v235
  v_mul_f32 v172, v172, v249
  v_mul_f32 v173, v173, v249
  v_mul_f32 v174, v174, v249
  v_mul_f32 v175, v175, v249
  v_mfma_f32_16x16x32_bf16 v[184:187], v[192:195], v[96:99], v[184:187]
  ds_read_b128 v[216:219], v253 offset:14336
  s_add_u32 s75, s64, 45056
  buffer_load_dwordx4 a[116:119], v2, s[36:39], s75 offen offset:0 sc1
  v_exp_f32 v236, v172
  v_exp_f32 v237, v173
  v_mfma_f32_16x16x32_bf16 v[188:191], v[192:195], v[100:103], v[188:191]
  v_exp_f32 v238, v174
  v_exp_f32 v239, v175
  v_add_f32 v236, 1.0, v236
  v_add_f32 v237, 1.0, v237
  v_add_f32 v238, 1.0, v238
  v_add_f32 v239, 1.0, v239
  v_mfma_f32_16x16x32_bf16 v[184:187], v[196:199], v[104:107], v[184:187]
  ds_read_b128 v[192:195], v252 offset:33792
  v_rcp_f32 v236, v236
  v_rcp_f32 v237, v237
  v_rcp_f32 v238, v238
  v_mfma_f32_16x16x32_bf16 v[188:191], v[196:199], v[108:111], v[188:191]
  s_waitcnt lgkmcnt(4)
  v_rcp_f32 v239, v239
  v_mul_f32 v236, v172, v236
  v_mul_f32 v237, v173, v237
  v_mul_f32 v238, v174, v238
  v_mul_f32 v239, v175, v239
  v_cvt_pk_bf16_f32 v242, v236, v237
  v_mfma_f32_16x16x32_bf16 v[184:187], v[200:203], v[112:115], v[184:187]
  ds_read_b128 v[196:199], v252 offset:34816
  s_add_u32 s75, s65, 61440
  buffer_load_dwordx4 a[120:123], v2, s[36:39], s75 offen offset:0 sc1
  v_cvt_pk_bf16_f32 v243, v238, v239
  v_mfma_f32_16x16x32_bf16 v[188:191], v[200:203], v[116:119], v[188:191]
  v_permlane16_swap_b32 v240, v242
  v_permlane16_swap_b32 v241, v243
  buffer_store_dwordx4 v[240:243], v2, s[36:39], s71 offen offset:2048 sc1
  v_mul_f32 v176, v176, v248
  v_mfma_f32_16x16x32_bf16 v[184:187], v[204:207], v[120:123], v[184:187]
  ds_read_b128 v[200:203], v252 offset:35840
  v_mul_f32 v177, v177, v248
  v_mul_f32 v178, v178, v248
  v_mul_f32 v179, v179, v248
  v_exp_f32 v232, v176
  v_exp_f32 v233, v177
  v_mfma_f32_16x16x32_bf16 v[188:191], v[204:207], v[124:127], v[188:191]
  s_waitcnt lgkmcnt(4)
  v_exp_f32 v234, v178
  v_exp_f32 v235, v179
  v_add_f32 v232, 1.0, v232
  v_add_f32 v233, 1.0, v233
  v_add_f32 v234, 1.0, v234
  v_mfma_f32_16x16x32_bf16 v[184:187], v[208:211], v[128:131], v[184:187]
  ds_read_b128 v[204:207], v252 offset:36864
  buffer_load_dwordx4 a[124:127], v2, s[36:39], s75 offen offset:1024 sc1
  v_add_f32 v235, 1.0, v235
  v_rcp_f32 v232, v232
  v_rcp_f32 v233, v233
  v_mfma_f32_16x16x32_bf16 v[188:191], v[208:211], v[132:135], v[188:191]
  v_rcp_f32 v234, v234
  v_rcp_f32 v235, v235
  v_mul_f32 v232, v176, v232
  v_mul_f32 v233, v177, v233
  v_mul_f32 v234, v178, v234
  v_mul_f32 v235, v179, v235
  v_mfma_f32_16x16x32_bf16 v[184:187], v[212:215], v[136:139], v[184:187]
  ds_read_b128 v[208:211], v252 offset:37888
  v_cvt_pk_bf16_f32 v244, v232, v233
  v_cvt_pk_bf16_f32 v245, v234, v235
  v_mul_f32 v180, v180, v249
  v_mul_f32 v181, v181, v249
  v_mul_f32 v182, v182, v249
  v_mul_f32 v183, v183, v249
  v_mfma_f32_16x16x32_bf16 v[188:191], v[212:215], v[140:143], v[188:191]
  s_waitcnt lgkmcnt(4)
  v_exp_f32 v236, v180
  v_exp_f32 v237, v181
  v_exp_f32 v238, v182
  v_mfma_f32_16x16x32_bf16 v[184:187], v[216:219], v[144:147], v[184:187]
  ds_read_b128 v[212:215], v2 offset:25600
  buffer_load_dwordx4 a[128:131], v2, s[36:39], s75 offen offset:2048 sc1
  v_exp_f32 v239, v183
  v_add_f32 v236, 1.0, v236
  v_add_f32 v237, 1.0, v237
  v_add_f32 v238, 1.0, v238
  v_add_f32 v239, 1.0, v239
  v_mfma_f32_16x16x32_bf16 v[188:191], v[216:219], v[148:151], v[188:191]
  v_rcp_f32 v236, v236
  v_rcp_f32 v237, v237
  v_rcp_f32 v238, v238
  v_rcp_f32 v239, v239
  v_mfma_f32_16x16x32_bf16 v[152:155], v[192:195], a[224:227], 0
  ds_read_b128 v[216:219], v2 offset:26624
  v_mul_f32 v236, v180, v236
  v_mul_f32 v237, v181, v237
  v_mul_f32 v238, v182, v238
  v_mul_f32 v239, v183, v239
  v_cvt_pk_bf16_f32 v246, v236, v237
  v_cvt_pk_bf16_f32 v247, v238, v239
  v_mfma_f32_16x16x32_bf16 v[156:159], v[192:195], a[228:231], 0
  s_waitcnt lgkmcnt(4)
  v_permlane16_swap_b32 v244, v246
  v_permlane16_swap_b32 v245, v247
  buffer_store_dwordx4 v[244:247], v2, s[36:39], s71 offen offset:3072 sc1
  v_mfma_f32_16x16x32_bf16 v[152:155], v[196:199], a[232:235], v[152:155]
  ds_read_b128 v[192:195], v2 offset:27648
  buffer_load_dwordx4 a[132:135], v2, s[36:39], s75 offen offset:3072 sc1
  v_mfma_f32_16x16x32_bf16 v[156:159], v[196:199], a[236:239], v[156:159]
  v_mfma_f32_16x16x32_bf16 v[152:155], v[200:203], a[240:243], v[152:155]
  ds_read_b128 v[196:199], v2 offset:28672
  v_mul_f32 v184, v184, v248
  v_mul_f32 v185, v185, v248
  v_mfma_f32_16x16x32_bf16 v[156:159], v[200:203], a[244:247], v[156:159]
  s_waitcnt lgkmcnt(4)
  v_mul_f32 v186, v186, v248
  v_mul_f32 v187, v187, v248
  v_mfma_f32_16x16x32_bf16 v[152:155], v[204:207], a[248:251], v[152:155]
  ds_read_b128 v[200:203], v2 offset:29696
  s_add_u32 s75, s65, 65536
  buffer_load_dwordx4 a[136:139], v2, s[36:39], s75 offen offset:0 sc1
  v_mfma_f32_16x16x32_bf16 v[156:159], v[204:207], a[252:255], v[156:159]
  v_exp_f32 v232, v184
  v_mfma_f32_16x16x32_bf16 v[152:155], v[208:211], v[16:19], v[152:155]
  ds_read_b128 v[204:207], v253 offset:15360
  v_exp_f32 v233, v185
  v_mfma_f32_16x16x32_bf16 v[156:159], v[208:211], v[20:23], v[156:159]
  s_waitcnt lgkmcnt(4)
  v_exp_f32 v234, v186
  v_mfma_f32_16x16x32_bf16 v[152:155], v[212:215], v[24:27], v[152:155]
  ds_read_b128 v[208:211], v253 offset:16384
  buffer_load_dwordx4 a[140:143], v2, s[36:39], s75 offen offset:1024 sc1
  v_mfma_f32_16x16x32_bf16 v[156:159], v[212:215], v[28:31], v[156:159]
  v_exp_f32 v235, v187
  v_add_f32 v232, 1.0, v232
  v_mfma_f32_16x16x32_bf16 v[152:155], v[216:219], v[32:35], v[152:155]
  ds_read_b128 v[212:215], v253 offset:17408
  v_add_f32 v233, 1.0, v233
  v_add_f32 v234, 1.0, v234
  v_mfma_f32_16x16x32_bf16 v[156:159], v[216:219], v[36:39], v[156:159]
  s_waitcnt lgkmcnt(4)
  v_add_f32 v235, 1.0, v235
  v_mfma_f32_16x16x32_bf16 v[152:155], v[192:195], v[40:43], v[152:155]
  ds_read_b128 v[216:219], v253 offset:18432
  buffer_load_dwordx4 a[144:147], v2, s[36:39], s75 offen offset:2048 sc1
  v_mfma_f32_16x16x32_bf16 v[156:159], v[192:195], v[44:47], v[156:159]
  v_rcp_f32 v232, v232
  v_mfma_f32_16x16x32_bf16 v[152:155], v[196:199], v[48:51], v[152:155]
  ds_read_b128 v[192:195], v253 offset:19456
  v_rcp_f32 v233, v233
  v_mfma_f32_16x16x32_bf16 v[156:159], v[196:199], v[52:55], v[156:159]
  s_waitcnt lgkmcnt(4)
  v_rcp_f32 v234, v234
  v_mfma_f32_16x16x32_bf16 v[152:155], v[200:203], v[56:59], v[152:155]
  ds_read_b128 v[196:199], v253 offset:20480
  buffer_load_dwordx4 a[148:151], v2, s[36:39], s75 offen offset:3072 sc1
  v_mfma_f32_16x16x32_bf16 v[156:159], v[200:203], v[60:63], v[156:159]
  v_rcp_f32 v235, v235
  v_mul_f32 v232, v184, v232
  v_mfma_f32_16x16x32_bf16 v[152:155], v[204:207], v[64:67], v[152:155]
  ds_read_b128 v[200:203], v253 offset:21504
  v_mul_f32 v233, v185, v233
  v_mul_f32 v234, v186, v234
  v_mfma_f32_16x16x32_bf16 v[156:159], v[204:207], v[68:71], v[156:159]
  s_waitcnt lgkmcnt(4)
  v_mul_f32 v235, v187, v235
  v_cvt_pk_bf16_f32 v240, v232, v233
  v_mfma_f32_16x16x32_bf16 v[152:155], v[208:211], v[72:75], v[152:155]
  ds_read_b128 v[204:207], v253 offset:22528
  s_add_u32 s75, s65, 69632
  buffer_load_dwordx4 a[152:155], v2, s[36:39], s75 offen offset:0 sc1
  v_mfma_f32_16x16x32_bf16 v[156:159], v[208:211], v[76:79], v[156:159]
  v_cvt_pk_bf16_f32 v241, v234, v235
  v_mul_f32 v188, v188, v249
  v_mul_f32 v189, v189, v249
  v_mfma_f32_16x16x32_bf16 v[152:155], v[212:215], v[80:83], v[152:155]
  ds_read_b128 v[208:211], v253 offset:23552
  v_mul_f32 v190, v190, v249
  v_mul_f32 v191, v191, v249
  v_mfma_f32_16x16x32_bf16 v[156:159], v[212:215], v[84:87], v[156:159]
  s_waitcnt lgkmcnt(4)
  v_exp_f32 v236, v188
  s_waitcnt vmcnt(6)
  s_cmp_lg_u32 s51, 0
  s_cbranch_scc0 L_stw_54
  buffer_store_dwordx2 v[222:223], v14, s[36:39], 0 offen offset:96
L_ste_55:
  v_mfma_f32_16x16x32_bf16 v[152:155], v[216:219], v[88:91], v[152:155]
  ds_read_b128 v[212:215], v253 offset:24576
  buffer_load_dwordx4 a[156:159], v2, s[36:39], s75 offen offset:1024 sc1
  v_mfma_f32_16x16x32_bf16 v[156:159], v[216:219], v[92:95], v[156:159]
  v_exp_f32 v237, v189
  v_mfma_f32_16x16x32_bf16 v[152:155], v[192:195], v[96:99], v[152:155]
  ds_read_b128 v[216:219], v253 offset:25600
  v_exp_f32 v238, v190
  v_mfma_f32_16x16x32_bf16 v[156:159], v[192:195], v[100:103], v[156:159]
  s_waitcnt lgkmcnt(4)
  v_exp_f32 v239, v191
  v_mfma_f32_16x16x32_bf16 v[152:155], v[196:199], v[104:107], v[152:155]
  ds_read_b128 v[192:195], v252 offset:38912
  s_add_u32 s75, s64, 8192
  buffer_load_dwordx4 a[160:163], v2, s[36:39], s75 offen offset:2048 sc1
  v_mfma_f32_16x16x32_bf16 v[156:159], v[196:199], v[108:111], v[156:159]
  v_add_f32 v236, 1.0, v236
  v_add_f32 v237, 1.0, v237
  v_add_f32 v238, 1.0, v238
  v_mfma_f32_16x16x32_bf16 v[152:155], v[200:203], v[112:115], v[152:155]
  ds_read_b128 v[196:199], v252 offset:39936
  v_add_f32 v239, 1.0, v239
  v_mfma_f32_16x16x32_bf16 v[156:159], v[200:203], v[116:119], v[156:159]
  s_waitcnt lgkmcnt(4)
  v_rcp_f32 v236, v236
  v_mfma_f32_16x16x32_bf16 v[152:155], v[204:207], v[120:123], v[152:155]
  ds_read_b128 v[200:203], v252 offset:40960
  buffer_load_dwordx4 a[164:167], v2, s[36:39], s75 offen offset:3072 sc1
  v_mfma_f32_16x16x32_bf16 v[156:159], v[204:207], v[124:127], v[156:159]
  v_rcp_f32 v237, v237
  v_mfma_f32_16x16x32_bf16 v[152:155], v[208:211], v[128:131], v[152:155]
  ds_read_b128 v[204:207], v252 offset:41984
  v_rcp_f32 v238, v238
  v_mfma_f32_16x16x32_bf16 v[156:159], v[208:211], v[132:135], v[156:159]
  s_waitcnt lgkmcnt(4)
  v_rcp_f32 v239, v239
  v_mfma_f32_16x16x32_bf16 v[152:155], v[212:215], v[136:139], v[152:155]
  ds_read_b128 v[208:211], v252 offset:43008
  s_add_u32 s75, s64, 12288
  buffer_load_dwordx4 a[168:171], v2, s[36:39], s75 offen offset:0 sc1
  v_mfma_f32_16x16x32_bf16 v[156:159], v[212:215], v[140:143], v[156:159]
  v_mul_f32 v236, v188, v236
  v_mul_f32 v237, v189, v237
  v_mul_f32 v238, v190, v238
  v_mfma_f32_16x16x32_bf16 v[152:155], v[216:219], v[144:147], v[152:155]
  ds_read_b128 v[212:215], v2 offset:30720
  v_mul_f32 v239, v191, v239
  v_cvt_pk_bf16_f32 v242, v236, v237
  v_mfma_f32_16x16x32_bf16 v[156:159], v[216:219], v[148:151], v[156:159]
  s_waitcnt lgkmcnt(4)
  v_cvt_pk_bf16_f32 v243, v238, v239
  v_mfma_f32_16x16x32_bf16 v[160:163], v[192:195], a[224:227], 0
  ds_read_b128 v[216:219], v2 offset:31744
  buffer_load_dwordx4 a[172:175], v2, s[36:39], s75 offen offset:1024 sc1
  v_mfma_f32_16x16x32_bf16 v[164:167], v[192:195], a[228:231], 0
  v_permlane16_swap_b32 v240, v242
  v_mfma_f32_16x16x32_bf16 v[160:163], v[196:199], a[232:235], v[160:163]
  ds_read_b128 v[192:195], v2 offset:32768
  v_permlane16_swap_b32 v241, v243
  v_mfma_f32_16x16x32_bf16 v[164:167], v[196:199], a[236:239], v[164:167]
  s_waitcnt lgkmcnt(4)
  v_mfma_f32_16x16x32_bf16 v[160:163], v[200:203], a[240:243], v[160:163]
  ds_read_b128 v[196:199], v2 offset:33792
  buffer_load_dwordx4 a[176:179], v2, s[36:39], s75 offen offset:2048 sc1
  v_mfma_f32_16x16x32_bf16 v[164:167], v[200:203], a[244:247], v[164:167]
  buffer_store_dwordx4 v[240:243], v2, s[36:39], s77 offen offset:0 sc1
  v_mfma_f32_16x16x32_bf16 v[160:163], v[204:207], a[248:251], v[160:163]
  ds_read_b128 v[200:203], v2 offset:34816
  s_lshl_b32 s7, s67, 11
  s_add_u32 s7, s7, 163840
  v_mfma_f32_16x16x32_bf16 v[164:167], v[204:207], a[252:255], v[164:167]
  s_waitcnt lgkmcnt(4)
  s_add_u32 s72, s50, 1
  s_and_b32 s72, s72, 3
  v_mfma_f32_16x16x32_bf16 v[160:163], v[208:211], v[16:19], v[160:163]
  ds_read_b128 v[204:207], v253 offset:26624
  buffer_load_dwordx4 a[180:183], v2, s[36:39], s75 offen offset:3072 sc1
  s_mul_i32 s73, s72, 15360
  v_mfma_f32_16x16x32_bf16 v[164:167], v[208:211], v[20:23], v[164:167]
  s_add_u32 s12, s73, 102400
  s_lshr_b32 s73, s72, 1
  s_mul_i32 s73, s73, 274432
  v_mfma_f32_16x16x32_bf16 v[160:163], v[212:215], v[24:27], v[160:163]
  ds_read_b128 v[208:211], v253 offset:27648
  s_and_b32 s72, s72, 1
  s_lshl_b32 s72, s72, 8
  v_mfma_f32_16x16x32_bf16 v[164:167], v[212:215], v[28:31], v[164:167]
  s_waitcnt lgkmcnt(4)
  s_add_u32 s72, s72, s73
  s_add_u32 s72, s72, s82
  v_mfma_f32_16x16x32_bf16 v[160:163], v[216:219], v[32:35], v[160:163]
  ds_read_b128 v[212:215], v253 offset:28672
  s_add_u32 s75, s64, 16384
  buffer_load_dwordx4 a[184:187], v2, s[36:39], s75 offen offset:0 sc1
  v_mfma_f32_16x16x32_bf16 v[164:167], v[216:219], v[36:39], v[164:167]
  s_add_u32 s52, s72, s7
  s_cmp_eq_u32 s50, 3
  s_cselect_b32 s56, 2147483648, s52
  v_mfma_f32_16x16x32_bf16 v[160:163], v[192:195], v[40:43], v[160:163]
  ds_read_b128 v[216:219], v253 offset:29696
  s_add_u32 s72, s50, 2
  s_and_b32 s72, s72, 3
  v_mfma_f32_16x16x32_bf16 v[164:167], v[192:195], v[44:47], v[164:167]
  s_waitcnt lgkmcnt(4)
  s_mul_i32 s73, s72, 15360
  s_add_u32 s13, s73, 107520
  v_mfma_f32_16x16x32_bf16 v[160:163], v[196:199], v[48:51], v[160:163]
  ds_read_b128 v[192:195], v253 offset:30720
  buffer_load_dwordx4 a[188:191], v2, s[36:39], s75 offen offset:1024 sc1
  s_lshr_b32 s73, s72, 1
  v_mfma_f32_16x16x32_bf16 v[164:167], v[196:199], v[52:55], v[164:167]
  s_mul_i32 s73, s73, 274432
  s_and_b32 s72, s72, 1
  s_lshl_b32 s72, s72, 8
  v_mfma_f32_16x16x32_bf16 v[160:163], v[200:203], v[56:59], v[160:163]
  ds_read_b128 v[196:199], v253 offset:31744
  s_add_u32 s72, s72, s73
  s_add_u32 s72, s72, s82
  v_mfma_f32_16x16x32_bf16 v[164:167], v[200:203], v[60:63], v[164:167]
  s_waitcnt lgkmcnt(4)
  s_add_u32 s53, s72, s7
  buffer_load_dwordx2 v[224:225], v220, s[36:39], 0 offen offset:96 sc1
  v_mfma_f32_16x16x32_bf16 v[160:163], v[204:207], v[64:67], v[160:163]
  ds_read_b128 v[200:203], v253 offset:32768
  buffer_load_dwordx4 a[192:195], v2, s[36:39], s75 offen offset:2048 sc1
  v_mfma_f32_16x16x32_bf16 v[164:167], v[204:207], v[68:71], v[164:167]
  s_cmp_eq_u32 s50, 3
  s_cselect_b32 s57, 2147483648, s53
  s_add_u32 s72, s50, 3
  v_mfma_f32_16x16x32_bf16 v[160:163], v[208:211], v[72:75], v[160:163]
  ds_read_b128 v[204:207], v253 offset:33792
  s_and_b32 s72, s72, 3
  s_mul_i32 s73, s72, 15360
  v_mfma_f32_16x16x32_bf16 v[164:167], v[208:211], v[76:79], v[164:167]
  s_waitcnt lgkmcnt(4)
  s_add_u32 s14, s73, 112640
  s_lshr_b32 s73, s72, 1
  v_mfma_f32_16x16x32_bf16 v[160:163], v[212:215], v[80:83], v[160:163]
  ds_read_b128 v[208:211], v253 offset:34816
  buffer_load_dwordx4 a[196:199], v2, s[36:39], s75 offen offset:3072 sc1
  s_mul_i32 s73, s73, 274432
  v_mfma_f32_16x16x32_bf16 v[164:167], v[212:215], v[84:87], v[164:167]
  s_and_b32 s72, s72, 1
  s_lshl_b32 s72, s72, 8
  s_add_u32 s72, s72, s73
  v_mfma_f32_16x16x32_bf16 v[160:163], v[216:219], v[88:91], v[160:163]
  ds_read_b128 v[212:215], v253 offset:35840
  s_add_u32 s72, s72, s82
  s_add_u32 s54, s72, s7
  v_mfma_f32_16x16x32_bf16 v[164:167], v[216:219], v[92:95], v[164:167]
  s_waitcnt lgkmcnt(4)
  s_cmp_eq_u32 s50, 3
  s_cselect_b32 s58, 2147483648, s54
  v_mfma_f32_16x16x32_bf16 v[160:163], v[192:195], v[96:99], v[160:163]
  ds_read_b128 v[216:219], v253 offset:36864
  s_add_u32 s75, s64, 20480
  buffer_load_dwordx4 a[200:203], v2, s[36:39], s75 offen offset:0 sc1
  v_mfma_f32_16x16x32_bf16 v[164:167], v[192:195], v[100:103], v[164:167]
  s_add_u32 s72, s50, 4
  s_and_b32 s72, s72, 3
  s_lshr_b32 s73, s72, 1
  v_mfma_f32_16x16x32_bf16 v[160:163], v[196:199], v[104:107], v[160:163]
  s_mul_i32 s73, s73, 274432
  s_and_b32 s72, s72, 1
  s_lshl_b32 s72, s72, 8
  v_mfma_f32_16x16x32_bf16 v[164:167], v[196:199], v[108:111], v[164:167]
  s_waitcnt lgkmcnt(3)
  s_add_u32 s72, s72, s73
  s_add_u32 s72, s72, s82
  v_mfma_f32_16x16x32_bf16 v[160:163], v[200:203], v[112:115], v[160:163]
  buffer_load_dwordx4 a[204:207], v2, s[36:39], s75 offen offset:1024 sc1
  s_add_u32 s55, s72, s7
  v_mfma_f32_16x16x32_bf16 v[164:167], v[200:203], v[116:119], v[164:167]
  s_cmp_eq_u32 s50, 3
  s_cselect_b32 s59, 2147483648, s55
  s_mul_i32 s73, s50, 15360
  v_mfma_f32_16x16x32_bf16 v[160:163], v[204:207], v[120:123], v[160:163]
  s_add_u32 s15, s73, 102400
  v_mul_f32 v152, v152, v248
  v_mul_f32 v153, v153, v248
  v_mfma_f32_16x16x32_bf16 v[164:167], v[204:207], v[124:127], v[164:167]
  s_waitcnt lgkmcnt(1)
  v_mul_f32 v154, v154, v248
  v_mul_f32 v155, v155, v248
  v_mfma_f32_16x16x32_bf16 v[160:163], v[208:211], v[128:131], v[160:163]
  buffer_load_dwordx4 a[208:211], v2, s[36:39], s75 offen offset:2048 sc1
  v_exp_f32 v232, v152
  v_mfma_f32_16x16x32_bf16 v[164:167], v[208:211], v[132:135], v[164:167]
  v_exp_f32 v233, v153
  v_mfma_f32_16x16x32_bf16 v[160:163], v[212:215], v[136:139], v[160:163]
  v_exp_f32 v234, v154
  v_mfma_f32_16x16x32_bf16 v[164:167], v[212:215], v[140:143], v[164:167]
  s_waitcnt lgkmcnt(0)
  v_exp_f32 v235, v155
  v_mfma_f32_16x16x32_bf16 v[160:163], v[216:219], v[144:147], v[160:163]
  buffer_load_dwordx4 a[212:215], v2, s[36:39], s75 offen offset:3072 sc1
  v_add_f32 v232, 1.0, v232
  v_add_f32 v233, 1.0, v233
  v_mfma_f32_16x16x32_bf16 v[164:167], v[216:219], v[148:151], v[164:167]
  v_add_f32 v234, 1.0, v234
  v_add_f32 v235, 1.0, v235
  v_rcp_f32 v232, v232
  v_rcp_f32 v233, v233
  v_rcp_f32 v234, v234
  v_rcp_f32 v235, v235
  v_mul_f32 v232, v152, v232
  v_mul_f32 v233, v153, v233
  v_mul_f32 v234, v154, v234
  v_mul_f32 v235, v155, v235
  v_cvt_pk_bf16_f32 v244, v232, v233
  v_cvt_pk_bf16_f32 v245, v234, v235
  v_mul_f32 v156, v156, v249
  v_mul_f32 v157, v157, v249
  v_mul_f32 v158, v158, v249
  v_mul_f32 v159, v159, v249
  v_exp_f32 v236, v156
  v_exp_f32 v237, v157
  v_exp_f32 v238, v158
  v_exp_f32 v239, v159
  v_add_f32 v236, 1.0, v236
  v_add_f32 v237, 1.0, v237
  v_add_f32 v238, 1.0, v238
  v_add_f32 v239, 1.0, v239
  v_rcp_f32 v236, v236
  v_rcp_f32 v237, v237
  v_rcp_f32 v238, v238
  v_rcp_f32 v239, v239
  v_mul_f32 v236, v156, v236
  v_mul_f32 v237, v157, v237
  v_mul_f32 v238, v158, v238
  v_mul_f32 v239, v159, v239
  v_cvt_pk_bf16_f32 v246, v236, v237
  v_cvt_pk_bf16_f32 v247, v238, v239
  s_nop 0
  v_permlane16_swap_b32 v244, v246
  v_permlane16_swap_b32 v245, v247
  buffer_store_dwordx4 v[244:247], v2, s[36:39], s77 offen offset:1024 sc1
  v_add_u32 v20, 0, v254
  v_add_u32 v21, 4096, v254
  v_add_u32 v22, 8192, v254
  v_add_u32 v23, 12288, v254
  v_add_u32 v24, 16384, v254
  v_add_u32 v25, 20480, v254
  v_add_u32 v26, 24576, v254
  s_waitcnt vmcnt(7)
  v_cmp_eq_u64 s[4:5], s[10:11], v[224:225]
  s_nop 1
  s_cmp_eq_u64 s[4:5], -1
  s_cbranch_scc0 L_ckr_56
L_ckb_57:
  buffer_load_dwordx4 v[32:35], v20, s[36:39], s52 offen offset:0 sc1
  buffer_load_dwordx4 v[36:39], v20, s[36:39], s52 offen offset:2048 sc1
  buffer_load_dwordx4 v[40:43], v22, s[36:39], s52 offen offset:2048 sc1
  buffer_load_dwordx4 v[44:47], v23, s[36:39], s52 offen offset:0 sc1
  buffer_load_dwordx4 v[48:51], v23, s[36:39], s52 offen offset:2048 sc1
  buffer_load_dwordx4 v[52:55], v24, s[36:39], s52 offen offset:0 sc1
  buffer_load_dwordx4 v[56:59], v26, s[36:39], s56 offen offset:0 sc1
  v_pk_mul_f32 v[160:161], v[160:161], v[248:249] op_sel:[0,0] op_sel_hi:[1,0]
  v_pk_mul_f32 v[162:163], v[162:163], v[248:249] op_sel:[0,0] op_sel_hi:[1,0]
  v_exp_f32 v232, v160
  v_exp_f32 v233, v161
  v_exp_f32 v234, v162
  v_exp_f32 v235, v163
  v_pk_add_f32 v[232:233], v[232:233], 1.0 op_sel_hi:[1,0]
  v_pk_add_f32 v[234:235], v[234:235], 1.0 op_sel_hi:[1,0]
  v_rcp_f32 v232, v232
  v_rcp_f32 v233, v233
  v_rcp_f32 v234, v234
  v_rcp_f32 v235, v235
  v_pk_mul_f32 v[232:233], v[160:161], v[232:233]
  v_pk_mul_f32 v[234:235], v[162:163], v[234:235]
  v_cvt_pk_bf16_f32 v240, v232, v233
  v_cvt_pk_bf16_f32 v241, v234, v235
  v_pk_mul_f32 v[164:165], v[164:165], v[248:249] op_sel:[0,1] op_sel_hi:[1,1]
  v_pk_mul_f32 v[166:167], v[166:167], v[248:249] op_sel:[0,1] op_sel_hi:[1,1]
  v_exp_f32 v236, v164
  v_exp_f32 v237, v165
  v_exp_f32 v238, v166
  v_exp_f32 v239, v167
  v_pk_add_f32 v[236:237], v[236:237], 1.0 op_sel_hi:[1,0]
  v_pk_add_f32 v[238:239], v[238:239], 1.0 op_sel_hi:[1,0]
  v_rcp_f32 v236, v236
  v_rcp_f32 v237, v237
  v_rcp_f32 v238, v238
  v_rcp_f32 v239, v239
  v_pk_mul_f32 v[236:237], v[164:165], v[236:237]
  v_pk_mul_f32 v[238:239], v[166:167], v[238:239]
  v_cvt_pk_bf16_f32 v242, v236, v237
  v_cvt_pk_bf16_f32 v243, v238, v239
  s_nop 0
  v_permlane16_swap_b32 v240, v242
  v_permlane16_swap_b32 v241, v243
  buffer_store_dwordx4 v[240:243], v2, s[36:39], s77 offen offset:2048 sc1
  s_waitcnt vmcnt(7)
  v_mfma_f32_16x16x32_bf16 v[80:83], a[0:3], v[32:35], 0
  buffer_load_dwordx4 v[60:63], v26, s[36:39], s56 offen offset:2048 sc1
  s_mov_b32 s16, 3207688728
  v_mfma_f32_16x16x32_bf16 v[84:87], a[4:7], v[32:35], 0
  s_mov_b32 s17, 3207688728
  v_add_u32 v28, s12, v2
  v_mfma_f32_16x16x32_bf16 v[88:91], a[8:11], v[32:35], 0
  s_add_u32 s75, s64, 24576
  buffer_load_dwordx4 a[216:219], v2, s[36:39], s75 offen offset:0 sc1
  v_mfma_f32_16x16x32_bf16 v[92:95], a[12:15], v[32:35], 0
  v_add_u32 v29, s13, v2
  v_add_u32 v30, s14, v2
  v_mfma_f32_16x16x32_bf16 v[96:99], a[16:19], v[32:35], 0
  s_waitcnt vmcnt(8)
  v_add_u32 v31, s15, v2
  v_mfma_f32_16x16x32_bf16 v[80:83], a[20:23], v[36:39], v[80:83]
  buffer_load_dwordx4 v[64:67], v20, s[36:39], s53 offen offset:0 sc1
  v_lshlrev_b32 v160, 16, v4
  v_mfma_f32_16x16x32_bf16 v[84:87], a[24:27], v[36:39], v[84:87]
  v_and_b32 v161, s78, v4
  v_lshlrev_b32 v162, 16, v5
  v_mfma_f32_16x16x32_bf16 v[88:91], a[28:31], v[36:39], v[88:91]
  v_and_b32 v163, s78, v5
  v_lshlrev_b32 v164, 16, v6
  v_mfma_f32_16x16x32_bf16 v[92:95], a[32:35], v[36:39], v[92:95]
  v_and_b32 v165, s78, v6
  v_lshlrev_b32 v166, 16, v7
  v_mfma_f32_16x16x32_bf16 v[96:99], a[36:39], v[36:39], v[96:99]
  s_waitcnt vmcnt(8)
  v_and_b32 v167, s78, v7
  v_mfma_f32_16x16x32_bf16 v[80:83], a[40:43], v[40:43], v[80:83]
  buffer_load_dwordx4 v[68:71], v20, s[36:39], s53 offen offset:2048 sc1
  v_lshlrev_b32 v168, 16, v8
  v_mfma_f32_16x16x32_bf16 v[84:87], a[44:47], v[40:43], v[84:87]
  v_and_b32 v169, s78, v8
  v_lshlrev_b32 v170, 16, v9
  v_mfma_f32_16x16x32_bf16 v[88:91], a[48:51], v[40:43], v[88:91]
  s_add_u32 s75, s64, 45056
  buffer_load_dwordx4 a[220:223], v2, s[36:39], s75 offen offset:1024 sc1
  v_mfma_f32_16x16x32_bf16 v[92:95], a[52:55], v[40:43], v[92:95]
  v_and_b32 v171, s78, v9
  v_lshlrev_b32 v172, 16, v10
  v_mfma_f32_16x16x32_bf16 v[96:99], a[56:59], v[40:43], v[96:99]
  s_waitcnt vmcnt(9)
  v_and_b32 v173, s78, v10
  v_mfma_f32_16x16x32_bf16 v[80:83], a[60:63], v[44:47], v[80:83]
  buffer_load_dwordx4 v[72:75], v22, s[36:39], s53 offen offset:2048 sc1
  v_lshlrev_b32 v174, 16, v11
  v_mfma_f32_16x16x32_bf16 v[84:87], a[64:67], v[44:47], v[84:87]
  v_and_b32 v175, s78, v11
  v_lshlrev_b32 v176, 16, v12
  v_mfma_f32_16x16x32_bf16 v[88:91], a[68:71], v[44:47], v[88:91]
  v_and_b32 v177, s78, v12
  v_lshlrev_b32 v178, 16, v13
  v_mfma_f32_16x16x32_bf16 v[92:95], a[72:75], v[44:47], v[92:95]
  v_and_b32 v179, s78, v13
  v_and_b32 v18, 15, v1
  v_mfma_f32_16x16x32_bf16 v[96:99], a[76:79], v[44:47], v[96:99]
  s_waitcnt vmcnt(9)
  v_mul_u32_u24 v18, 1280, v18
  v_mfma_f32_16x16x32_bf16 v[80:83], a[80:83], v[48:51], v[80:83]
  buffer_load_dwordx4 v[76:79], v23, s[36:39], s53 offen offset:0 sc1
  v_lshrrev_b32 v19, 4, v1
L_tc1_3:
  s_cbranch_execz L_tr1
  v_mfma_f32_16x16x32_bf16 v[84:87], a[84:87], v[48:51], v[84:87]
  v_lshl_add_u32 v15, v19, 4, v18
  v_lshl_add_u32 v3, v19, 3, v18
  v_mfma_f32_16x16x32_bf16 v[88:91], a[88:91], v[48:51], v[88:91]
  buffer_load_dwordx4 a[224:227], v2, s[36:39], s75 offen offset:2048 sc1
  v_mfma_f32_16x16x32_bf16 v[92:95], a[92:95], v[48:51], v[92:95]
  v_mfma_f32_16x16x32_bf16 v[96:99], a[96:99], v[48:51], v[96:99]
  s_waitcnt vmcnt(10)
  s_waitcnt vmcnt(8)
  s_cmp_lg_u32 s51, 0
  s_cbranch_scc0 L_stw_58
  buffer_store_dwordx2 v[222:223], v14, s[36:39], 0 offen offset:64
L_ste_59:
  v_mfma_f32_16x16x32_bf16 v[80:83], a[100:103], v[52:55], v[80:83]
  buffer_load_dwordx4 v[32:35], v23, s[36:39], s53 offen offset:2048 sc1
  v_mfma_f32_16x16x32_bf16 v[84:87], a[104:107], v[52:55], v[84:87]
  v_mfma_f32_16x16x32_bf16 v[88:91], a[108:111], v[52:55], v[88:91]
  v_mfma_f32_16x16x32_bf16 v[92:95], a[112:115], v[52:55], v[92:95]
  v_mfma_f32_16x16x32_bf16 v[96:99], a[116:119], v[52:55], v[96:99]
  v_mfma_f32_16x16x32_bf16 v[80:83], a[120:123], v[56:59], v[80:83]
  buffer_load_dwordx4 v[36:39], v24, s[36:39], s53 offen offset:0 sc1
  v_mfma_f32_16x16x32_bf16 v[84:87], a[124:127], v[56:59], v[84:87]
  v_mfma_f32_16x16x32_bf16 v[88:91], a[128:131], v[56:59], v[88:91]
  buffer_load_dwordx4 a[228:231], v2, s[36:39], s75 offen offset:3072 sc1
  v_mfma_f32_16x16x32_bf16 v[92:95], a[132:135], v[56:59], v[92:95]
  v_mfma_f32_16x16x32_bf16 v[96:99], a[136:139], v[56:59], v[96:99]
  s_waitcnt vmcnt(11)
  v_mfma_f32_16x16x32_bf16 v[80:83], a[140:143], v[60:63], v[80:83]
  buffer_load_dwordx4 v[40:43], v26, s[36:39], s57 offen offset:0 sc1
  v_mfma_f32_16x16x32_bf16 v[84:87], a[144:147], v[60:63], v[84:87]
  v_mfma_f32_16x16x32_bf16 v[88:91], a[148:151], v[60:63], v[88:91]
  v_mfma_f32_16x16x32_bf16 v[92:95], a[152:155], v[60:63], v[92:95]
  v_mfma_f32_16x16x32_bf16 v[96:99], a[156:159], v[60:63], v[96:99]
  s_waitcnt vmcnt(10)
  v_mfma_f32_16x16x32_bf16 v[100:103], a[0:3], v[64:67], 0
  buffer_load_dwordx4 v[44:47], v26, s[36:39], s57 offen offset:2048 sc1
  v_mfma_f32_16x16x32_bf16 v[104:107], a[4:7], v[64:67], 0
  v_mfma_f32_16x16x32_bf16 v[108:111], a[8:11], v[64:67], 0
  s_add_u32 s75, s64, 49152
  buffer_load_dwordx4 a[232:235], v2, s[36:39], s75 offen offset:0 sc1
  v_mfma_f32_16x16x32_bf16 v[112:115], a[12:15], v[64:67], 0
  v_mfma_f32_16x16x32_bf16 v[116:119], a[16:19], v[64:67], 0
  s_waitcnt vmcnt(11)
  v_mfma_f32_16x16x32_bf16 v[100:103], a[20:23], v[68:71], v[100:103]
  buffer_load_dwordx4 v[48:51], v20, s[36:39], s54 offen offset:0 sc1
  v_mfma_f32_16x16x32_bf16 v[104:107], a[24:27], v[68:71], v[104:107]
  v_mfma_f32_16x16x32_bf16 v[108:111], a[28:31], v[68:71], v[108:111]
  v_mfma_f32_16x16x32_bf16 v[112:115], a[32:35], v[68:71], v[112:115]
  v_mfma_f32_16x16x32_bf16 v[116:119], a[36:39], v[68:71], v[116:119]
  s_waitcnt vmcnt(10)
  v_mfma_f32_16x16x32_bf16 v[100:103], a[40:43], v[72:75], v[100:103]
  buffer_load_dwordx4 v[52:55], v20, s[36:39], s54 offen offset:2048 sc1
  v_mfma_f32_16x16x32_bf16 v[104:107], a[44:47], v[72:75], v[104:107]
  v_mfma_f32_16x16x32_bf16 v[108:111], a[48:51], v[72:75], v[108:111]
  buffer_load_dwordx4 a[236:239], v2, s[36:39], s75 offen offset:1024 sc1
  v_mfma_f32_16x16x32_bf16 v[112:115], a[52:55], v[72:75], v[112:115]
  v_mfma_f32_16x16x32_bf16 v[116:119], a[56:59], v[72:75], v[116:119]
  s_waitcnt vmcnt(11)
  v_mfma_f32_16x16x32_bf16 v[100:103], a[60:63], v[76:79], v[100:103]
  buffer_load_dwordx4 v[56:59], v22, s[36:39], s54 offen offset:2048 sc1
  v_mfma_f32_16x16x32_bf16 v[104:107], a[64:67], v[76:79], v[104:107]
  v_mfma_f32_16x16x32_bf16 v[108:111], a[68:71], v[76:79], v[108:111]
  v_mfma_f32_16x16x32_bf16 v[112:115], a[72:75], v[76:79], v[112:115]
  v_mfma_f32_16x16x32_bf16 v[116:119], a[76:79], v[76:79], v[116:119]
  s_waitcnt vmcnt(9)
  v_mfma_f32_16x16x32_bf16 v[100:103], a[80:83], v[32:35], v[100:103]
  buffer_load_dwordx4 v[60:63], v23, s[36:39], s54 offen offset:0 sc1
  v_mfma_f32_16x16x32_bf16 v[104:107], a[84:87], v[32:35], v[104:107]
  v_mfma_f32_16x16x32_bf16 v[108:111], a[88:91], v[32:35], v[108:111]
  buffer_load_dwordx4 a[240:243], v2, s[36:39], s75 offen offset:2048 sc1
  v_mfma_f32_16x16x32_bf16 v[112:115], a[92:95], v[32:35], v[112:115]
  v_mfma_f32_16x16x32_bf16 v[116:119], a[96:99], v[32:35], v[116:119]
  s_waitcnt vmcnt(10)
  v_mfma_f32_16x16x32_bf16 v[100:103], a[100:103], v[36:39], v[100:103]
  buffer_load_dwordx4 v[64:67], v23, s[36:39], s54 offen offset:2048 sc1
  v_mfma_f32_16x16x32_bf16 v[104:107], a[104:107], v[36:39], v[104:107]
  v_mfma_f32_16x16x32_bf16 v[108:111], a[108:111], v[36:39], v[108:111]
  v_mfma_f32_16x16x32_bf16 v[112:115], a[112:115], v[36:39], v[112:115]
  v_mfma_f32_16x16x32_bf16 v[116:119], a[116:119], v[36:39], v[116:119]
  s_waitcnt vmcnt(9)
  v_mfma_f32_16x16x32_bf16 v[100:103], a[120:123], v[40:43], v[100:103]
  buffer_load_dwordx4 v[68:71], v24, s[36:39], s54 offen offset:0 sc1
  v_mfma_f32_16x16x32_bf16 v[104:107], a[124:127], v[40:43], v[104:107]
  v_mfma_f32_16x16x32_bf16 v[108:111], a[128:131], v[40:43], v[108:111]
  buffer_load_dwordx4 a[244:247], v2, s[36:39], s75 offen offset:3072 sc1
  v_mfma_f32_16x16x32_bf16 v[112:115], a[132:135], v[40:43], v[112:115]
  v_mfma_f32_16x16x32_bf16 v[116:119], a[136:139], v[40:43], v[116:119]
  s_waitcnt vmcnt(10)
  v_mfma_f32_16x16x32_bf16 v[100:103], a[140:143], v[44:47], v[100:103]
  buffer_load_dwordx4 v[72:75], v26, s[36:39], s58 offen offset:0 sc1
  v_mfma_f32_16x16x32_bf16 v[104:107], a[144:147], v[44:47], v[104:107]
  v_mfma_f32_16x16x32_bf16 v[108:111], a[148:151], v[44:47], v[108:111]
  v_mfma_f32_16x16x32_bf16 v[112:115], a[152:155], v[44:47], v[112:115]
  v_mfma_f32_16x16x32_bf16 v[116:119], a[156:159], v[44:47], v[116:119]
  s_waitcnt vmcnt(9)
  v_mfma_f32_16x16x32_bf16 v[120:123], a[0:3], v[48:51], 0
  buffer_load_dwordx4 v[76:79], v26, s[36:39], s58 offen offset:2048 sc1
  v_mfma_f32_16x16x32_bf16 v[124:127], a[4:7], v[48:51], 0
  v_mfma_f32_16x16x32_bf16 v[128:131], a[8:11], v[48:51], 0
  s_add_u32 s75, s64, 53248
  buffer_load_dwordx4 a[248:251], v2, s[36:39], s75 offen offset:0 sc1
  v_mfma_f32_16x16x32_bf16 v[132:135], a[12:15], v[48:51], 0
  v_mfma_f32_16x16x32_bf16 v[136:139], a[16:19], v[48:51], 0
  s_waitcnt vmcnt(10)
  v_mfma_f32_16x16x32_bf16 v[120:123], a[20:23], v[52:55], v[120:123]
  buffer_load_dwordx4 v[32:35], v20, s[36:39], s55 offen offset:0 sc1
  v_mfma_f32_16x16x32_bf16 v[124:127], a[24:27], v[52:55], v[124:127]
  v_mfma_f32_16x16x32_bf16 v[128:131], a[28:31], v[52:55], v[128:131]
  v_mfma_f32_16x16x32_bf16 v[132:135], a[32:35], v[52:55], v[132:135]
  v_mfma_f32_16x16x32_bf16 v[136:139], a[36:39], v[52:55], v[136:139]
  s_waitcnt vmcnt(9)
  buffer_load_dwordx2 v[16:17], v220, s[36:39], 0 offen offset:64 sc1
  v_mfma_f32_16x16x32_bf16 v[120:123], a[40:43], v[56:59], v[120:123]
  buffer_load_dwordx4 v[36:39], v20, s[36:39], s55 offen offset:2048 sc1
  v_mfma_f32_16x16x32_bf16 v[124:127], a[44:47], v[56:59], v[124:127]
  v_mfma_f32_16x16x32_bf16 v[128:131], a[48:51], v[56:59], v[128:131]
  buffer_load_dwordx4 a[252:255], v2, s[36:39], s75 offen offset:1024 sc1
  v_mfma_f32_16x16x32_bf16 v[132:135], a[52:55], v[56:59], v[132:135]
  v_mfma_f32_16x16x32_bf16 v[136:139], a[56:59], v[56:59], v[136:139]
  s_waitcnt vmcnt(11)
  v_mfma_f32_16x16x32_bf16 v[120:123], a[60:63], v[60:63], v[120:123]
  buffer_load_dwordx4 v[40:43], v22, s[36:39], s55 offen offset:2048 sc1
  v_mfma_f32_16x16x32_bf16 v[124:127], a[64:67], v[60:63], v[124:127]
  v_mfma_f32_16x16x32_bf16 v[128:131], a[68:71], v[60:63], v[128:131]
  v_mfma_f32_16x16x32_bf16 v[132:135], a[72:75], v[60:63], v[132:135]
  v_mfma_f32_16x16x32_bf16 v[136:139], a[76:79], v[60:63], v[136:139]
  s_waitcnt vmcnt(10)
  v_mfma_f32_16x16x32_bf16 v[120:123], a[80:83], v[64:67], v[120:123]
  buffer_load_dwordx4 v[44:47], v23, s[36:39], s55 offen offset:0 sc1
  v_mfma_f32_16x16x32_bf16 v[124:127], a[84:87], v[64:67], v[124:127]
  v_mfma_f32_16x16x32_bf16 v[128:131], a[88:91], v[64:67], v[128:131]
  buffer_load_dwordx4 v[232:235], v2, s[36:39], s75 offen offset:2048 sc1
  v_mfma_f32_16x16x32_bf16 v[132:135], a[92:95], v[64:67], v[132:135]
  v_mfma_f32_16x16x32_bf16 v[136:139], a[96:99], v[64:67], v[136:139]
  s_waitcnt vmcnt(11)
  v_mfma_f32_16x16x32_bf16 v[120:123], a[100:103], v[68:71], v[120:123]
  buffer_load_dwordx4 v[48:51], v23, s[36:39], s55 offen offset:2048 sc1
  v_mfma_f32_16x16x32_bf16 v[124:127], a[104:107], v[68:71], v[124:127]
  v_mfma_f32_16x16x32_bf16 v[128:131], a[108:111], v[68:71], v[128:131]
  v_mfma_f32_16x16x32_bf16 v[132:135], a[112:115], v[68:71], v[132:135]
  v_mfma_f32_16x16x32_bf16 v[136:139], a[116:119], v[68:71], v[136:139]
  s_waitcnt vmcnt(10)
  v_mfma_f32_16x16x32_bf16 v[120:123], a[120:123], v[72:75], v[120:123]
  buffer_load_dwordx4 v[52:55], v24, s[36:39], s55 offen offset:0 sc1
  v_mfma_f32_16x16x32_bf16 v[124:127], a[124:127], v[72:75], v[124:127]
  v_mfma_f32_16x16x32_bf16 v[128:131], a[128:131], v[72:75], v[128:131]
  buffer_load_dwordx4 v[236:239], v2, s[36:39], s75 offen offset:3072 sc1
  v_mfma_f32_16x16x32_bf16 v[132:135], a[132:135], v[72:75], v[132:135]
  v_mfma_f32_16x16x32_bf16 v[136:139], a[136:139], v[72:75], v[136:139]
  s_waitcnt vmcnt(11)
  v_mfma_f32_16x16x32_bf16 v[120:123], a[140:143], v[76:79], v[120:123]
  buffer_load_dwordx4 v[56:59], v26, s[36:39], s59 offen offset:0 sc1
  v_mfma_f32_16x16x32_bf16 v[124:127], a[144:147], v[76:79], v[124:127]
  v_mfma_f32_16x16x32_bf16 v[128:131], a[148:151], v[76:79], v[128:131]
  v_mfma_f32_16x16x32_bf16 v[132:135], a[152:155], v[76:79], v[132:135]
  v_mfma_f32_16x16x32_bf16 v[136:139], a[156:159], v[76:79], v[136:139]
  s_waitcnt vmcnt(10)
  v_mfma_f32_16x16x32_bf16 v[140:143], a[0:3], v[32:35], 0
  buffer_load_dwordx4 v[60:63], v26, s[36:39], s59 offen offset:2048 sc1
  v_mfma_f32_16x16x32_bf16 v[144:147], a[4:7], v[32:35], 0
  v_mfma_f32_16x16x32_bf16 v[148:151], a[8:11], v[32:35], 0
  s_add_u32 s75, s64, 57344
  buffer_load_dwordx4 v[240:243], v2, s[36:39], s75 offen offset:0 sc1
  v_mfma_f32_16x16x32_bf16 v[152:155], a[12:15], v[32:35], 0
  v_mfma_f32_16x16x32_bf16 v[156:159], a[16:19], v[32:35], 0
  s_waitcnt vmcnt(10)
  v_cmp_eq_u64 s[4:5], s[10:11], v[16:17]
  s_nop 1
  s_cmp_eq_u64 s[4:5], -1
  s_cbranch_scc0 L_ckr_60
L_ckb_61:
  v_mfma_f32_16x16x32_bf16 v[140:143], a[20:23], v[36:39], v[140:143]
  buffer_load_dwordx4 v[64:67], v21, s[36:39], s52 offen offset:0 sc1
  v_mfma_f32_16x16x32_bf16 v[144:147], a[24:27], v[36:39], v[144:147]
  v_mfma_f32_16x16x32_bf16 v[148:151], a[28:31], v[36:39], v[148:151]
  v_mfma_f32_16x16x32_bf16 v[152:155], a[32:35], v[36:39], v[152:155]
  v_mfma_f32_16x16x32_bf16 v[156:159], a[36:39], v[36:39], v[156:159]
  s_waitcnt vmcnt(9)
  v_mfma_f32_16x16x32_bf16 v[140:143], a[40:43], v[40:43], v[140:143]
  buffer_load_dwordx4 v[68:71], v21, s[36:39], s52 offen offset:2048 sc1
  v_mfma_f32_16x16x32_bf16 v[144:147], a[44:47], v[40:43], v[144:147]
  v_mfma_f32_16x16x32_bf16 v[148:151], a[48:51], v[40:43], v[148:151]
  buffer_load_dwordx4 v[244:247], v2, s[36:39], s75 offen offset:1024 sc1
  v_mfma_f32_16x16x32_bf16 v[152:155], a[52:55], v[40:43], v[152:155]
  v_mfma_f32_16x16x32_bf16 v[156:159], a[56:59], v[40:43], v[156:159]
  s_waitcnt vmcnt(10)
  v_mfma_f32_16x16x32_bf16 v[140:143], a[60:63], v[44:47], v[140:143]
  buffer_load_dwordx4 v[72:75], v22, s[36:39], s52 offen offset:0 sc1
  v_mfma_f32_16x16x32_bf16 v[144:147], a[64:67], v[44:47], v[144:147]
  v_mfma_f32_16x16x32_bf16 v[148:151], a[68:71], v[44:47], v[148:151]
  v_mfma_f32_16x16x32_bf16 v[152:155], a[72:75], v[44:47], v[152:155]
  v_mfma_f32_16x16x32_bf16 v[156:159], a[76:79], v[44:47], v[156:159]
  s_waitcnt vmcnt(9)
  v_mfma_f32_16x16x32_bf16 v[140:143], a[80:83], v[48:51], v[140:143]
  buffer_load_dwordx4 v[76:79], v24, s[36:39], s52 offen offset:2048 sc1
  v_mfma_f32_16x16x32_bf16 v[144:147], a[84:87], v[48:51], v[144:147]
  v_mfma_f32_16x16x32_bf16 v[148:151], a[88:91], v[48:51], v[148:151]
  buffer_load_dwordx4 v[248:251], v2, s[36:39], s75 offen offset:2048 sc1
  v_mfma_f32_16x16x32_bf16 v[152:155], a[92:95], v[48:51], v[152:155]
  v_mfma_f32_16x16x32_bf16 v[156:159], a[96:99], v[48:51], v[156:159]
  s_waitcnt vmcnt(10)
  v_mfma_f32_16x16x32_bf16 v[140:143], a[100:103], v[52:55], v[140:143]
  buffer_load_dwordx4 v[32:35], v25, s[36:39], s52 offen offset:0 sc1
  v_mfma_f32_16x16x32_bf16 v[144:147], a[104:107], v[52:55], v[144:147]
  v_mfma_f32_16x16x32_bf16 v[148:151], a[108:111], v[52:55], v[148:151]
  v_mfma_f32_16x16x32_bf16 v[152:155], a[112:115], v[52:55], v[152:155]
  v_mfma_f32_16x16x32_bf16 v[156:159], a[116:119], v[52:55], v[156:159]
  s_waitcnt vmcnt(9)
  v_mfma_f32_16x16x32_bf16 v[140:143], a[120:123], v[56:59], v[140:143]
  buffer_load_dwordx4 v[36:39], v25, s[36:39], s52 offen offset:2048 sc1
  v_mfma_f32_16x16x32_bf16 v[144:147], a[124:127], v[56:59], v[144:147]
  v_mfma_f32_16x16x32_bf16 v[148:151], a[128:131], v[56:59], v[148:151]
  buffer_load_dwordx4 v[252:255], v2, s[36:39], s75 offen offset:3072 sc1
  v_mfma_f32_16x16x32_bf16 v[152:155], a[132:135], v[56:59], v[152:155]
  v_mfma_f32_16x16x32_bf16 v[156:159], a[136:139], v[56:59], v[156:159]
  s_waitcnt vmcnt(10)
  v_mfma_f32_16x16x32_bf16 v[140:143], a[140:143], v[60:63], v[140:143]
  buffer_load_dwordx4 v[40:43], v21, s[36:39], s53 offen offset:0 sc1
  v_mfma_f32_16x16x32_bf16 v[144:147], a[144:147], v[60:63], v[144:147]
  v_mfma_f32_16x16x32_bf16 v[148:151], a[148:151], v[60:63], v[148:151]
  v_mfma_f32_16x16x32_bf16 v[152:155], a[152:155], v[60:63], v[152:155]
  v_mfma_f32_16x16x32_bf16 v[156:159], a[156:159], v[60:63], v[156:159]
  s_waitcnt vmcnt(9)
  v_mfma_f32_16x16x32_bf16 v[80:83], a[160:163], v[64:67], v[80:83]
  buffer_load_dwordx4 v[44:47], v21, s[36:39], s53 offen offset:2048 sc1
  v_mfma_f32_16x16x32_bf16 v[84:87], a[164:167], v[64:67], v[84:87]
  v_mfma_f32_16x16x32_bf16 v[88:91], a[168:171], v[64:67], v[88:91]
  v_mfma_f32_16x16x32_bf16 v[92:95], a[172:175], v[64:67], v[92:95]
  v_mfma_f32_16x16x32_bf16 v[96:99], a[176:179], v[64:67], v[96:99]
  s_waitcnt vmcnt(9)
  v_mfma_f32_16x16x32_bf16 v[80:83], a[180:183], v[68:71], v[80:83]
  buffer_load_dwordx4 v[48:51], v22, s[36:39], s53 offen offset:0 sc1
  v_mfma_f32_16x16x32_bf16 v[84:87], a[184:187], v[68:71], v[84:87]
  v_mfma_f32_16x16x32_bf16 v[88:91], a[188:191], v[68:71], v[88:91]
  v_mfma_f32_16x16x32_bf16 v[92:95], a[192:195], v[68:71], v[92:95]
  v_mfma_f32_16x16x32_bf16 v[96:99], a[196:199], v[68:71], v[96:99]
  s_waitcnt vmcnt(8)
  v_mfma_f32_16x16x32_bf16 v[80:83], a[200:203], v[72:75], v[80:83]
  buffer_load_dwordx4 v[52:55], v24, s[36:39], s53 offen offset:2048 sc1
  v_mfma_f32_16x16x32_bf16 v[84:87], a[204:207], v[72:75], v[84:87]
  v_mfma_f32_16x16x32_bf16 v[88:91], a[208:211], v[72:75], v[88:91]
  v_mfma_f32_16x16x32_bf16 v[92:95], a[212:215], v[72:75], v[92:95]
  v_mfma_f32_16x16x32_bf16 v[96:99], a[216:219], v[72:75], v[96:99]
  s_waitcnt vmcnt(8)
  v_mfma_f32_16x16x32_bf16 v[80:83], a[220:223], v[76:79], v[80:83]
  buffer_load_dwordx4 v[56:59], v25, s[36:39], s53 offen offset:0 sc1
  v_mfma_f32_16x16x32_bf16 v[84:87], a[224:227], v[76:79], v[84:87]
  v_mfma_f32_16x16x32_bf16 v[88:91], a[228:231], v[76:79], v[88:91]
  v_mfma_f32_16x16x32_bf16 v[92:95], a[232:235], v[76:79], v[92:95]
  v_mfma_f32_16x16x32_bf16 v[96:99], a[236:239], v[76:79], v[96:99]
  s_waitcnt vmcnt(7)
  v_mfma_f32_16x16x32_bf16 v[80:83], a[240:243], v[32:35], v[80:83]
  buffer_load_dwordx4 v[60:63], v25, s[36:39], s53 offen offset:2048 sc1
  v_mfma_f32_16x16x32_bf16 v[84:87], a[244:247], v[32:35], v[84:87]
  v_mfma_f32_16x16x32_bf16 v[88:91], a[248:251], v[32:35], v[88:91]
  v_mfma_f32_16x16x32_bf16 v[92:95], a[252:255], v[32:35], v[92:95]
  v_mfma_f32_16x16x32_bf16 v[96:99], v[232:235], v[32:35], v[96:99]
  s_waitcnt vmcnt(6)
  v_mfma_f32_16x16x32_bf16 v[80:83], v[236:239], v[36:39], v[80:83]
  buffer_load_dwordx4 v[64:67], v21, s[36:39], s54 offen offset:0 sc1
  v_mfma_f32_16x16x32_bf16 v[84:87], v[240:243], v[36:39], v[84:87]
  v_mfma_f32_16x16x32_bf16 v[88:91], v[244:247], v[36:39], v[88:91]
  v_mfma_f32_16x16x32_bf16 v[92:95], v[248:251], v[36:39], v[92:95]
  v_mfma_f32_16x16x32_bf16 v[96:99], v[252:255], v[36:39], v[96:99]
  s_waitcnt vmcnt(6)
  s_waitcnt lgkmcnt(0)
  s_barrier
  v_mfma_f32_16x16x32_bf16 v[100:103], a[160:163], v[40:43], v[100:103]
  buffer_load_dwordx4 v[68:71], v21, s[36:39], s54 offen offset:2048 sc1
  v_mfma_f32_16x16x32_bf16 v[104:107], a[164:167], v[40:43], v[104:107]
  v_mfma_f32_16x16x32_bf16 v[108:111], a[168:171], v[40:43], v[108:111]
  ds_write_b128 v28, v[80:83] offset:0
  v_mfma_f32_16x16x32_bf16 v[112:115], a[172:175], v[40:43], v[112:115]
  v_mfma_f32_16x16x32_bf16 v[116:119], a[176:179], v[40:43], v[116:119]
  s_waitcnt vmcnt(6)
  v_mfma_f32_16x16x32_bf16 v[100:103], a[180:183], v[44:47], v[100:103]
  buffer_load_dwordx4 v[72:75], v22, s[36:39], s54 offen offset:0 sc1
  v_mfma_f32_16x16x32_bf16 v[104:107], a[184:187], v[44:47], v[104:107]
  v_mfma_f32_16x16x32_bf16 v[108:111], a[188:191], v[44:47], v[108:111]
  ds_write_b128 v28, v[84:87] offset:1024
  v_mfma_f32_16x16x32_bf16 v[112:115], a[192:195], v[44:47], v[112:115]
  v_mfma_f32_16x16x32_bf16 v[116:119], a[196:199], v[44:47], v[116:119]
  s_waitcnt vmcnt(6)
  v_mfma_f32_16x16x32_bf16 v[100:103], a[200:203], v[48:51], v[100:103]
  buffer_load_dwordx4 v[76:79], v24, s[36:39], s54 offen offset:2048 sc1
  v_mfma_f32_16x16x32_bf16 v[104:107], a[204:207], v[48:51], v[104:107]
  v_mfma_f32_16x16x32_bf16 v[108:111], a[208:211], v[48:51], v[108:111]
  ds_write_b128 v28, v[88:91] offset:2048
  v_mfma_f32_16x16x32_bf16 v[112:115], a[212:215], v[48:51], v[112:115]
  v_mfma_f32_16x16x32_bf16 v[116:119], a[216:219], v[48:51], v[116:119]
  s_waitcnt vmcnt(6)
  v_mfma_f32_16x16x32_bf16 v[100:103], a[220:223], v[52:55], v[100:103]
  buffer_load_dwordx4 v[32:35], v25, s[36:39], s54 offen offset:0 sc1
  v_mfma_f32_16x16x32_bf16 v[104:107], a[224:227], v[52:55], v[104:107]
  v_mfma_f32_16x16x32_bf16 v[108:111], a[228:231], v[52:55], v[108:111]
  ds_write_b128 v28, v[92:95] offset:3072
  v_mfma_f32_16x16x32_bf16 v[112:115], a[232:235], v[52:55], v[112:115]
  v_mfma_f32_16x16x32_bf16 v[116:119], a[236:239], v[52:55], v[116:119]
  s_waitcnt vmcnt(6)
  v_mfma_f32_16x16x32_bf16 v[100:103], a[240:243], v[56:59], v[100:103]
  buffer_load_dwordx4 v[36:39], v25, s[36:39], s54 offen offset:2048 sc1
  v_mfma_f32_16x16x32_bf16 v[104:107], a[244:247], v[56:59], v[104:107]
  v_mfma_f32_16x16x32_bf16 v[108:111], a[248:251], v[56:59], v[108:111]
  ds_write_b128 v28, v[96:99] offset:4096
  v_mfma_f32_16x16x32_bf16 v[112:115], a[252:255], v[56:59], v[112:115]
  v_mfma_f32_16x16x32_bf16 v[116:119], v[232:235], v[56:59], v[116:119]
  s_waitcnt vmcnt(6)
  v_mfma_f32_16x16x32_bf16 v[100:103], v[236:239], v[60:63], v[100:103]
  buffer_load_dwordx4 v[40:43], v21, s[36:39], s55 offen offset:0 sc1
  v_mfma_f32_16x16x32_bf16 v[104:107], v[240:243], v[60:63], v[104:107]
  v_mfma_f32_16x16x32_bf16 v[108:111], v[244:247], v[60:63], v[108:111]
  v_mfma_f32_16x16x32_bf16 v[112:115], v[248:251], v[60:63], v[112:115]
  v_mfma_f32_16x16x32_bf16 v[116:119], v[252:255], v[60:63], v[116:119]
  s_waitcnt vmcnt(6)
  s_waitcnt lgkmcnt(0)
  s_barrier
  v_mfma_f32_16x16x32_bf16 v[120:123], a[160:163], v[64:67], v[120:123]
  buffer_load_dwordx4 v[44:47], v21, s[36:39], s55 offen offset:2048 sc1
  ds_read_b128 v[180:183], v31 offset:0
  v_mfma_f32_16x16x32_bf16 v[124:127], a[164:167], v[64:67], v[124:127]
  ds_read_b128 v[184:187], v31 offset:1024
  ds_read_b128 v[188:191], v31 offset:2048
  v_mfma_f32_16x16x32_bf16 v[128:131], a[168:171], v[64:67], v[128:131]
  ds_write_b128 v29, v[100:103] offset:0
  v_mfma_f32_16x16x32_bf16 v[132:135], a[172:175], v[64:67], v[132:135]
  ds_read_b128 v[192:195], v31 offset:3072
  ds_read_b128 v[196:199], v31 offset:4096
  v_mfma_f32_16x16x32_bf16 v[136:139], a[176:179], v[64:67], v[136:139]
  s_waitcnt vmcnt(6)
  v_mfma_f32_16x16x32_bf16 v[120:123], a[180:183], v[68:71], v[120:123]
  buffer_load_dwordx4 v[48:51], v22, s[36:39], s55 offen offset:0 sc1
  v_mfma_f32_16x16x32_bf16 v[124:127], a[184:187], v[68:71], v[124:127]
  s_waitcnt lgkmcnt(5)
  v_fmac_f32 v160, s16, v180
  v_mfma_f32_16x16x32_bf16 v[128:131], a[188:191], v[68:71], v[128:131]
  ds_write_b128 v29, v[104:107] offset:1024
  v_mfma_f32_16x16x32_bf16 v[132:135], a[192:195], v[68:71], v[132:135]
  v_fmac_f32 v161, s16, v181
  v_fmac_f32 v162, s16, v182
  v_mfma_f32_16x16x32_bf16 v[136:139], a[196:199], v[68:71], v[136:139]
  s_waitcnt vmcnt(6)
  v_fmac_f32 v163, s16, v183
  v_mfma_f32_16x16x32_bf16 v[120:123], a[200:203], v[72:75], v[120:123]
  buffer_load_dwordx4 v[52:55], v24, s[36:39], s55 offen offset:2048 sc1
  s_waitcnt lgkmcnt(5)
  v_fmac_f32 v164, s16, v184
  v_mfma_f32_16x16x32_bf16 v[124:127], a[204:207], v[72:75], v[124:127]
  v_fmac_f32 v165, s16, v185
  v_fmac_f32 v166, s16, v186
  v_mfma_f32_16x16x32_bf16 v[128:131], a[208:211], v[72:75], v[128:131]
  ds_write_b128 v29, v[108:111] offset:2048
  v_mfma_f32_16x16x32_bf16 v[132:135], a[212:215], v[72:75], v[132:135]
  v_fmac_f32 v167, s16, v187
  s_waitcnt lgkmcnt(5)
  v_fmac_f32 v168, s16, v188
  v_mfma_f32_16x16x32_bf16 v[136:139], a[216:219], v[72:75], v[136:139]
  s_waitcnt vmcnt(6)
  v_fmac_f32 v169, s16, v189
  v_mfma_f32_16x16x32_bf16 v[120:123], a[220:223], v[76:79], v[120:123]
  buffer_load_dwordx4 v[56:59], v25, s[36:39], s55 offen offset:0 sc1
  v_fmac_f32 v170, s16, v190
  v_mfma_f32_16x16x32_bf16 v[124:127], a[224:227], v[76:79], v[124:127]
  v_fmac_f32 v171, s16, v191
  s_waitcnt lgkmcnt(3)
  v_fmac_f32 v172, s16, v192
  v_mfma_f32_16x16x32_bf16 v[128:131], a[228:231], v[76:79], v[128:131]
  ds_write_b128 v29, v[112:115] offset:3072
  v_mfma_f32_16x16x32_bf16 v[132:135], a[232:235], v[76:79], v[132:135]
  v_fmac_f32 v173, s16, v193
  v_fmac_f32 v174, s16, v194
  v_mfma_f32_16x16x32_bf16 v[136:139], a[236:239], v[76:79], v[136:139]
  s_waitcnt vmcnt(6)
  v_fmac_f32 v175, s16, v195
  v_mfma_f32_16x16x32_bf16 v[120:123], a[240:243], v[32:35], v[120:123]
  buffer_load_dwordx4 v[60:63], v25, s[36:39], s55 offen offset:2048 sc1
  s_waitcnt lgkmcnt(3)
  v_fmac_f32 v176, s16, v196
  v_mfma_f32_16x16x32_bf16 v[124:127], a[244:247], v[32:35], v[124:127]
  v_fmac_f32 v177, s16, v197
  v_fmac_f32 v178, s16, v198
  v_mfma_f32_16x16x32_bf16 v[128:131], a[248:251], v[32:35], v[128:131]
  ds_write_b128 v29, v[116:119] offset:4096
  v_mfma_f32_16x16x32_bf16 v[132:135], a[252:255], v[32:35], v[132:135]
  v_fmac_f32 v179, s16, v199
  v_mfma_f32_16x16x32_bf16 v[136:139], v[232:235], v[32:35], v[136:139]
  s_waitcnt vmcnt(6)
  v_mfma_f32_16x16x32_bf16 v[120:123], v[236:239], v[36:39], v[120:123]
  v_mfma_f32_16x16x32_bf16 v[124:127], v[240:243], v[36:39], v[124:127]
  v_mfma_f32_16x16x32_bf16 v[128:131], v[244:247], v[36:39], v[128:131]
  v_mfma_f32_16x16x32_bf16 v[132:135], v[248:251], v[36:39], v[132:135]
  v_mfma_f32_16x16x32_bf16 v[136:139], v[252:255], v[36:39], v[136:139]
  s_waitcnt vmcnt(5)
  s_waitcnt lgkmcnt(0)
  s_barrier
  v_mfma_f32_16x16x32_bf16 v[140:143], a[160:163], v[40:43], v[140:143]
  ds_read_b128 v[200:203], v31 offset:5120
  ds_read_b128 v[204:207], v31 offset:6144
  v_mfma_f32_16x16x32_bf16 v[144:147], a[164:167], v[40:43], v[144:147]
  ds_read_b128 v[208:211], v31 offset:7168
  ds_read_b128 v[212:215], v31 offset:8192
  v_mfma_f32_16x16x32_bf16 v[148:151], a[168:171], v[40:43], v[148:151]
  ds_write_b128 v30, v[120:123] offset:0
  v_mfma_f32_16x16x32_bf16 v[152:155], a[172:175], v[40:43], v[152:155]
  ds_read_b128 v[216:219], v31 offset:9216
  v_mfma_f32_16x16x32_bf16 v[156:159], a[176:179], v[40:43], v[156:159]
  s_waitcnt vmcnt(4)
  v_mfma_f32_16x16x32_bf16 v[140:143], a[180:183], v[44:47], v[140:143]
  ds_write_b128 v30, v[124:127] offset:1024
  v_mfma_f32_16x16x32_bf16 v[144:147], a[184:187], v[44:47], v[144:147]
  v_mfma_f32_16x16x32_bf16 v[148:151], a[188:191], v[44:47], v[148:151]
  s_waitcnt lgkmcnt(6)
  v_fmac_f32 v160, s16, v200
  v_mfma_f32_16x16x32_bf16 v[152:155], a[192:195], v[44:47], v[152:155]
  ds_write_b128 v30, v[128:131] offset:2048
  v_mfma_f32_16x16x32_bf16 v[156:159], a[196:199], v[44:47], v[156:159]
  s_waitcnt vmcnt(3)
  v_fmac_f32 v161, s16, v201
  v_mfma_f32_16x16x32_bf16 v[140:143], a[200:203], v[48:51], v[140:143]
  v_fmac_f32 v162, s16, v202
  v_fmac_f32 v163, s16, v203
  v_mfma_f32_16x16x32_bf16 v[144:147], a[204:207], v[48:51], v[144:147]
  ds_write_b128 v30, v[132:135] offset:3072
  v_mfma_f32_16x16x32_bf16 v[148:151], a[208:211], v[48:51], v[148:151]
  s_waitcnt lgkmcnt(7)
  v_fmac_f32 v164, s16, v204
  v_mfma_f32_16x16x32_bf16 v[152:155], a[212:215], v[48:51], v[152:155]
  v_fmac_f32 v165, s16, v205
  v_fmac_f32 v166, s16, v206
  v_mfma_f32_16x16x32_bf16 v[156:159], a[216:219], v[48:51], v[156:159]
  s_waitcnt vmcnt(2)
  ds_write_b128 v30, v[136:139] offset:4096
  v_mfma_f32_16x16x32_bf16 v[140:143], a[220:223], v[52:55], v[140:143]
  v_fmac_f32 v167, s16, v207
  s_waitcnt lgkmcnt(7)
  v_fmac_f32 v168, s16, v208
  v_mfma_f32_16x16x32_bf16 v[144:147], a[224:227], v[52:55], v[144:147]
  v_fmac_f32 v169, s16, v209
  v_fmac_f32 v170, s16, v210
  v_mfma_f32_16x16x32_bf16 v[148:151], a[228:231], v[52:55], v[148:151]
  s_waitcnt lgkmcnt(0)
  s_barrier
  ds_read_b128 v[180:183], v31 offset:10240
  ds_read_b128 v[184:187], v31 offset:11264
  ds_read_b128 v[188:191], v31 offset:12288
  ds_read_b128 v[192:195], v31 offset:13312
  ds_read_b128 v[196:199], v31 offset:14336
  v_mfma_f32_16x16x32_bf16 v[152:155], a[232:235], v[52:55], v[152:155]
  v_fmac_f32 v171, s16, v211
  v_fmac_f32 v172, s16, v212
  v_mfma_f32_16x16x32_bf16 v[156:159], a[236:239], v[52:55], v[156:159]
  s_waitcnt vmcnt(1)
  v_fmac_f32 v173, s16, v213
  v_mfma_f32_16x16x32_bf16 v[140:143], a[240:243], v[56:59], v[140:143]
  v_fmac_f32 v174, s16, v214
  v_fmac_f32 v175, s16, v215
  v_mfma_f32_16x16x32_bf16 v[144:147], a[244:247], v[56:59], v[144:147]
  v_fmac_f32 v176, s16, v216
  v_fmac_f32 v177, s16, v217
  v_mfma_f32_16x16x32_bf16 v[148:151], a[248:251], v[56:59], v[148:151]
  v_fmac_f32 v178, s16, v218
  v_fmac_f32 v179, s16, v219
  v_mfma_f32_16x16x32_bf16 v[152:155], a[252:255], v[56:59], v[152:155]
  v_mfma_f32_16x16x32_bf16 v[156:159], v[232:235], v[56:59], v[156:159]
  s_waitcnt vmcnt(0)
  v_mfma_f32_16x16x32_bf16 v[140:143], v[236:239], v[60:63], v[140:143]
  v_mfma_f32_16x16x32_bf16 v[144:147], v[240:243], v[60:63], v[144:147]
  v_mfma_f32_16x16x32_bf16 v[148:151], v[244:247], v[60:63], v[148:151]
  v_mfma_f32_16x16x32_bf16 v[152:155], v[248:251], v[60:63], v[152:155]
  v_mfma_f32_16x16x32_bf16 v[156:159], v[252:255], v[60:63], v[156:159]
  s_waitcnt lgkmcnt(4)
  s_nop 2
  v_pk_add_f32 v[140:141], v[140:141], v[180:181]
  v_pk_add_f32 v[142:143], v[142:143], v[182:183]
  s_waitcnt lgkmcnt(3)
  v_pk_add_f32 v[144:145], v[144:145], v[184:185]
  v_pk_add_f32 v[146:147], v[146:147], v[186:187]
  v_pk_fma_f32 v[140:141], v[140:141], s[16:17], v[160:161]
  v_pk_fma_f32 v[142:143], v[142:143], s[16:17], v[162:163]
  v_pk_fma_f32 v[144:145], v[144:145], s[16:17], v[164:165]
  v_pk_fma_f32 v[146:147], v[146:147], s[16:17], v[166:167]
  v_cvt_pk_bf16_f32 v4, v140, v141
  v_cvt_pk_bf16_f32 v5, v142, v143
  v_cvt_pk_bf16_f32 v6, v144, v145
  v_cvt_pk_bf16_f32 v7, v146, v147
  buffer_store_dwordx4 v[4:7], v15, s[40:43], s70 offen offset:0
  s_waitcnt lgkmcnt(2)
  v_pk_add_f32 v[148:149], v[148:149], v[188:189]
  v_pk_add_f32 v[150:151], v[150:151], v[190:191]
  s_waitcnt lgkmcnt(1)
  v_pk_add_f32 v[152:153], v[152:153], v[192:193]
  v_pk_add_f32 v[154:155], v[154:155], v[194:195]
  v_pk_fma_f32 v[148:149], v[148:149], s[16:17], v[168:169]
  v_pk_fma_f32 v[150:151], v[150:151], s[16:17], v[170:171]
  v_pk_fma_f32 v[152:153], v[152:153], s[16:17], v[172:173]
  v_pk_fma_f32 v[154:155], v[154:155], s[16:17], v[174:175]
  v_cvt_pk_bf16_f32 v8, v148, v149
  v_cvt_pk_bf16_f32 v9, v150, v151
  v_cvt_pk_bf16_f32 v10, v152, v153
  v_cvt_pk_bf16_f32 v11, v154, v155
  buffer_store_dwordx4 v[8:11], v15, s[40:43], s70 offen offset:64
  s_waitcnt lgkmcnt(0)
  v_pk_add_f32 v[156:157], v[156:157], v[196:197]
  v_pk_add_f32 v[158:159], v[158:159], v[198:199]
  v_pk_fma_f32 v[156:157], v[156:157], s[16:17], v[176:177]
  v_pk_fma_f32 v[158:159], v[158:159], s[16:17], v[178:179]
  v_cvt_pk_bf16_f32 v12, v156, v157
  v_cvt_pk_bf16_f32 v13, v158, v159
  buffer_store_dwordx2 v[12:13], v3, s[40:43], s70 offen offset:128
L_end:
  s_endpgm
L_retry_12:
  s_mov_b32 s80, 65536
L_retry2_62:
  s_mov_b32 s75, 0
  buffer_load_dwordx4 v[160:163], v56, s[36:39], s75 offen offset:0 sc1
  buffer_load_dwordx4 v[164:167], v56, s[36:39], s75 offen offset:2048 sc1
  s_mov_b32 s75, 4096
  buffer_load_dwordx4 v[168:171], v56, s[36:39], s75 offen offset:0 sc1
  buffer_load_dwordx4 v[172:175], v56, s[36:39], s75 offen offset:2048 sc1
  s_mov_b32 s75, 8192
  buffer_load_dwordx4 v[176:179], v56, s[36:39], s75 offen offset:0 sc1
  s_waitcnt vmcnt(0)
  v_cmp_eq_u64 s[4:5], s[10:11], v[178:179]
  v_cmp_eq_u64 s[12:13], s[10:11], v[162:163]
  v_cmp_eq_u64 s[14:15], s[10:11], v[166:167]
  v_cmp_eq_u64 s[16:17], s[10:11], v[170:171]
  v_cmp_eq_u64 s[18:19], s[10:11], v[174:175]
  s_and_b64 s[4:5], s[4:5], s[12:13]
  s_and_b64 s[4:5], s[4:5], s[14:15]
  s_and_b64 s[4:5], s[4:5], s[16:17]
  s_and_b64 s[4:5], s[4:5], s[18:19]
  s_cmp_eq_u64 s[4:5], -1
  s_cbranch_scc1 L_back_13
  s_sub_u32 s80, s80, 1
  s_cmp_lg_u32 s80, 0
  s_cbranch_scc1 L_retry2_62
  s_branch L_back_13
L_ckr_14:
  s_mov_b32 s80, 65536
L_poll_63:
  buffer_load_dwordx2 v[58:59], v57, s[36:39], 0 offen offset:512 sc1
  s_waitcnt vmcnt(0)
  v_cmp_eq_u64 vcc, s[10:11], v[58:59]
  s_nop 1
  s_cmp_eq_u64 vcc, -1
  s_cbranch_scc1 L_polld_64
  s_sub_u32 s80, s80, 1
  s_cmp_lg_u32 s80, 0
  s_cbranch_scc1 L_poll_63
L_polld_64:
  s_branch L_ckb_15
L_retry_24:
  s_mov_b32 s80, 65536
L_retry2_65:
  s_mov_b32 s75, 0
  buffer_load_dwordx4 v[160:163], v56, s[36:39], s75 offen offset:0 sc1
  buffer_load_dwordx4 v[164:167], v56, s[36:39], s75 offen offset:2048 sc1
  s_mov_b32 s75, 4096
  buffer_load_dwordx4 v[168:171], v56, s[36:39], s75 offen offset:0 sc1
  buffer_load_dwordx4 v[172:175], v56, s[36:39], s75 offen offset:2048 sc1
  s_mov_b32 s75, 8192
  buffer_load_dwordx4 v[176:179], v56, s[36:39], s75 offen offset:0 sc1
  s_waitcnt vmcnt(0)
  v_cmp_eq_u64 s[4:5], s[10:11], v[178:179]
  v_cmp_eq_u64 s[12:13], s[10:11], v[162:163]
  v_cmp_eq_u64 s[14:15], s[10:11], v[166:167]
  v_cmp_eq_u64 s[16:17], s[10:11], v[170:171]
  v_cmp_eq_u64 s[18:19], s[10:11], v[174:175]
  s_and_b64 s[4:5], s[4:5], s[12:13]
  s_and_b64 s[4:5], s[4:5], s[14:15]
  s_and_b64 s[4:5], s[4:5], s[16:17]
  s_and_b64 s[4:5], s[4:5], s[18:19]
  s_cmp_eq_u64 s[4:5], -1
  s_cbranch_scc1 L_back_25
  s_sub_u32 s80, s80, 1
  s_cmp_lg_u32 s80, 0
  s_cbranch_scc1 L_retry2_65
  s_branch L_back_25
L_ckr_26:
  s_mov_b32 s80, 65536
L_poll_66:
  buffer_load_dwordx2 v[58:59], v57, s[36:39], 0 offen offset:512 sc1
  s_waitcnt vmcnt(0)
  v_cmp_eq_u64 vcc, s[10:11], v[58:59]
  s_nop 1
  s_cmp_eq_u64 vcc, -1
  s_cbranch_scc1 L_polld_67
  s_sub_u32 s80, s80, 1
  s_cmp_lg_u32 s80, 0
  s_cbranch_scc1 L_poll_66
L_polld_67:
  s_branch L_ckb_27
L_helper:
  s_mov_b32 s32, s8
  s_mov_b32 s33, s9
  s_mov_b32 s34, 819200
  s_mov_b32 s35, 131072
  s_mov_b32 s28, s12
  s_mov_b32 s29, s13
  s_mov_b32 s30, 2211840
  s_mov_b32 s31, 131072
  s_mov_b32 s8, -1
  s_mov_b32 s9, 0
  s_mov_b32 s76, 0
  v_lshrrev_b32 v60, 3, v1
  v_mul_u32_u24 v60, 3456, v60
  v_and_b32 v61, 7, v1
  v_lshl_add_u32 v32, v61, 4, v60
  v_add_u32 v33, 26624, v32
  v_add_u32 v34, 53248, v32
  v_add_u32 v35, 79872, v32
  v_add_u32 v36, 110592, v32
  v_lshrrev_b32 v60, 4, v1
  v_lshlrev_b32 v60, 3, v60
  v_bfe_u32 v61, v1, 2, 2
  v_add_u32 v60, v60, v61
  v_lshlrev_b32 v60, 7, v60
  s_lshl_b32 s73, s50, 5
  s_add_u32 s73, s73, 0
  v_add_u32 v60, s73, v60
  v_and_b32 v61, 3, v1
  v_lshl_add_u32 v38, v61, 3, v60
  s_mul_i32 s73, s76, -4864
  s_add_u32 s73, s73, 20480
  v_add_u32 v60, s73, v2
  v_mov_b32 v61, 2147483648
  v_cmp_gt_u32 vcc, 16, v1
  s_nop 1
  v_cndmask_b32 v27, v61, v60, vcc
  s_add_u32 s72, s22, 0
  s_cmp_ge_u32 s72, 27
  s_cselect_b32 s76, 1, 0
  s_cselect_b32 s73, 27, 0
  s_sub_u32 s72, s72, s73
  s_lshl_b32 s72, s72, 1
  s_lshr_b32 s73, s72, 1
  s_lshl_b32 s74, s76, 2
  s_add_u32 s74, s74, s50
  s_mul_i32 s74, s74, 138240
  s_lshl_b32 s52, s73, 7
  s_add_u32 s52, s52, s74
  s_lshl_b32 s73, s73, 2
  s_add_u32 s73, s73, s50
  s_mul_i32 s73, s73, 21504
  s_mul_i32 s74, s76, 5120
  s_add_u32 s73, s73, s74
  s_add_u32 s53, s73, 23216128
  s_cmp_lt_u32 s72, 54
  s_cselect_b32 s52, s52, 2147483648
  s_cselect_b32 s53, s53, 2147483648
  s_mul_i32 s73, s76, -4864
  s_add_u32 s54, s53, s73
  s_add_u32 m0, s46, 0
  s_nop 0
  buffer_load_dwordx4 v32, s[28:31], s52 offen offset:0 lds
  buffer_load_dwordx4 v33, s[28:31], s52 offen offset:1024 lds
  buffer_load_dwordx4 v34, s[28:31], s52 offen offset:2048 lds
  buffer_load_dwordx4 v35, s[28:31], s52 offen offset:3072 lds
  s_add_u32 m0, s46, 4096
  s_nop 0
  buffer_load_dwordx4 v36, s[28:31], s52 offen offset:0 lds
  s_add_u32 s72, s22, 16
  s_cmp_ge_u32 s72, 27
  s_cselect_b32 s76, 1, 0
  s_cselect_b32 s73, 27, 0
  s_sub_u32 s72, s72, s73
  s_lshl_b32 s72, s72, 1
  s_lshr_b32 s73, s72, 1
  s_lshl_b32 s74, s76, 2
  s_add_u32 s74, s74, s50
  s_mul_i32 s74, s74, 138240
  s_lshl_b32 s55, s73, 7
  s_add_u32 s55, s55, s74
  s_lshl_b32 s73, s73, 2
  s_add_u32 s73, s73, s50
  s_mul_i32 s73, s73, 21504
  s_mul_i32 s74, s76, 5120
  s_add_u32 s73, s73, s74
  s_add_u32 s56, s73, 23216128
  s_cmp_lt_u32 s72, 54
  s_cselect_b32 s55, s55, 2147483648
  s_cselect_b32 s56, s56, 2147483648
  s_mul_i32 s73, s76, -4864
  s_add_u32 s57, s56, s73
  s_add_u32 m0, s46, 20480
  s_nop 0
  buffer_load_dwordx4 v32, s[28:31], s55 offen offset:0 lds
  buffer_load_dwordx4 v33, s[28:31], s55 offen offset:1024 lds
  buffer_load_dwordx4 v34, s[28:31], s55 offen offset:2048 lds
  buffer_load_dwordx4 v35, s[28:31], s55 offen offset:3072 lds
  s_add_u32 m0, s46, 24576
  s_nop 0
  buffer_load_dwordx4 v36, s[28:31], s55 offen offset:0 lds
  v_add_u32 v60, 0, v1
  v_mul_u32_u24 v61, 1639, v60
  v_lshrrev_b32 v61, 16, v61
  v_mul_u32_u24 v61, 640, v61
  v_add_u32 v22, v61, v2
  v_add_u32 v60, 64, v1
  v_mul_u32_u24 v61, 1639, v60
  v_lshrrev_b32 v61, 16, v61
  v_mul_u32_u24 v61, 640, v61
  v_add_u32 v23, v61, v2
  v_add_u32 v60, 128, v1
  v_mul_u32_u24 v61, 1639, v60
  v_lshrrev_b32 v61, 16, v61
  v_mul_u32_u24 v61, 640, v61
  v_add_u32 v24, v61, v2
  v_add_u32 v60, 192, v1
  v_mul_u32_u24 v61, 1639, v60
  v_lshrrev_b32 v61, 16, v61
  v_mul_u32_u24 v61, 640, v61
  v_add_u32 v25, v61, v2
  v_add_u32 v60, 256, v1
  v_mul_u32_u24 v61, 1639, v60
  v_lshrrev_b32 v61, 16, v61
  v_mul_u32_u24 v61, 640, v61
  v_add_u32 v26, v61, v2
  v_add_u32 v26, 4096, v26
  v_lshrrev_b32 v60, 4, v1
  v_lshlrev_b32 v60, 3, v60
  v_bfe_u32 v61, v1, 2, 2
  v_add_u32 v60, v60, v61
  v_mul_u32_u24 v60, 640, v60
  s_mul_i32 s73, s50, 160
  s_add_u32 s73, s73, 0
  v_add_u32 v60, s73, v60
  v_and_b32 v61, 3, v1
  v_lshl_add_u32 v30, v61, 4, v60
  v_lshl_add_u32 v31, v61, 3, v60
  v_mov_b32 v44, 1065369472
  v_mov_b32 v45, 1065369472
  v_mov_b32 v46, 1065369472
  v_mov_b32 v47, 1065369472
  v_mov_b32 v54, 0
  v_mov_b32 v55, 0
  v_mov_b32 v70, 0
  v_mov_b32 v71, 0
  s_and_b32 s83, s49, 7
  s_mul_i32 s72, s83, 102400
  s_mul_i32 s73, s50, 25600
  s_add_u32 s72, s72, s73
  s_add_u32 s62, s72, 20185088
  s_and_b32 s72, s49, 15
  s_mul_i32 s72, s72, 7
  s_min_u32 s66, s72, 101
  s_bitcmp1_b32 s66, 0
  s_cselect_b32 s72, 3, 0
  s_cselect_b32 s73, 0, 4
  s_add_u32 s63, s66, s72
  s_add_u32 s69, s66, s73
  s_mul_i32 s72, s50, 3072
  s_min_u32 s45, s72, 8192
  s_mul_i32 s72, s69, 21504
  s_add_u32 s72, s72, s45
  s_add_u32 s44, s72, 23226368
  s_mul_i32 s67, s50, 14
  s_mul_i32 s72, s83, 54
  s_add_u32 s72, s72, s67
  s_mul_i32 s72, s72, 5120
  s_add_u32 s64, s72, 21004288
  s_cmp_eq_u32 s50, 3
  s_cselect_b32 s65, 2147483648, s64
  v_add_u32 v216, 32768, v29
  s_lshr_b32 s72, s49, 3
  s_lshl_b32 s72, s72, 1
  s_lshl_b32 s73, s48, 3
  s_add_u32 s72, s72, s73
  s_mul_i32 s82, s72, 274432
  s_lshl_b32 s72, s48, 11
  s_add_u32 s72, s72, 25821184
  v_and_b32 v57, 15, v1
  v_lshlrev_b32 v57, 5, v57
  v_add_u32 v57, s72, v57
  s_waitcnt vmcnt(10)
  v_readfirstlane_b32 s10, v254
  v_readfirstlane_b32 s11, v255
  s_getreg_b32 s4, hwreg(HW_REG_XCC_ID, 0, 4)
  s_add_u32 s10, s10, 2135587861
  s_addc_u32 s11, s11, 2654435769
  v_mov_b32 v250, s10
  v_mov_b32 v251, s11
  v_mov_b32 v252, s4
  v_mov_b32 v253, 0
  v_mov_b32 v254, s10
  v_mov_b32 v255, s11
  buffer_store_dwordx4 v[250:253], v29, s[36:39], 0 offen sc1
  v_lshlrev_b32 v56, 7, v0
  v_add_u32 v56, 25690112, v56
  s_lshl_b32 s72, s22, 5
  s_add_u32 s72, s72, 25821184
  v_lshlrev_b32 v60, 11, v0
  v_add_u32 v60, s72, v60
  v_mov_b32 v61, 2147483648
  v_cmp_gt_u32 vcc, 8, v0
  s_nop 1
  v_cndmask_b32 v216, v61, v60, vcc
  v_mov_b32 v220, 0
  v_mov_b32 v221, 0
  s_mov_b32 s81, 2147483648
  s_waitcnt vmcnt(6)
  s_barrier
  v_add_u32 v40, 0, v38
  ds_read_b64_tr_b16 v[80:81], v40 offset:0
  ds_read_b64_tr_b16 v[82:83], v40 offset:512
  ds_read_b64_tr_b16 v[84:85], v40 offset:4096
  ds_read_b64_tr_b16 v[86:87], v40 offset:4608
  ds_read_b64_tr_b16 v[88:89], v40 offset:8192
  ds_read_b64_tr_b16 v[90:91], v40 offset:8704
  ds_read_b64_tr_b16 v[92:93], v40 offset:12288
  ds_read_b64_tr_b16 v[94:95], v40 offset:12800
  ds_read_b64_tr_b16 v[96:97], v40 offset:16384
  ds_read_b64_tr_b16 v[98:99], v40 offset:16896
  s_add_u32 s72, s22, 32
  s_cmp_ge_u32 s72, 27
  s_cselect_b32 s76, 1, 0
  s_cselect_b32 s73, 27, 0
  s_sub_u32 s72, s72, s73
  s_lshl_b32 s72, s72, 1
  s_lshr_b32 s73, s72, 1
  s_lshl_b32 s74, s76, 2
  s_add_u32 s74, s74, s50
  s_mul_i32 s74, s74, 138240
  s_lshl_b32 s58, s73, 7
  s_add_u32 s58, s58, s74
  s_lshl_b32 s73, s73, 2
  s_add_u32 s73, s73, s50
  s_mul_i32 s73, s73, 21504
  s_mul_i32 s74, s76, 5120
  s_add_u32 s73, s73, s74
  s_add_u32 s59, s73, 23216128
  s_cmp_lt_u32 s72, 54
  s_cselect_b32 s58, s58, 2147483648
  s_cselect_b32 s59, s59, 2147483648
  s_mul_i32 s73, s76, -4864
  s_add_u32 s60, s59, s73
  s_add_u32 m0, s46, 40960
  s_nop 0
  buffer_load_dwordx4 v32, s[28:31], s58 offen offset:0 lds
  buffer_load_dwordx4 v33, s[28:31], s58 offen offset:1024 lds
  buffer_load_dwordx4 v34, s[28:31], s58 offen offset:2048 lds
  buffer_load_dwordx4 v35, s[28:31], s58 offen offset:3072 lds
  s_add_u32 m0, s46, 45056
  s_nop 0
  buffer_load_dwordx4 v36, s[28:31], s58 offen offset:0 lds
  s_waitcnt lgkmcnt(0)
  v_mfma_f32_16x16x32_bf16 v[48:51], v[44:47], v[80:83], 0
  v_mfma_f32_16x16x32_bf16 v[48:51], v[44:47], v[84:87], v[48:51]
  v_mfma_f32_16x16x32_bf16 v[48:51], v[44:47], v[88:91], v[48:51]
  v_mfma_f32_16x16x32_bf16 v[48:51], v[44:47], v[92:95], v[48:51]
  v_mfma_f32_16x16x32_bf16 v[48:51], v[44:47], v[96:99], v[48:51]
  buffer_store_dwordx4 v[80:83], v2, s[36:39], s53 offen offset:0 sc1
  buffer_store_dwordx4 v[84:87], v2, s[36:39], s53 offen offset:1024 sc1
  buffer_store_dwordx4 v[88:91], v2, s[36:39], s53 offen offset:2048 sc1
  buffer_store_dwordx4 v[92:95], v2, s[36:39], s53 offen offset:3072 sc1
  buffer_store_dwordx4 v[96:99], v28, s[36:39], s53 offen offset:0 sc1
  s_nop 2
  v_cvt_pk_bf16_f32 v53, v48, v54
  v_lshlrev_b32 v49, 16, v53
  v_sub_f32 v49, v48, v49
  v_cvt_pk_bf16_f32 v52, v48, v49
  buffer_store_dwordx4 v[52:55], v27, s[36:39], s54 offen sc1
  s_waitcnt vmcnt(12)
  s_barrier
  v_add_u32 v40, 20480, v38
  ds_read_b64_tr_b16 v[100:101], v40 offset:0
  ds_read_b64_tr_b16 v[102:103], v40 offset:512
  ds_read_b64_tr_b16 v[104:105], v40 offset:4096
  ds_read_b64_tr_b16 v[106:107], v40 offset:4608
  ds_read_b64_tr_b16 v[108:109], v40 offset:8192
  ds_read_b64_tr_b16 v[110:111], v40 offset:8704
  ds_read_b64_tr_b16 v[112:113], v40 offset:12288
  ds_read_b64_tr_b16 v[114:115], v40 offset:12800
  ds_read_b64_tr_b16 v[116:117], v40 offset:16384
  ds_read_b64_tr_b16 v[118:119], v40 offset:16896
  s_waitcnt lgkmcnt(0)
  v_mfma_f32_16x16x32_bf16 v[48:51], v[44:47], v[100:103], 0
  v_mfma_f32_16x16x32_bf16 v[48:51], v[44:47], v[104:107], v[48:51]
  v_mfma_f32_16x16x32_bf16 v[48:51], v[44:47], v[108:111], v[48:51]
  v_mfma_f32_16x16x32_bf16 v[48:51], v[44:47], v[112:115], v[48:51]
  v_mfma_f32_16x16x32_bf16 v[48:51], v[44:47], v[116:119], v[48:51]
  buffer_store_dwordx4 v[100:103], v2, s[36:39], s56 offen offset:0 sc1
  buffer_store_dwordx4 v[104:107], v2, s[36:39], s56 offen offset:1024 sc1
  buffer_store_dwordx4 v[108:111], v2, s[36:39], s56 offen offset:2048 sc1
  buffer_store_dwordx4 v[112:115], v2, s[36:39], s56 offen offset:3072 sc1
  buffer_store_dwordx4 v[116:119], v28, s[36:39], s56 offen offset:0 sc1
  s_nop 2
  v_cvt_pk_bf16_f32 v69, v48, v70
  v_lshlrev_b32 v49, 16, v69
  v_sub_f32 v49, v48, v49
  v_cvt_pk_bf16_f32 v68, v48, v49
  buffer_store_dwordx4 v[68:71], v27, s[36:39], s57 offen sc1
  s_cmp_lt_u32 s22, 6
  s_cbranch_scc1 L_hs1_68
  s_add_u32 s72, s22, 26
  s_and_b32 s73, s72, 1
  s_lshr_b32 s74, s72, 1
  s_mul_i32 s52, s74, 40960
  s_mul_i32 s53, s73, 640
  s_add_u32 s52, s52, s53
  s_mul_i32 s53, s50, 10240
  s_add_u32 s52, s52, s53
  s_lshl_b32 s73, s73, 2
  s_add_u32 s73, s73, s50
  s_mul_i32 s73, s73, 20
  s_add_u32 s73, s73, s74
  s_mul_i32 s73, s73, 5120
  s_add_u32 s53, s73, 20185088
  s_cmp_lt_u32 s72, 40
  s_cselect_b32 s52, s52, 2147483648
  s_cselect_b32 s53, s53, 2147483648
  s_mov_b32 s54, 2147483648
  s_add_u32 m0, s46, 61440
  s_nop 0
  buffer_load_dwordx4 v22, s[32:35], s52 offen offset:0 lds
  buffer_load_dwordx4 v23, s[32:35], s52 offen offset:1024 lds
  buffer_load_dwordx4 v24, s[32:35], s52 offen offset:2048 lds
  buffer_load_dwordx4 v25, s[32:35], s52 offen offset:3072 lds
  s_add_u32 m0, s46, 65536
  s_nop 0
  buffer_load_dwordx4 v26, s[32:35], s52 offen offset:0 lds
  s_branch L_hs2_69
L_hs1_68:
  s_add_u32 s72, s22, 48
  s_cmp_ge_u32 s72, 27
  s_cselect_b32 s76, 1, 0
  s_cselect_b32 s73, 27, 0
  s_sub_u32 s72, s72, s73
  s_lshl_b32 s72, s72, 1
  s_lshr_b32 s73, s72, 1
  s_lshl_b32 s74, s76, 2
  s_add_u32 s74, s74, s50
  s_mul_i32 s74, s74, 138240
  s_lshl_b32 s52, s73, 7
  s_add_u32 s52, s52, s74
  s_lshl_b32 s73, s73, 2
  s_add_u32 s73, s73, s50
  s_mul_i32 s73, s73, 21504
  s_mul_i32 s74, s76, 5120
  s_add_u32 s73, s73, s74
  s_add_u32 s53, s73, 23216128
  s_cmp_lt_u32 s72, 54
  s_cselect_b32 s52, s52, 2147483648
  s_cselect_b32 s53, s53, 2147483648
  s_mul_i32 s73, s76, -4864
  s_add_u32 s54, s53, s73
  s_add_u32 m0, s46, 61440
  s_nop 0
  buffer_load_dwordx4 v32, s[28:31], s52 offen offset:0 lds
  buffer_load_dwordx4 v33, s[28:31], s52 offen offset:1024 lds
  buffer_load_dwordx4 v34, s[28:31], s52 offen offset:2048 lds
  buffer_load_dwordx4 v35, s[28:31], s52 offen offset:3072 lds
  s_add_u32 m0, s46, 65536
  s_nop 0
  buffer_load_dwordx4 v36, s[28:31], s52 offen offset:0 lds
L_hs2_69:
  s_waitcnt vmcnt(17)
  s_waitcnt vmcnt(5)
  s_barrier
  buffer_store_dwordx2 v[254:255], v216, s[36:39], 0 offen offset:512 sc1
  v_add_u32 v40, 40960, v38
  ds_read_b64_tr_b16 v[80:81], v40 offset:0
  ds_read_b64_tr_b16 v[82:83], v40 offset:512
  ds_read_b64_tr_b16 v[84:85], v40 offset:4096
  ds_read_b64_tr_b16 v[86:87], v40 offset:4608
  ds_read_b64_tr_b16 v[88:89], v40 offset:8192
  ds_read_b64_tr_b16 v[90:91], v40 offset:8704
  ds_read_b64_tr_b16 v[92:93], v40 offset:12288
  ds_read_b64_tr_b16 v[94:95], v40 offset:12800
  ds_read_b64_tr_b16 v[96:97], v40 offset:16384
  ds_read_b64_tr_b16 v[98:99], v40 offset:16896
  s_add_u32 s72, s22, 0
  s_and_b32 s73, s72, 1
  s_lshr_b32 s74, s72, 1
  s_mul_i32 s55, s74, 40960
  s_mul_i32 s56, s73, 640
  s_add_u32 s55, s55, s56
  s_mul_i32 s56, s50, 10240
  s_add_u32 s55, s55, s56
  s_lshl_b32 s73, s73, 2
  s_add_u32 s73, s73, s50
  s_mul_i32 s73, s73, 20
  s_add_u32 s73, s73, s74
  s_mul_i32 s73, s73, 5120
  s_add_u32 s56, s73, 20185088
  s_cmp_lt_u32 s72, 40
  s_cselect_b32 s55, s55, 2147483648
  s_cselect_b32 s56, s56, 2147483648
  s_add_u32 m0, s46, 81920
  s_nop 0
  buffer_load_dwordx4 v22, s[32:35], s55 offen offset:0 lds
  buffer_load_dwordx4 v23, s[32:35], s55 offen offset:1024 lds
  buffer_load_dwordx4 v24, s[32:35], s55 offen offset:2048 lds
  buffer_load_dwordx4 v25, s[32:35], s55 offen offset:3072 lds
  s_add_u32 m0, s46, 86016
  s_nop 0
  buffer_load_dwordx4 v26, s[32:35], s55 offen offset:0 lds
  s_waitcnt lgkmcnt(0)
  v_mfma_f32_16x16x32_bf16 v[48:51], v[44:47], v[80:83], 0
  v_mfma_f32_16x16x32_bf16 v[48:51], v[44:47], v[84:87], v[48:51]
  v_mfma_f32_16x16x32_bf16 v[48:51], v[44:47], v[88:91], v[48:51]
  v_mfma_f32_16x16x32_bf16 v[48:51], v[44:47], v[92:95], v[48:51]
  v_mfma_f32_16x16x32_bf16 v[48:51], v[44:47], v[96:99], v[48:51]
  buffer_store_dwordx4 v[80:83], v2, s[36:39], s59 offen offset:0 sc1
  buffer_store_dwordx4 v[84:87], v2, s[36:39], s59 offen offset:1024 sc1
  buffer_store_dwordx4 v[88:91], v2, s[36:39], s59 offen offset:2048 sc1
  buffer_store_dwordx4 v[92:95], v2, s[36:39], s59 offen offset:3072 sc1
  buffer_store_dwordx4 v[96:99], v28, s[36:39], s59 offen offset:0 sc1
  s_nop 2
  v_cvt_pk_bf16_f32 v53, v48, v54
  v_lshlrev_b32 v49, 16, v53
  v_sub_f32 v49, v48, v49
  v_cvt_pk_bf16_f32 v52, v48, v49
  buffer_store_dwordx4 v[52:55], v27, s[36:39], s60 offen sc1
  s_waitcnt vmcnt(12)
  s_barrier
  s_cmp_lt_u32 s22, 6
  s_cbranch_scc1 L_hs1_70
  v_add_u32 v40, 61440, v30
  v_add_u32 v41, 61440, v31
  ds_read_b64_tr_b16 v[100:101], v40 offset:0
  ds_read_b64_tr_b16 v[102:103], v40 offset:2560
  ds_read_b64_tr_b16 v[104:105], v40 offset:8
  ds_read_b64_tr_b16 v[106:107], v40 offset:2568
  ds_read_b64_tr_b16 v[108:109], v40 offset:64
  ds_read_b64_tr_b16 v[110:111], v40 offset:2624
  ds_read_b64_tr_b16 v[112:113], v40 offset:72
  ds_read_b64_tr_b16 v[114:115], v40 offset:2632
  ds_read_b64_tr_b16 v[116:117], v41 offset:128
  ds_read_b64_tr_b16 v[118:119], v41 offset:2688
  s_branch L_hs2_71
L_hs1_70:
  v_add_u32 v40, 61440, v38
  ds_read_b64_tr_b16 v[100:101], v40 offset:0
  ds_read_b64_tr_b16 v[102:103], v40 offset:512
  ds_read_b64_tr_b16 v[104:105], v40 offset:4096
  ds_read_b64_tr_b16 v[106:107], v40 offset:4608
  ds_read_b64_tr_b16 v[108:109], v40 offset:8192
  ds_read_b64_tr_b16 v[110:111], v40 offset:8704
  ds_read_b64_tr_b16 v[112:113], v40 offset:12288
  ds_read_b64_tr_b16 v[114:115], v40 offset:12800
  ds_read_b64_tr_b16 v[116:117], v40 offset:16384
  ds_read_b64_tr_b16 v[118:119], v40 offset:16896
L_hs2_71:
  s_waitcnt lgkmcnt(0)
  v_mfma_f32_16x16x32_bf16 v[48:51], v[44:47], v[100:103], 0
  v_mfma_f32_16x16x32_bf16 v[48:51], v[44:47], v[104:107], v[48:51]
  v_mfma_f32_16x16x32_bf16 v[48:51], v[44:47], v[108:111], v[48:51]
  v_mfma_f32_16x16x32_bf16 v[48:51], v[44:47], v[112:115], v[48:51]
  v_mfma_f32_16x16x32_bf16 v[48:51], v[44:47], v[116:119], v[48:51]
  buffer_store_dwordx4 v[100:103], v2, s[36:39], s53 offen offset:0 sc1
  buffer_store_dwordx4 v[104:107], v2, s[36:39], s53 offen offset:1024 sc1
  buffer_store_dwordx4 v[108:111], v2, s[36:39], s53 offen offset:2048 sc1
  buffer_store_dwordx4 v[112:115], v2, s[36:39], s53 offen offset:3072 sc1
  buffer_store_dwordx4 v[116:119], v28, s[36:39], s53 offen offset:0 sc1
  s_nop 2
  v_cvt_pk_bf16_f32 v69, v48, v70
  v_lshlrev_b32 v49, 16, v69
  v_sub_f32 v49, v48, v49
  v_cvt_pk_bf16_f32 v68, v48, v49
  buffer_store_dwordx4 v[68:71], v27, s[36:39], s54 offen sc1
  s_add_u32 s72, s22, 16
  s_and_b32 s73, s72, 1
  s_lshr_b32 s74, s72, 1
  s_mul_i32 s58, s74, 40960
  s_mul_i32 s59, s73, 640
  s_add_u32 s58, s58, s59
  s_mul_i32 s59, s50, 10240
  s_add_u32 s58, s58, s59
  s_lshl_b32 s73, s73, 2
  s_add_u32 s73, s73, s50
  s_mul_i32 s73, s73, 20
  s_add_u32 s73, s73, s74
  s_mul_i32 s73, s73, 5120
  s_add_u32 s59, s73, 20185088
  s_cmp_lt_u32 s72, 40
  s_cselect_b32 s58, s58, 2147483648
  s_cselect_b32 s59, s59, 2147483648
  s_add_u32 m0, s46, 102400
  s_nop 0
  buffer_load_dwordx4 v22, s[32:35], s58 offen offset:0 lds
  buffer_load_dwordx4 v23, s[32:35], s58 offen offset:1024 lds
  buffer_load_dwordx4 v24, s[32:35], s58 offen offset:2048 lds
  buffer_load_dwordx4 v25, s[32:35], s58 offen offset:3072 lds
  s_add_u32 m0, s46, 106496
  s_nop 0
  buffer_load_dwordx4 v26, s[32:35], s58 offen offset:0 lds
  s_waitcnt vmcnt(17)
  s_waitcnt vmcnt(5)
  s_barrier
  buffer_store_dwordx2 v[254:255], v216, s[36:39], 0 offen sc1
  v_add_u32 v40, 81920, v30
  v_add_u32 v41, 81920, v31
  ds_read_b64_tr_b16 v[80:81], v40 offset:0
  ds_read_b64_tr_b16 v[82:83], v40 offset:2560
  ds_read_b64_tr_b16 v[84:85], v40 offset:8
  ds_read_b64_tr_b16 v[86:87], v40 offset:2568
  ds_read_b64_tr_b16 v[88:89], v40 offset:64
  ds_read_b64_tr_b16 v[90:91], v40 offset:2624
  ds_read_b64_tr_b16 v[92:93], v40 offset:72
  ds_read_b64_tr_b16 v[94:95], v40 offset:2632
  ds_read_b64_tr_b16 v[96:97], v41 offset:128
  ds_read_b64_tr_b16 v[98:99], v41 offset:2688
  s_waitcnt lgkmcnt(0)
  buffer_store_dwordx4 v[80:83], v2, s[36:39], s56 offen offset:0 sc1
  buffer_store_dwordx4 v[84:87], v2, s[36:39], s56 offen offset:1024 sc1
  buffer_store_dwordx4 v[88:91], v2, s[36:39], s56 offen offset:2048 sc1
  buffer_store_dwordx4 v[92:95], v2, s[36:39], s56 offen offset:3072 sc1
  buffer_store_dwordx4 v[96:99], v28, s[36:39], s56 offen offset:0 sc1
  buffer_load_dwordx2 v[64:65], v56, s[36:39], 0 offen sc1
  s_waitcnt vmcnt(7)
  s_barrier
  v_add_u32 v40, 102400, v30
  v_add_u32 v41, 102400, v31
  ds_read_b64_tr_b16 v[100:101], v40 offset:0
  ds_read_b64_tr_b16 v[102:103], v40 offset:2560
  ds_read_b64_tr_b16 v[104:105], v40 offset:8
  ds_read_b64_tr_b16 v[106:107], v40 offset:2568
  ds_read_b64_tr_b16 v[108:109], v40 offset:64
  ds_read_b64_tr_b16 v[110:111], v40 offset:2624
  ds_read_b64_tr_b16 v[112:113], v40 offset:72
  ds_read_b64_tr_b16 v[114:115], v40 offset:2632
  ds_read_b64_tr_b16 v[116:117], v41 offset:128
  ds_read_b64_tr_b16 v[118:119], v41 offset:2688
  s_waitcnt lgkmcnt(0)
  buffer_load_dwordx2 v[58:59], v57, s[36:39], 0 offen offset:0 sc1
  buffer_store_dwordx4 v[100:103], v2, s[36:39], s59 offen offset:0 sc1
  buffer_store_dwordx4 v[104:107], v2, s[36:39], s59 offen offset:1024 sc1
  buffer_store_dwordx4 v[108:111], v2, s[36:39], s59 offen offset:2048 sc1
  buffer_store_dwordx4 v[112:115], v2, s[36:39], s59 offen offset:3072 sc1
  buffer_store_dwordx4 v[116:119], v28, s[36:39], s59 offen offset:0 sc1
  s_sub_u32 s52, s82, 2195456
  s_cselect_b32 s52, 2147483648, s52
  s_sub_u32 s53, s82, 1921024
  s_cselect_b32 s53, 2147483648, s53
  s_sub_u32 s54, s82, 1646592
  s_cselect_b32 s54, 2147483648, s54
  s_sub_u32 s55, s82, 1372160
  s_cselect_b32 s55, 2147483648, s55
  s_sub_u32 s56, s82, 1097728
  s_cselect_b32 s56, 2147483648, s56
  s_sub_u32 s57, s82, 823296
  s_cselect_b32 s57, 2147483648, s57
  s_sub_u32 s58, s82, 548864
  s_cselect_b32 s58, 2147483648, s58
  s_sub_u32 s59, s82, 274432
  s_cselect_b32 s59, 2147483648, s59
  s_add_u32 s60, s82, 0
  s_add_u32 s61, s82, 274432
  s_lshl_b32 s72, s22, 8
  v_add_u32 v60, s72, v0
  v_mov_b32 v61, 25853952
  v_cmp_eq_u32 vcc, 8, v60
  v_add_u32 v216, 16384, v216
  s_nop 0
  v_cndmask_b32 v216, v216, v61, vcc
  s_waitcnt vmcnt(6)
  v_cmp_eq_u64 vcc, s[10:11], v[64:65]
  s_nop 1
  s_cmp_eq_u64 vcc, -1
  s_cbranch_scc0 L_ckr_72
L_ckb_73:
  s_waitcnt vmcnt(5)
  s_branch L_p1j
L_ckr_30:
  s_mov_b32 s80, 65536
L_poll_74:
  buffer_load_dwordx2 v[58:59], v57, s[36:39], 0 offen offset:0 sc1
  s_waitcnt vmcnt(0)
  v_cmp_eq_u64 vcc, s[10:11], v[58:59]
  s_nop 1
  s_cmp_eq_u64 vcc, -1
  s_cbranch_scc1 L_polld_75
  s_sub_u32 s80, s80, 1
  s_cmp_lg_u32 s80, 0
  s_cbranch_scc1 L_poll_74
L_polld_75:
  s_branch L_ckb_31
L_hw_32:
  s_mul_i32 s19, s50, 5120
  s_add_u32 m0, s19, 65536
  s_add_u32 s68, s63, s50
  s_mul_i32 s68, s68, 21504
  s_add_u32 s68, s68, 23216128
  buffer_load_dwordx4 v2, s[36:39], s68 offen offset:0 sc1 lds
  buffer_load_dwordx4 v2, s[36:39], s68 offen offset:1024 sc1 lds
  buffer_load_dwordx4 v2, s[36:39], s68 offen offset:2048 sc1 lds
  buffer_load_dwordx4 v2, s[36:39], s68 offen offset:3072 sc1 lds
  s_add_u32 m0, m0, 4096
  s_add_u32 s68, s68, 4096
  buffer_load_dwordx4 v2, s[36:39], s68 offen offset:0 sc1 lds
  s_min_u32 s68, s50, 2
  s_mul_i32 s19, s68, 5120
  s_add_u32 m0, s19, 86016
  s_add_u32 s68, s68, s69
  s_mul_i32 s68, s68, 21504
  s_add_u32 s68, s68, 23216128
  buffer_load_dwordx4 v2, s[36:39], s68 offen offset:0 sc1 lds
  buffer_load_dwordx4 v2, s[36:39], s68 offen offset:1024 sc1 lds
  buffer_load_dwordx4 v2, s[36:39], s68 offen offset:2048 sc1 lds
  s_branch L_hwb_33
L_ckr_34:
  s_mov_b32 s80, 65536
L_poll_76:
  buffer_load_dwordx2 v[150:151], v189, s[36:39], 0 offen offset:0 sc1
  s_waitcnt vmcnt(0)
  v_cmp_eq_u64 vcc, s[10:11], v[150:151]
  s_nop 1
  s_cmp_eq_u64 vcc, -1
  s_cbranch_scc1 L_polld_77
  s_sub_u32 s80, s80, 1
  s_cmp_lg_u32 s80, 0
  s_cbranch_scc1 L_poll_76
L_polld_77:
  s_branch L_ckb_35
L_ckr_36:
  s_mov_b32 s80, 65536
L_poll_78:
  buffer_load_dwordx2 v[158:159], v191, s[36:39], 0 offen offset:0 sc1
  s_waitcnt vmcnt(0)
  v_cmp_eq_u64 vcc, s[10:11], v[158:159]
  s_nop 1
  s_cmp_eq_u64 vcc, -1
  s_cbranch_scc1 L_polld_79
  s_sub_u32 s80, s80, 1
  s_cmp_lg_u32 s80, 0
  s_cbranch_scc1 L_poll_78
L_polld_79:
  s_branch L_ckb_37
L_stw_40:
  buffer_store_dwordx4 v[72:75], v183, s[36:39], s61 offen offset:0 sc1
  buffer_store_dwordx4 v[64:67], v183, s[36:39], s60 offen offset:0 sc1
  buffer_store_dwordx2 v[68:69], v184, s[36:39], s60 offen offset:0 sc1
  s_branch L_ste_41
L_stw_42:
  buffer_store_dwordx2 v[222:223], v14, s[36:39], 0 offen offset:0 sc1
  s_branch L_ste_43
L_ckr_44:
  s_mov_b32 s80, 65536
L_poll_80:
  buffer_load_dwordx2 v[16:17], v18, s[36:39], 0 offen offset:0 sc1
  s_waitcnt vmcnt(0)
  v_cmp_eq_u64 vcc, s[10:11], v[16:17]
  s_nop 1
  s_cmp_eq_u64 vcc, -1
  s_cbranch_scc1 L_polld_81
  s_sub_u32 s80, s80, 1
  s_cmp_lg_u32 s80, 0
  s_cbranch_scc1 L_poll_80
L_polld_81:
  s_branch L_ckb_45
L_stw_46:
  buffer_store_dwordx4 v[4:7], v20, s[36:39], s76 offen offset:0 sc1
  buffer_store_dwordx4 v[8:11], v20, s[36:39], s76 offen offset:2048 sc1
  buffer_store_dwordx2 v[12:13], v26, s[36:39], s76 offen offset:0 sc1
  s_branch L_ste_47
L_stw_48:
  buffer_store_dwordx2 v[24:25], v27, s[36:39], s77 offen offset:0 sc1
  s_branch L_ste_49
L_stw_50:
  buffer_store_dwordx2 v[222:223], v14, s[36:39], 0 offen offset:32 sc1
  s_branch L_ste_51
L_stw_54:
  buffer_store_dwordx2 v[222:223], v14, s[36:39], 0 offen offset:96 sc1
  s_branch L_ste_55
L_ckr_56:
  s_mov_b32 s80, 65536
L_poll_82:
  buffer_load_dwordx2 v[224:225], v220, s[36:39], 0 offen offset:96 sc1
  s_waitcnt vmcnt(0)
  v_cmp_eq_u64 s[4:5], s[10:11], v[224:225]
  s_nop 1
  s_cmp_eq_u64 s[4:5], -1
  s_cbranch_scc1 L_polld_83
  s_sub_u32 s80, s80, 1
  s_cmp_lg_u32 s80, 0
  s_cbranch_scc1 L_poll_82
L_polld_83:
  s_branch L_ckb_57
L_stw_58:
  buffer_store_dwordx2 v[222:223], v14, s[36:39], 0 offen offset:64 sc1
  s_branch L_ste_59
L_ckr_60:
  s_mov_b32 s80, 65536
L_poll_84:
  buffer_load_dwordx2 v[16:17], v220, s[36:39], 0 offen offset:64 sc1
  s_waitcnt vmcnt(0)
  v_cmp_eq_u64 s[4:5], s[10:11], v[16:17]
  s_nop 1
  s_cmp_eq_u64 s[4:5], -1
  s_cbranch_scc1 L_polld_85
  s_sub_u32 s80, s80, 1
  s_cmp_lg_u32 s80, 0
  s_cbranch_scc1 L_poll_84
L_polld_85:
  s_branch L_ckb_61
L_ckr_72:
  s_mov_b32 s80, 65536
L_poll_86:
  buffer_load_dwordx2 v[64:65], v56, s[36:39], 0 offen offset:0 sc1
  s_waitcnt vmcnt(0)
  v_cmp_eq_u64 vcc, s[10:11], v[64:65]
  s_nop 1
  s_cmp_eq_u64 vcc, -1
  s_cbranch_scc1 L_polld_87
  s_sub_u32 s80, s80, 1
  s_cmp_lg_u32 s80, 0
  s_cbranch_scc1 L_poll_86
L_polld_87:
  s_branch L_ckb_73
L_codeend:
L_max_38:
  v_mov_b32 v150, 4286578688
  v_mfma_f32_32x32x16_bf16 v[64:79], a[32:35], v[16:19], v[32:47]
  v_mfma_f32_32x32x8_bf16 v[64:79], a[48:49], v[24:25], v[64:79]
  s_nop 11
  v_max3_f32 v150, v150, v64, v65
  v_max3_f32 v150, v150, v66, v67
  v_max3_f32 v150, v150, v68, v69
  v_max3_f32 v150, v150, v70, v71
  v_max3_f32 v150, v150, v72, v73
  v_max3_f32 v150, v150, v74, v75
  v_max3_f32 v150, v150, v76, v77
  v_max3_f32 v150, v150, v78, v79
  s_cmp_eq_u32 s59, 2147483648
  s_cbranch_scc1 L_fbd_88
  v_mfma_f32_32x32x16_bf16 v[64:79], a[28:31], v[16:19], 0
  v_mfma_f32_32x32x8_bf16 v[64:79], a[46:47], v[26:27], v[64:79]
  s_nop 11
  v_max3_f32 v150, v150, v64, v65
  v_max3_f32 v150, v150, v66, v67
  v_max3_f32 v150, v150, v68, v69
  v_max3_f32 v150, v150, v70, v71
  v_max3_f32 v150, v150, v72, v73
  v_max3_f32 v150, v150, v74, v75
  v_max3_f32 v150, v150, v76, v77
  v_max3_f32 v150, v150, v78, v79
  s_cmp_eq_u32 s58, 2147483648
  s_cbranch_scc1 L_fbd_88
  v_mfma_f32_32x32x16_bf16 v[64:79], a[24:27], v[16:19], 0
  v_mfma_f32_32x32x8_bf16 v[64:79], a[46:47], v[24:25], v[64:79]
  s_nop 11
  v_max3_f32 v150, v150, v64, v65
  v_max3_f32 v150, v150, v66, v67
  v_max3_f32 v150, v150, v68, v69
  v_max3_f32 v150, v150, v70, v71
  v_max3_f32 v150, v150, v72, v73
  v_max3_f32 v150, v150, v74, v75
  v_max3_f32 v150, v150, v76, v77
  v_max3_f32 v150, v150, v78, v79
  s_cmp_eq_u32 s57, 2147483648
  s_cbranch_scc1 L_fbd_88
  v_mfma_f32_32x32x16_bf16 v[64:79], a[20:23], v[16:19], 0
  v_mfma_f32_32x32x8_bf16 v[64:79], a[44:45], v[26:27], v[64:79]
  s_nop 11
  v_max3_f32 v150, v150, v64, v65
  v_max3_f32 v150, v150, v66, v67
  v_max3_f32 v150, v150, v68, v69
  v_max3_f32 v150, v150, v70, v71
  v_max3_f32 v150, v150, v72, v73
  v_max3_f32 v150, v150, v74, v75
  v_max3_f32 v150, v150, v76, v77
  v_max3_f32 v150, v150, v78, v79
  s_cmp_eq_u32 s56, 2147483648
  s_cbranch_scc1 L_fbd_88
  v_mfma_f32_32x32x16_bf16 v[64:79], a[16:19], v[16:19], 0
  v_mfma_f32_32x32x8_bf16 v[64:79], a[44:45], v[24:25], v[64:79]
  s_nop 11
  v_max3_f32 v150, v150, v64, v65
  v_max3_f32 v150, v150, v66, v67
  v_max3_f32 v150, v150, v68, v69
  v_max3_f32 v150, v150, v70, v71
  v_max3_f32 v150, v150, v72, v73
  v_max3_f32 v150, v150, v74, v75
  v_max3_f32 v150, v150, v76, v77
  v_max3_f32 v150, v150, v78, v79
  s_cmp_eq_u32 s55, 2147483648
  s_cbranch_scc1 L_fbd_88
  v_mfma_f32_32x32x16_bf16 v[64:79], a[12:15], v[16:19], 0
  v_mfma_f32_32x32x8_bf16 v[64:79], a[42:43], v[26:27], v[64:79]
  s_nop 11
  v_max3_f32 v150, v150, v64, v65
  v_max3_f32 v150, v150, v66, v67
  v_max3_f32 v150, v150, v68, v69
  v_max3_f32 v150, v150, v70, v71
  v_max3_f32 v150, v150, v72, v73
  v_max3_f32 v150, v150, v74, v75
  v_max3_f32 v150, v150, v76, v77
  v_max3_f32 v150, v150, v78, v79
  s_cmp_eq_u32 s54, 2147483648
  s_cbranch_scc1 L_fbd_88
  v_mfma_f32_32x32x16_bf16 v[64:79], a[8:11], v[16:19], 0
  v_mfma_f32_32x32x8_bf16 v[64:79], a[42:43], v[24:25], v[64:79]
  s_nop 11
  v_max3_f32 v150, v150, v64, v65
  v_max3_f32 v150, v150, v66, v67
  v_max3_f32 v150, v150, v68, v69
  v_max3_f32 v150, v150, v70, v71
  v_max3_f32 v150, v150, v72, v73
  v_max3_f32 v150, v150, v74, v75
  v_max3_f32 v150, v150, v76, v77
  v_max3_f32 v150, v150, v78, v79
  s_cmp_eq_u32 s53, 2147483648
  s_cbranch_scc1 L_fbd_88
  v_mfma_f32_32x32x16_bf16 v[64:79], a[4:7], v[16:19], 0
  v_mfma_f32_32x32x8_bf16 v[64:79], a[40:41], v[26:27], v[64:79]
  s_nop 11
  v_max3_f32 v150, v150, v64, v65
  v_max3_f32 v150, v150, v66, v67
  v_max3_f32 v150, v150, v68, v69
  v_max3_f32 v150, v150, v70, v71
  v_max3_f32 v150, v150, v72, v73
  v_max3_f32 v150, v150, v74, v75
  v_max3_f32 v150, v150, v76, v77
  v_max3_f32 v150, v150, v78, v79
  s_cmp_eq_u32 s52, 2147483648
  s_cbranch_scc1 L_fbd_88
  v_mfma_f32_32x32x16_bf16 v[64:79], a[0:3], v[16:19], v[48:63]
  v_mfma_f32_32x32x8_bf16 v[64:79], a[40:41], v[24:25], v[64:79]
  s_nop 11
  v_max3_f32 v150, v150, v64, v65
  v_max3_f32 v150, v150, v66, v67
  v_max3_f32 v150, v150, v68, v69
  v_max3_f32 v150, v150, v70, v71
  v_max3_f32 v150, v150, v72, v73
  v_max3_f32 v150, v150, v74, v75
  v_max3_f32 v150, v150, v76, v77
  v_max3_f32 v150, v150, v78, v79
L_fbd_88:
  v_mov_b32 v151, v150
  s_nop 1
  v_permlane32_swap_b32 v150, v151
  v_max_f32 v150, v150, v151
  v_mfma_f32_32x32x16_bf16 v[64:79], a[32:35], v[16:19], v[32:47]
  v_mfma_f32_32x32x8_bf16 v[64:79], a[48:49], v[24:25], v[64:79]
  s_nop 11
  v_sub_f32 v64, v64, v150
  v_sub_f32 v65, v65, v150
  v_sub_f32 v66, v66, v150
  v_sub_f32 v67, v67, v150
  v_sub_f32 v68, v68, v150
  v_sub_f32 v69, v69, v150
  v_sub_f32 v70, v70, v150
  v_sub_f32 v71, v71, v150
  v_sub_f32 v72, v72, v150
  v_sub_f32 v73, v73, v150
  v_sub_f32 v74, v74, v150
  v_sub_f32 v75, v75, v150
  v_sub_f32 v76, v76, v150
  v_sub_f32 v77, v77, v150
  v_sub_f32 v78, v78, v150
  v_sub_f32 v79, v79, v150
  v_exp_f32 v64, v64
  v_exp_f32 v65, v65
  v_exp_f32 v66, v66
  v_exp_f32 v67, v67
  v_exp_f32 v68, v68
  v_exp_f32 v69, v69
  v_exp_f32 v70, v70
  v_exp_f32 v71, v71
  v_exp_f32 v72, v72
  v_exp_f32 v73, v73
  v_exp_f32 v74, v74
  v_exp_f32 v75, v75
  v_exp_f32 v76, v76
  v_exp_f32 v77, v77
  v_exp_f32 v78, v78
  v_exp_f32 v79, v79
  v_cvt_pk_bf16_f32 v96, v64, v65
  v_cvt_pk_bf16_f32 v97, v66, v67
  v_cvt_pk_bf16_f32 v98, v68, v69
  v_cvt_pk_bf16_f32 v99, v70, v71
  v_cvt_pk_bf16_f32 v100, v72, v73
  v_cvt_pk_bf16_f32 v101, v74, v75
  v_cvt_pk_bf16_f32 v102, v76, v77
  v_cvt_pk_bf16_f32 v103, v78, v79
  v_mfma_f32_32x32x16_bf16 v[112:127], a[114:117], v[96:99], 0
  s_nop 0
  v_mfma_f32_32x32x16_bf16 v[112:127], a[118:121], v[100:103], v[112:127]
  s_cmp_eq_u32 s59, 2147483648
  s_cbranch_scc1 L_fbd_89
  v_mfma_f32_32x32x16_bf16 v[64:79], a[28:31], v[16:19], 0
  v_mfma_f32_32x32x8_bf16 v[64:79], a[46:47], v[26:27], v[64:79]
  s_nop 11
  v_sub_f32 v64, v64, v150
  v_sub_f32 v65, v65, v150
  v_sub_f32 v66, v66, v150
  v_sub_f32 v67, v67, v150
  v_sub_f32 v68, v68, v150
  v_sub_f32 v69, v69, v150
  v_sub_f32 v70, v70, v150
  v_sub_f32 v71, v71, v150
  v_sub_f32 v72, v72, v150
  v_sub_f32 v73, v73, v150
  v_sub_f32 v74, v74, v150
  v_sub_f32 v75, v75, v150
  v_sub_f32 v76, v76, v150
  v_sub_f32 v77, v77, v150
  v_sub_f32 v78, v78, v150
  v_sub_f32 v79, v79, v150
  v_exp_f32 v64, v64
  v_exp_f32 v65, v65
  v_exp_f32 v66, v66
  v_exp_f32 v67, v67
  v_exp_f32 v68, v68
  v_exp_f32 v69, v69
  v_exp_f32 v70, v70
  v_exp_f32 v71, v71
  v_exp_f32 v72, v72
  v_exp_f32 v73, v73
  v_exp_f32 v74, v74
  v_exp_f32 v75, v75
  v_exp_f32 v76, v76
  v_exp_f32 v77, v77
  v_exp_f32 v78, v78
  v_exp_f32 v79, v79
  v_cvt_pk_bf16_f32 v96, v64, v65
  v_cvt_pk_bf16_f32 v97, v66, v67
  v_cvt_pk_bf16_f32 v98, v68, v69
  v_cvt_pk_bf16_f32 v99, v70, v71
  v_cvt_pk_bf16_f32 v100, v72, v73
  v_cvt_pk_bf16_f32 v101, v74, v75
  v_cvt_pk_bf16_f32 v102, v76, v77
  v_cvt_pk_bf16_f32 v103, v78, v79
  v_mfma_f32_32x32x16_bf16 v[112:127], a[106:109], v[96:99], v[112:127]
  s_nop 0
  v_mfma_f32_32x32x16_bf16 v[112:127], a[110:113], v[100:103], v[112:127]
  s_cmp_eq_u32 s58, 2147483648
  s_cbranch_scc1 L_fbd_89
  v_mfma_f32_32x32x16_bf16 v[64:79], a[24:27], v[16:19], 0
  v_mfma_f32_32x32x8_bf16 v[64:79], a[46:47], v[24:25], v[64:79]
  s_nop 11
  v_sub_f32 v64, v64, v150
  v_sub_f32 v65, v65, v150
  v_sub_f32 v66, v66, v150
  v_sub_f32 v67, v67, v150
  v_sub_f32 v68, v68, v150
  v_sub_f32 v69, v69, v150
  v_sub_f32 v70, v70, v150
  v_sub_f32 v71, v71, v150
  v_sub_f32 v72, v72, v150
  v_sub_f32 v73, v73, v150
  v_sub_f32 v74, v74, v150
  v_sub_f32 v75, v75, v150
  v_sub_f32 v76, v76, v150
  v_sub_f32 v77, v77, v150
  v_sub_f32 v78, v78, v150
  v_sub_f32 v79, v79, v150
  v_exp_f32 v64, v64
  v_exp_f32 v65, v65
  v_exp_f32 v66, v66
  v_exp_f32 v67, v67
  v_exp_f32 v68, v68
  v_exp_f32 v69, v69
  v_exp_f32 v70, v70
  v_exp_f32 v71, v71
  v_exp_f32 v72, v72
  v_exp_f32 v73, v73
  v_exp_f32 v74, v74
  v_exp_f32 v75, v75
  v_exp_f32 v76, v76
  v_exp_f32 v77, v77
  v_exp_f32 v78, v78
  v_exp_f32 v79, v79
  v_cvt_pk_bf16_f32 v96, v64, v65
  v_cvt_pk_bf16_f32 v97, v66, v67
  v_cvt_pk_bf16_f32 v98, v68, v69
  v_cvt_pk_bf16_f32 v99, v70, v71
  v_cvt_pk_bf16_f32 v100, v72, v73
  v_cvt_pk_bf16_f32 v101, v74, v75
  v_cvt_pk_bf16_f32 v102, v76, v77
  v_cvt_pk_bf16_f32 v103, v78, v79
  v_mfma_f32_32x32x16_bf16 v[112:127], a[98:101], v[96:99], v[112:127]
  s_nop 0
  v_mfma_f32_32x32x16_bf16 v[112:127], a[102:105], v[100:103], v[112:127]
  s_cmp_eq_u32 s57, 2147483648
  s_cbranch_scc1 L_fbd_89
  v_mfma_f32_32x32x16_bf16 v[64:79], a[20:23], v[16:19], 0
  v_mfma_f32_32x32x8_bf16 v[64:79], a[44:45], v[26:27], v[64:79]
  s_nop 11
  v_sub_f32 v64, v64, v150
  v_sub_f32 v65, v65, v150
  v_sub_f32 v66, v66, v150
  v_sub_f32 v67, v67, v150
  v_sub_f32 v68, v68, v150
  v_sub_f32 v69, v69, v150
  v_sub_f32 v70, v70, v150
  v_sub_f32 v71, v71, v150
  v_sub_f32 v72, v72, v150
  v_sub_f32 v73, v73, v150
  v_sub_f32 v74, v74, v150
  v_sub_f32 v75, v75, v150
  v_sub_f32 v76, v76, v150
  v_sub_f32 v77, v77, v150
  v_sub_f32 v78, v78, v150
  v_sub_f32 v79, v79, v150
  v_exp_f32 v64, v64
  v_exp_f32 v65, v65
  v_exp_f32 v66, v66
  v_exp_f32 v67, v67
  v_exp_f32 v68, v68
  v_exp_f32 v69, v69
  v_exp_f32 v70, v70
  v_exp_f32 v71, v71
  v_exp_f32 v72, v72
  v_exp_f32 v73, v73
  v_exp_f32 v74, v74
  v_exp_f32 v75, v75
  v_exp_f32 v76, v76
  v_exp_f32 v77, v77
  v_exp_f32 v78, v78
  v_exp_f32 v79, v79
  v_cvt_pk_bf16_f32 v96, v64, v65
  v_cvt_pk_bf16_f32 v97, v66, v67
  v_cvt_pk_bf16_f32 v98, v68, v69
  v_cvt_pk_bf16_f32 v99, v70, v71
  v_cvt_pk_bf16_f32 v100, v72, v73
  v_cvt_pk_bf16_f32 v101, v74, v75
  v_cvt_pk_bf16_f32 v102, v76, v77
  v_cvt_pk_bf16_f32 v103, v78, v79
  v_mfma_f32_32x32x16_bf16 v[112:127], a[90:93], v[96:99], v[112:127]
  s_nop 0
  v_mfma_f32_32x32x16_bf16 v[112:127], a[94:97], v[100:103], v[112:127]
  s_cmp_eq_u32 s56, 2147483648
  s_cbranch_scc1 L_fbd_89
  v_mfma_f32_32x32x16_bf16 v[64:79], a[16:19], v[16:19], 0
  v_mfma_f32_32x32x8_bf16 v[64:79], a[44:45], v[24:25], v[64:79]
  s_nop 11
  v_sub_f32 v64, v64, v150
  v_sub_f32 v65, v65, v150
  v_sub_f32 v66, v66, v150
  v_sub_f32 v67, v67, v150
  v_sub_f32 v68, v68, v150
  v_sub_f32 v69, v69, v150
  v_sub_f32 v70, v70, v150
  v_sub_f32 v71, v71, v150
  v_sub_f32 v72, v72, v150
  v_sub_f32 v73, v73, v150
  v_sub_f32 v74, v74, v150
  v_sub_f32 v75, v75, v150
  v_sub_f32 v76, v76, v150
  v_sub_f32 v77, v77, v150
  v_sub_f32 v78, v78, v150
  v_sub_f32 v79, v79, v150
  v_exp_f32 v64, v64
  v_exp_f32 v65, v65
  v_exp_f32 v66, v66
  v_exp_f32 v67, v67
  v_exp_f32 v68, v68
  v_exp_f32 v69, v69
  v_exp_f32 v70, v70
  v_exp_f32 v71, v71
  v_exp_f32 v72, v72
  v_exp_f32 v73, v73
  v_exp_f32 v74, v74
  v_exp_f32 v75, v75
  v_exp_f32 v76, v76
  v_exp_f32 v77, v77
  v_exp_f32 v78, v78
  v_exp_f32 v79, v79
  v_cvt_pk_bf16_f32 v96, v64, v65
  v_cvt_pk_bf16_f32 v97, v66, v67
  v_cvt_pk_bf16_f32 v98, v68, v69
  v_cvt_pk_bf16_f32 v99, v70, v71
  v_cvt_pk_bf16_f32 v100, v72, v73
  v_cvt_pk_bf16_f32 v101, v74, v75
  v_cvt_pk_bf16_f32 v102, v76, v77
  v_cvt_pk_bf16_f32 v103, v78, v79
  v_mfma_f32_32x32x16_bf16 v[112:127], a[82:85], v[96:99], v[112:127]
  s_nop 0
  v_mfma_f32_32x32x16_bf16 v[112:127], a[86:89], v[100:103], v[112:127]
  s_cmp_eq_u32 s55, 2147483648
  s_cbranch_scc1 L_fbd_89
  v_mfma_f32_32x32x16_bf16 v[64:79], a[12:15], v[16:19], 0
  v_mfma_f32_32x32x8_bf16 v[64:79], a[42:43], v[26:27], v[64:79]
  s_nop 11
  v_sub_f32 v64, v64, v150
  v_sub_f32 v65, v65, v150
  v_sub_f32 v66, v66, v150
  v_sub_f32 v67, v67, v150
  v_sub_f32 v68, v68, v150
  v_sub_f32 v69, v69, v150
  v_sub_f32 v70, v70, v150
  v_sub_f32 v71, v71, v150
  v_sub_f32 v72, v72, v150
  v_sub_f32 v73, v73, v150
  v_sub_f32 v74, v74, v150
  v_sub_f32 v75, v75, v150
  v_sub_f32 v76, v76, v150
  v_sub_f32 v77, v77, v150
  v_sub_f32 v78, v78, v150
  v_sub_f32 v79, v79, v150
  v_exp_f32 v64, v64
  v_exp_f32 v65, v65
  v_exp_f32 v66, v66
  v_exp_f32 v67, v67
  v_exp_f32 v68, v68
  v_exp_f32 v69, v69
  v_exp_f32 v70, v70
  v_exp_f32 v71, v71
  v_exp_f32 v72, v72
  v_exp_f32 v73, v73
  v_exp_f32 v74, v74
  v_exp_f32 v75, v75
  v_exp_f32 v76, v76
  v_exp_f32 v77, v77
  v_exp_f32 v78, v78
  v_exp_f32 v79, v79
  v_cvt_pk_bf16_f32 v96, v64, v65
  v_cvt_pk_bf16_f32 v97, v66, v67
  v_cvt_pk_bf16_f32 v98, v68, v69
  v_cvt_pk_bf16_f32 v99, v70, v71
  v_cvt_pk_bf16_f32 v100, v72, v73
  v_cvt_pk_bf16_f32 v101, v74, v75
  v_cvt_pk_bf16_f32 v102, v76, v77
  v_cvt_pk_bf16_f32 v103, v78, v79
  v_mfma_f32_32x32x16_bf16 v[112:127], a[74:77], v[96:99], v[112:127]
  s_nop 0
  v_mfma_f32_32x32x16_bf16 v[112:127], a[78:81], v[100:103], v[112:127]
  s_cmp_eq_u32 s54, 2147483648
  s_cbranch_scc1 L_fbd_89
  v_mfma_f32_32x32x16_bf16 v[64:79], a[8:11], v[16:19], 0
  v_mfma_f32_32x32x8_bf16 v[64:79], a[42:43], v[24:25], v[64:79]
  s_nop 11
  v_sub_f32 v64, v64, v150
  v_sub_f32 v65, v65, v150
  v_sub_f32 v66, v66, v150
  v_sub_f32 v67, v67, v150
  v_sub_f32 v68, v68, v150
  v_sub_f32 v69, v69, v150
  v_sub_f32 v70, v70, v150
  v_sub_f32 v71, v71, v150
  v_sub_f32 v72, v72, v150
  v_sub_f32 v73, v73, v150
  v_sub_f32 v74, v74, v150
  v_sub_f32 v75, v75, v150
  v_sub_f32 v76, v76, v150
  v_sub_f32 v77, v77, v150
  v_sub_f32 v78, v78, v150
  v_sub_f32 v79, v79, v150
  v_exp_f32 v64, v64
  v_exp_f32 v65, v65
  v_exp_f32 v66, v66
  v_exp_f32 v67, v67
  v_exp_f32 v68, v68
  v_exp_f32 v69, v69
  v_exp_f32 v70, v70
  v_exp_f32 v71, v71
  v_exp_f32 v72, v72
  v_exp_f32 v73, v73
  v_exp_f32 v74, v74
  v_exp_f32 v75, v75
  v_exp_f32 v76, v76
  v_exp_f32 v77, v77
  v_exp_f32 v78, v78
  v_exp_f32 v79, v79
  v_cvt_pk_bf16_f32 v96, v64, v65
  v_cvt_pk_bf16_f32 v97, v66, v67
  v_cvt_pk_bf16_f32 v98, v68, v69
  v_cvt_pk_bf16_f32 v99, v70, v71
  v_cvt_pk_bf16_f32 v100, v72, v73
  v_cvt_pk_bf16_f32 v101, v74, v75
  v_cvt_pk_bf16_f32 v102, v76, v77
  v_cvt_pk_bf16_f32 v103, v78, v79
  v_mfma_f32_32x32x16_bf16 v[112:127], a[66:69], v[96:99], v[112:127]
  s_nop 0
  v_mfma_f32_32x32x16_bf16 v[112:127], a[70:73], v[100:103], v[112:127]
  s_cmp_eq_u32 s53, 2147483648
  s_cbranch_scc1 L_fbd_89
  v_mfma_f32_32x32x16_bf16 v[64:79], a[4:7], v[16:19], 0
  v_mfma_f32_32x32x8_bf16 v[64:79], a[40:41], v[26:27], v[64:79]
  s_nop 11
  v_sub_f32 v64, v64, v150
  v_sub_f32 v65, v65, v150
  v_sub_f32 v66, v66, v150
  v_sub_f32 v67, v67, v150
  v_sub_f32 v68, v68, v150
  v_sub_f32 v69, v69, v150
  v_sub_f32 v70, v70, v150
  v_sub_f32 v71, v71, v150
  v_sub_f32 v72, v72, v150
  v_sub_f32 v73, v73, v150
  v_sub_f32 v74, v74, v150
  v_sub_f32 v75, v75, v150
  v_sub_f32 v76, v76, v150
  v_sub_f32 v77, v77, v150
  v_sub_f32 v78, v78, v150
  v_sub_f32 v79, v79, v150
  v_exp_f32 v64, v64
  v_exp_f32 v65, v65
  v_exp_f32 v66, v66
  v_exp_f32 v67, v67
  v_exp_f32 v68, v68
  v_exp_f32 v69, v69
  v_exp_f32 v70, v70
  v_exp_f32 v71, v71
  v_exp_f32 v72, v72
  v_exp_f32 v73, v73
  v_exp_f32 v74, v74
  v_exp_f32 v75, v75
  v_exp_f32 v76, v76
  v_exp_f32 v77, v77
  v_exp_f32 v78, v78
  v_exp_f32 v79, v79
  v_cvt_pk_bf16_f32 v96, v64, v65
  v_cvt_pk_bf16_f32 v97, v66, v67
  v_cvt_pk_bf16_f32 v98, v68, v69
  v_cvt_pk_bf16_f32 v99, v70, v71
  v_cvt_pk_bf16_f32 v100, v72, v73
  v_cvt_pk_bf16_f32 v101, v74, v75
  v_cvt_pk_bf16_f32 v102, v76, v77
  v_cvt_pk_bf16_f32 v103, v78, v79
  v_mfma_f32_32x32x16_bf16 v[112:127], a[58:61], v[96:99], v[112:127]
  s_nop 0
  v_mfma_f32_32x32x16_bf16 v[112:127], a[62:65], v[100:103], v[112:127]
  s_cmp_eq_u32 s52, 2147483648
  s_cbranch_scc1 L_fbd_89
  v_mfma_f32_32x32x16_bf16 v[64:79], a[0:3], v[16:19], v[48:63]
  v_mfma_f32_32x32x8_bf16 v[64:79], a[40:41], v[24:25], v[64:79]
  s_nop 11
  v_sub_f32 v64, v64, v150
  v_sub_f32 v65, v65, v150
  v_sub_f32 v66, v66, v150
  v_sub_f32 v67, v67, v150
  v_sub_f32 v68, v68, v150
  v_sub_f32 v69, v69, v150
  v_sub_f32 v70, v70, v150
  v_sub_f32 v71, v71, v150
  v_sub_f32 v72, v72, v150
  v_sub_f32 v73, v73, v150
  v_sub_f32 v74, v74, v150
  v_sub_f32 v75, v75, v150
  v_sub_f32 v76, v76, v150
  v_sub_f32 v77, v77, v150
  v_sub_f32 v78, v78, v150
  v_sub_f32 v79, v79, v150
  v_exp_f32 v64, v64
  v_exp_f32 v65, v65
  v_exp_f32 v66, v66
  v_exp_f32 v67, v67
  v_exp_f32 v68, v68
  v_exp_f32 v69, v69
  v_exp_f32 v70, v70
  v_exp_f32 v71, v71
  v_exp_f32 v72, v72
  v_exp_f32 v73, v73
  v_exp_f32 v74, v74
  v_exp_f32 v75, v75
  v_exp_f32 v76, v76
  v_exp_f32 v77, v77
  v_exp_f32 v78, v78
  v_exp_f32 v79, v79
  v_cvt_pk_bf16_f32 v96, v64, v65
  v_cvt_pk_bf16_f32 v97, v66, v67
  v_cvt_pk_bf16_f32 v98, v68, v69
  v_cvt_pk_bf16_f32 v99, v70, v71
  v_cvt_pk_bf16_f32 v100, v72, v73
  v_cvt_pk_bf16_f32 v101, v74, v75
  v_cvt_pk_bf16_f32 v102, v76, v77
  v_cvt_pk_bf16_f32 v103, v78, v79
  v_mfma_f32_32x32x16_bf16 v[112:127], a[50:53], v[96:99], v[112:127]
  s_nop 0
  v_mfma_f32_32x32x16_bf16 v[112:127], a[54:57], v[100:103], v[112:127]
L_fbd_89:
  v_mov_b32 v150, 4286578688
  v_mfma_f32_32x32x16_bf16 v[64:79], a[36:39], v[20:23], v[32:47]
  v_mfma_f32_32x32x8_bf16 v[64:79], a[48:49], v[30:31], v[64:79]
  s_nop 11
  v_max3_f32 v150, v150, v64, v65
  v_max3_f32 v150, v150, v66, v67
  v_max3_f32 v150, v150, v68, v69
  v_max3_f32 v150, v150, v70, v71
  v_max3_f32 v150, v150, v72, v73
  v_max3_f32 v150, v150, v74, v75
  v_max3_f32 v150, v150, v76, v77
  v_max3_f32 v150, v150, v78, v79
  v_mfma_f32_32x32x16_bf16 v[64:79], a[32:35], v[20:23], 0
  v_mfma_f32_32x32x8_bf16 v[64:79], a[48:49], v[28:29], v[64:79]
  s_nop 11
  v_max3_f32 v150, v150, v64, v65
  v_max3_f32 v150, v150, v66, v67
  v_max3_f32 v150, v150, v68, v69
  v_max3_f32 v150, v150, v70, v71
  v_max3_f32 v150, v150, v72, v73
  v_max3_f32 v150, v150, v74, v75
  v_max3_f32 v150, v150, v76, v77
  v_max3_f32 v150, v150, v78, v79
  s_cmp_eq_u32 s59, 2147483648
  s_cbranch_scc1 L_fbd_90
  v_mfma_f32_32x32x16_bf16 v[64:79], a[28:31], v[20:23], 0
  v_mfma_f32_32x32x8_bf16 v[64:79], a[46:47], v[30:31], v[64:79]
  s_nop 11
  v_max3_f32 v150, v150, v64, v65
  v_max3_f32 v150, v150, v66, v67
  v_max3_f32 v150, v150, v68, v69
  v_max3_f32 v150, v150, v70, v71
  v_max3_f32 v150, v150, v72, v73
  v_max3_f32 v150, v150, v74, v75
  v_max3_f32 v150, v150, v76, v77
  v_max3_f32 v150, v150, v78, v79
  s_cmp_eq_u32 s58, 2147483648
  s_cbranch_scc1 L_fbd_90
  v_mfma_f32_32x32x16_bf16 v[64:79], a[24:27], v[20:23], 0
  v_mfma_f32_32x32x8_bf16 v[64:79], a[46:47], v[28:29], v[64:79]
  s_nop 11
  v_max3_f32 v150, v150, v64, v65
  v_max3_f32 v150, v150, v66, v67
  v_max3_f32 v150, v150, v68, v69
  v_max3_f32 v150, v150, v70, v71
  v_max3_f32 v150, v150, v72, v73
  v_max3_f32 v150, v150, v74, v75
  v_max3_f32 v150, v150, v76, v77
  v_max3_f32 v150, v150, v78, v79
  s_cmp_eq_u32 s57, 2147483648
  s_cbranch_scc1 L_fbd_90
  v_mfma_f32_32x32x16_bf16 v[64:79], a[20:23], v[20:23], 0
  v_mfma_f32_32x32x8_bf16 v[64:79], a[44:45], v[30:31], v[64:79]
  s_nop 11
  v_max3_f32 v150, v150, v64, v65
  v_max3_f32 v150, v150, v66, v67
  v_max3_f32 v150, v150, v68, v69
  v_max3_f32 v150, v150, v70, v71
  v_max3_f32 v150, v150, v72, v73
  v_max3_f32 v150, v150, v74, v75
  v_max3_f32 v150, v150, v76, v77
  v_max3_f32 v150, v150, v78, v79
  s_cmp_eq_u32 s56, 2147483648
  s_cbranch_scc1 L_fbd_90
  v_mfma_f32_32x32x16_bf16 v[64:79], a[16:19], v[20:23], 0
  v_mfma_f32_32x32x8_bf16 v[64:79], a[44:45], v[28:29], v[64:79]
  s_nop 11
  v_max3_f32 v150, v150, v64, v65
  v_max3_f32 v150, v150, v66, v67
  v_max3_f32 v150, v150, v68, v69
  v_max3_f32 v150, v150, v70, v71
  v_max3_f32 v150, v150, v72, v73
  v_max3_f32 v150, v150, v74, v75
  v_max3_f32 v150, v150, v76, v77
  v_max3_f32 v150, v150, v78, v79
  s_cmp_eq_u32 s55, 2147483648
  s_cbranch_scc1 L_fbd_90
  v_mfma_f32_32x32x16_bf16 v[64:79], a[12:15], v[20:23], 0
  v_mfma_f32_32x32x8_bf16 v[64:79], a[42:43], v[30:31], v[64:79]
  s_nop 11
  v_max3_f32 v150, v150, v64, v65
  v_max3_f32 v150, v150, v66, v67
  v_max3_f32 v150, v150, v68, v69
  v_max3_f32 v150, v150, v70, v71
  v_max3_f32 v150, v150, v72, v73
  v_max3_f32 v150, v150, v74, v75
  v_max3_f32 v150, v150, v76, v77
  v_max3_f32 v150, v150, v78, v79
  s_cmp_eq_u32 s54, 2147483648
  s_cbranch_scc1 L_fbd_90
  v_mfma_f32_32x32x16_bf16 v[64:79], a[8:11], v[20:23], 0
  v_mfma_f32_32x32x8_bf16 v[64:79], a[42:43], v[28:29], v[64:79]
  s_nop 11
  v_max3_f32 v150, v150, v64, v65
  v_max3_f32 v150, v150, v66, v67
  v_max3_f32 v150, v150, v68, v69
  v_max3_f32 v150, v150, v70, v71
  v_max3_f32 v150, v150, v72, v73
  v_max3_f32 v150, v150, v74, v75
  v_max3_f32 v150, v150, v76, v77
  v_max3_f32 v150, v150, v78, v79
  s_cmp_eq_u32 s53, 2147483648
  s_cbranch_scc1 L_fbd_90
  v_mfma_f32_32x32x16_bf16 v[64:79], a[4:7], v[20:23], v[48:63]
  v_mfma_f32_32x32x8_bf16 v[64:79], a[40:41], v[30:31], v[64:79]
  s_nop 11
  v_max3_f32 v150, v150, v64, v65
  v_max3_f32 v150, v150, v66, v67
  v_max3_f32 v150, v150, v68, v69
  v_max3_f32 v150, v150, v70, v71
  v_max3_f32 v150, v150, v72, v73
  v_max3_f32 v150, v150, v74, v75
  v_max3_f32 v150, v150, v76, v77
  v_max3_f32 v150, v150, v78, v79
L_fbd_90:
  v_mov_b32 v151, v150
  s_nop 1
  v_permlane32_swap_b32 v150, v151
  v_max_f32 v150, v150, v151
  v_mfma_f32_32x32x16_bf16 v[64:79], a[36:39], v[20:23], v[32:47]
  v_mfma_f32_32x32x8_bf16 v[64:79], a[48:49], v[30:31], v[64:79]
  s_nop 11
  v_sub_f32 v64, v64, v150
  v_sub_f32 v65, v65, v150
  v_sub_f32 v66, v66, v150
  v_sub_f32 v67, v67, v150
  v_sub_f32 v68, v68, v150
  v_sub_f32 v69, v69, v150
  v_sub_f32 v70, v70, v150
  v_sub_f32 v71, v71, v150
  v_sub_f32 v72, v72, v150
  v_sub_f32 v73, v73, v150
  v_sub_f32 v74, v74, v150
  v_sub_f32 v75, v75, v150
  v_sub_f32 v76, v76, v150
  v_sub_f32 v77, v77, v150
  v_sub_f32 v78, v78, v150
  v_sub_f32 v79, v79, v150
  v_exp_f32 v64, v64
  v_exp_f32 v65, v65
  v_exp_f32 v66, v66
  v_exp_f32 v67, v67
  v_exp_f32 v68, v68
  v_exp_f32 v69, v69
  v_exp_f32 v70, v70
  v_exp_f32 v71, v71
  v_exp_f32 v72, v72
  v_exp_f32 v73, v73
  v_exp_f32 v74, v74
  v_exp_f32 v75, v75
  v_exp_f32 v76, v76
  v_exp_f32 v77, v77
  v_exp_f32 v78, v78
  v_exp_f32 v79, v79
  v_cvt_pk_bf16_f32 v96, v64, v65
  v_cvt_pk_bf16_f32 v97, v66, v67
  v_cvt_pk_bf16_f32 v98, v68, v69
  v_cvt_pk_bf16_f32 v99, v70, v71
  v_cvt_pk_bf16_f32 v100, v72, v73
  v_cvt_pk_bf16_f32 v101, v74, v75
  v_cvt_pk_bf16_f32 v102, v76, v77
  v_cvt_pk_bf16_f32 v103, v78, v79
  v_mfma_f32_32x32x16_bf16 v[128:143], a[122:125], v[96:99], 0
  s_nop 0
  v_mfma_f32_32x32x16_bf16 v[128:143], a[126:129], v[100:103], v[128:143]
  v_mfma_f32_32x32x16_bf16 v[64:79], a[32:35], v[20:23], 0
  v_mfma_f32_32x32x8_bf16 v[64:79], a[48:49], v[28:29], v[64:79]
  s_nop 11
  v_sub_f32 v64, v64, v150
  v_sub_f32 v65, v65, v150
  v_sub_f32 v66, v66, v150
  v_sub_f32 v67, v67, v150
  v_sub_f32 v68, v68, v150
  v_sub_f32 v69, v69, v150
  v_sub_f32 v70, v70, v150
  v_sub_f32 v71, v71, v150
  v_sub_f32 v72, v72, v150
  v_sub_f32 v73, v73, v150
  v_sub_f32 v74, v74, v150
  v_sub_f32 v75, v75, v150
  v_sub_f32 v76, v76, v150
  v_sub_f32 v77, v77, v150
  v_sub_f32 v78, v78, v150
  v_sub_f32 v79, v79, v150
  v_exp_f32 v64, v64
  v_exp_f32 v65, v65
  v_exp_f32 v66, v66
  v_exp_f32 v67, v67
  v_exp_f32 v68, v68
  v_exp_f32 v69, v69
  v_exp_f32 v70, v70
  v_exp_f32 v71, v71
  v_exp_f32 v72, v72
  v_exp_f32 v73, v73
  v_exp_f32 v74, v74
  v_exp_f32 v75, v75
  v_exp_f32 v76, v76
  v_exp_f32 v77, v77
  v_exp_f32 v78, v78
  v_exp_f32 v79, v79
  v_cvt_pk_bf16_f32 v96, v64, v65
  v_cvt_pk_bf16_f32 v97, v66, v67
  v_cvt_pk_bf16_f32 v98, v68, v69
  v_cvt_pk_bf16_f32 v99, v70, v71
  v_cvt_pk_bf16_f32 v100, v72, v73
  v_cvt_pk_bf16_f32 v101, v74, v75
  v_cvt_pk_bf16_f32 v102, v76, v77
  v_cvt_pk_bf16_f32 v103, v78, v79
  v_mfma_f32_32x32x16_bf16 v[128:143], a[114:117], v[96:99], v[128:143]
  s_nop 0
  v_mfma_f32_32x32x16_bf16 v[128:143], a[118:121], v[100:103], v[128:143]
  s_cmp_eq_u32 s59, 2147483648
  s_cbranch_scc1 L_fbd_91
  v_mfma_f32_32x32x16_bf16 v[64:79], a[28:31], v[20:23], 0
  v_mfma_f32_32x32x8_bf16 v[64:79], a[46:47], v[30:31], v[64:79]
  s_nop 11
  v_sub_f32 v64, v64, v150
  v_sub_f32 v65, v65, v150
  v_sub_f32 v66, v66, v150
  v_sub_f32 v67, v67, v150
  v_sub_f32 v68, v68, v150
  v_sub_f32 v69, v69, v150
  v_sub_f32 v70, v70, v150
  v_sub_f32 v71, v71, v150
  v_sub_f32 v72, v72, v150
  v_sub_f32 v73, v73, v150
  v_sub_f32 v74, v74, v150
  v_sub_f32 v75, v75, v150
  v_sub_f32 v76, v76, v150
  v_sub_f32 v77, v77, v150
  v_sub_f32 v78, v78, v150
  v_sub_f32 v79, v79, v150
  v_exp_f32 v64, v64
  v_exp_f32 v65, v65
  v_exp_f32 v66, v66
  v_exp_f32 v67, v67
  v_exp_f32 v68, v68
  v_exp_f32 v69, v69
  v_exp_f32 v70, v70
  v_exp_f32 v71, v71
  v_exp_f32 v72, v72
  v_exp_f32 v73, v73
  v_exp_f32 v74, v74
  v_exp_f32 v75, v75
  v_exp_f32 v76, v76
  v_exp_f32 v77, v77
  v_exp_f32 v78, v78
  v_exp_f32 v79, v79
  v_cvt_pk_bf16_f32 v96, v64, v65
  v_cvt_pk_bf16_f32 v97, v66, v67
  v_cvt_pk_bf16_f32 v98, v68, v69
  v_cvt_pk_bf16_f32 v99, v70, v71
  v_cvt_pk_bf16_f32 v100, v72, v73
  v_cvt_pk_bf16_f32 v101, v74, v75
  v_cvt_pk_bf16_f32 v102, v76, v77
  v_cvt_pk_bf16_f32 v103, v78, v79
  v_mfma_f32_32x32x16_bf16 v[128:143], a[106:109], v[96:99], v[128:143]
  s_nop 0
  v_mfma_f32_32x32x16_bf16 v[128:143], a[110:113], v[100:103], v[128:143]
  s_cmp_eq_u32 s58, 2147483648
  s_cbranch_scc1 L_fbd_91
  v_mfma_f32_32x32x16_bf16 v[64:79], a[24:27], v[20:23], 0
  v_mfma_f32_32x32x8_bf16 v[64:79], a[46:47], v[28:29], v[64:79]
  s_nop 11
  v_sub_f32 v64, v64, v150
  v_sub_f32 v65, v65, v150
  v_sub_f32 v66, v66, v150
  v_sub_f32 v67, v67, v150
  v_sub_f32 v68, v68, v150
  v_sub_f32 v69, v69, v150
  v_sub_f32 v70, v70, v150
  v_sub_f32 v71, v71, v150
  v_sub_f32 v72, v72, v150
  v_sub_f32 v73, v73, v150
  v_sub_f32 v74, v74, v150
  v_sub_f32 v75, v75, v150
  v_sub_f32 v76, v76, v150
  v_sub_f32 v77, v77, v150
  v_sub_f32 v78, v78, v150
  v_sub_f32 v79, v79, v150
  v_exp_f32 v64, v64
  v_exp_f32 v65, v65
  v_exp_f32 v66, v66
  v_exp_f32 v67, v67
  v_exp_f32 v68, v68
  v_exp_f32 v69, v69
  v_exp_f32 v70, v70
  v_exp_f32 v71, v71
  v_exp_f32 v72, v72
  v_exp_f32 v73, v73
  v_exp_f32 v74, v74
  v_exp_f32 v75, v75
  v_exp_f32 v76, v76
  v_exp_f32 v77, v77
  v_exp_f32 v78, v78
  v_exp_f32 v79, v79
  v_cvt_pk_bf16_f32 v96, v64, v65
  v_cvt_pk_bf16_f32 v97, v66, v67
  v_cvt_pk_bf16_f32 v98, v68, v69
  v_cvt_pk_bf16_f32 v99, v70, v71
  v_cvt_pk_bf16_f32 v100, v72, v73
  v_cvt_pk_bf16_f32 v101, v74, v75
  v_cvt_pk_bf16_f32 v102, v76, v77
  v_cvt_pk_bf16_f32 v103, v78, v79
  v_mfma_f32_32x32x16_bf16 v[128:143], a[98:101], v[96:99], v[128:143]
  s_nop 0
  v_mfma_f32_32x32x16_bf16 v[128:143], a[102:105], v[100:103], v[128:143]
  s_cmp_eq_u32 s57, 2147483648
  s_cbranch_scc1 L_fbd_91
  v_mfma_f32_32x32x16_bf16 v[64:79], a[20:23], v[20:23], 0
  v_mfma_f32_32x32x8_bf16 v[64:79], a[44:45], v[30:31], v[64:79]
  s_nop 11
  v_sub_f32 v64, v64, v150
  v_sub_f32 v65, v65, v150
  v_sub_f32 v66, v66, v150
  v_sub_f32 v67, v67, v150
  v_sub_f32 v68, v68, v150
  v_sub_f32 v69, v69, v150
  v_sub_f32 v70, v70, v150
  v_sub_f32 v71, v71, v150
  v_sub_f32 v72, v72, v150
  v_sub_f32 v73, v73, v150
  v_sub_f32 v74, v74, v150
  v_sub_f32 v75, v75, v150
  v_sub_f32 v76, v76, v150
  v_sub_f32 v77, v77, v150
  v_sub_f32 v78, v78, v150
  v_sub_f32 v79, v79, v150
  v_exp_f32 v64, v64
  v_exp_f32 v65, v65
  v_exp_f32 v66, v66
  v_exp_f32 v67, v67
  v_exp_f32 v68, v68
  v_exp_f32 v69, v69
  v_exp_f32 v70, v70
  v_exp_f32 v71, v71
  v_exp_f32 v72, v72
  v_exp_f32 v73, v73
  v_exp_f32 v74, v74
  v_exp_f32 v75, v75
  v_exp_f32 v76, v76
  v_exp_f32 v77, v77
  v_exp_f32 v78, v78
  v_exp_f32 v79, v79
  v_cvt_pk_bf16_f32 v96, v64, v65
  v_cvt_pk_bf16_f32 v97, v66, v67
  v_cvt_pk_bf16_f32 v98, v68, v69
  v_cvt_pk_bf16_f32 v99, v70, v71
  v_cvt_pk_bf16_f32 v100, v72, v73
  v_cvt_pk_bf16_f32 v101, v74, v75
  v_cvt_pk_bf16_f32 v102, v76, v77
  v_cvt_pk_bf16_f32 v103, v78, v79
  v_mfma_f32_32x32x16_bf16 v[128:143], a[90:93], v[96:99], v[128:143]
  s_nop 0
  v_mfma_f32_32x32x16_bf16 v[128:143], a[94:97], v[100:103], v[128:143]
  s_cmp_eq_u32 s56, 2147483648
  s_cbranch_scc1 L_fbd_91
  v_mfma_f32_32x32x16_bf16 v[64:79], a[16:19], v[20:23], 0
  v_mfma_f32_32x32x8_bf16 v[64:79], a[44:45], v[28:29], v[64:79]
  s_nop 11
  v_sub_f32 v64, v64, v150
  v_sub_f32 v65, v65, v150
  v_sub_f32 v66, v66, v150
  v_sub_f32 v67, v67, v150
  v_sub_f32 v68, v68, v150
  v_sub_f32 v69, v69, v150
  v_sub_f32 v70, v70, v150
  v_sub_f32 v71, v71, v150
  v_sub_f32 v72, v72, v150
  v_sub_f32 v73, v73, v150
  v_sub_f32 v74, v74, v150
  v_sub_f32 v75, v75, v150
  v_sub_f32 v76, v76, v150
  v_sub_f32 v77, v77, v150
  v_sub_f32 v78, v78, v150
  v_sub_f32 v79, v79, v150
  v_exp_f32 v64, v64
  v_exp_f32 v65, v65
  v_exp_f32 v66, v66
  v_exp_f32 v67, v67
  v_exp_f32 v68, v68
  v_exp_f32 v69, v69
  v_exp_f32 v70, v70
  v_exp_f32 v71, v71
  v_exp_f32 v72, v72
  v_exp_f32 v73, v73
  v_exp_f32 v74, v74
  v_exp_f32 v75, v75
  v_exp_f32 v76, v76
  v_exp_f32 v77, v77
  v_exp_f32 v78, v78
  v_exp_f32 v79, v79
  v_cvt_pk_bf16_f32 v96, v64, v65
  v_cvt_pk_bf16_f32 v97, v66, v67
  v_cvt_pk_bf16_f32 v98, v68, v69
  v_cvt_pk_bf16_f32 v99, v70, v71
  v_cvt_pk_bf16_f32 v100, v72, v73
  v_cvt_pk_bf16_f32 v101, v74, v75
  v_cvt_pk_bf16_f32 v102, v76, v77
  v_cvt_pk_bf16_f32 v103, v78, v79
  v_mfma_f32_32x32x16_bf16 v[128:143], a[82:85], v[96:99], v[128:143]
  s_nop 0
  v_mfma_f32_32x32x16_bf16 v[128:143], a[86:89], v[100:103], v[128:143]
  s_cmp_eq_u32 s55, 2147483648
  s_cbranch_scc1 L_fbd_91
  v_mfma_f32_32x32x16_bf16 v[64:79], a[12:15], v[20:23], 0
  v_mfma_f32_32x32x8_bf16 v[64:79], a[42:43], v[30:31], v[64:79]
  s_nop 11
  v_sub_f32 v64, v64, v150
  v_sub_f32 v65, v65, v150
  v_sub_f32 v66, v66, v150
  v_sub_f32 v67, v67, v150
  v_sub_f32 v68, v68, v150
  v_sub_f32 v69, v69, v150
  v_sub_f32 v70, v70, v150
  v_sub_f32 v71, v71, v150
  v_sub_f32 v72, v72, v150
  v_sub_f32 v73, v73, v150
  v_sub_f32 v74, v74, v150
  v_sub_f32 v75, v75, v150
  v_sub_f32 v76, v76, v150
  v_sub_f32 v77, v77, v150
  v_sub_f32 v78, v78, v150
  v_sub_f32 v79, v79, v150
  v_exp_f32 v64, v64
  v_exp_f32 v65, v65
  v_exp_f32 v66, v66
  v_exp_f32 v67, v67
  v_exp_f32 v68, v68
  v_exp_f32 v69, v69
  v_exp_f32 v70, v70
  v_exp_f32 v71, v71
  v_exp_f32 v72, v72
  v_exp_f32 v73, v73
  v_exp_f32 v74, v74
  v_exp_f32 v75, v75
  v_exp_f32 v76, v76
  v_exp_f32 v77, v77
  v_exp_f32 v78, v78
  v_exp_f32 v79, v79
  v_cvt_pk_bf16_f32 v96, v64, v65
  v_cvt_pk_bf16_f32 v97, v66, v67
  v_cvt_pk_bf16_f32 v98, v68, v69
  v_cvt_pk_bf16_f32 v99, v70, v71
  v_cvt_pk_bf16_f32 v100, v72, v73
  v_cvt_pk_bf16_f32 v101, v74, v75
  v_cvt_pk_bf16_f32 v102, v76, v77
  v_cvt_pk_bf16_f32 v103, v78, v79
  v_mfma_f32_32x32x16_bf16 v[128:143], a[74:77], v[96:99], v[128:143]
  s_nop 0
  v_mfma_f32_32x32x16_bf16 v[128:143], a[78:81], v[100:103], v[128:143]
  s_cmp_eq_u32 s54, 2147483648
  s_cbranch_scc1 L_fbd_91
  v_mfma_f32_32x32x16_bf16 v[64:79], a[8:11], v[20:23], 0
  v_mfma_f32_32x32x8_bf16 v[64:79], a[42:43], v[28:29], v[64:79]
  s_nop 11
  v_sub_f32 v64, v64, v150
  v_sub_f32 v65, v65, v150
  v_sub_f32 v66, v66, v150
  v_sub_f32 v67, v67, v150
  v_sub_f32 v68, v68, v150
  v_sub_f32 v69, v69, v150
  v_sub_f32 v70, v70, v150
  v_sub_f32 v71, v71, v150
  v_sub_f32 v72, v72, v150
  v_sub_f32 v73, v73, v150
  v_sub_f32 v74, v74, v150
  v_sub_f32 v75, v75, v150
  v_sub_f32 v76, v76, v150
  v_sub_f32 v77, v77, v150
  v_sub_f32 v78, v78, v150
  v_sub_f32 v79, v79, v150
  v_exp_f32 v64, v64
  v_exp_f32 v65, v65
  v_exp_f32 v66, v66
  v_exp_f32 v67, v67
  v_exp_f32 v68, v68
  v_exp_f32 v69, v69
  v_exp_f32 v70, v70
  v_exp_f32 v71, v71
  v_exp_f32 v72, v72
  v_exp_f32 v73, v73
  v_exp_f32 v74, v74
  v_exp_f32 v75, v75
  v_exp_f32 v76, v76
  v_exp_f32 v77, v77
  v_exp_f32 v78, v78
  v_exp_f32 v79, v79
  v_cvt_pk_bf16_f32 v96, v64, v65
  v_cvt_pk_bf16_f32 v97, v66, v67
  v_cvt_pk_bf16_f32 v98, v68, v69
  v_cvt_pk_bf16_f32 v99, v70, v71
  v_cvt_pk_bf16_f32 v100, v72, v73
  v_cvt_pk_bf16_f32 v101, v74, v75
  v_cvt_pk_bf16_f32 v102, v76, v77
  v_cvt_pk_bf16_f32 v103, v78, v79
  v_mfma_f32_32x32x16_bf16 v[128:143], a[66:69], v[96:99], v[128:143]
  s_nop 0
  v_mfma_f32_32x32x16_bf16 v[128:143], a[70:73], v[100:103], v[128:143]
  s_cmp_eq_u32 s53, 2147483648
  s_cbranch_scc1 L_fbd_91
  v_mfma_f32_32x32x16_bf16 v[64:79], a[4:7], v[20:23], v[48:63]
  v_mfma_f32_32x32x8_bf16 v[64:79], a[40:41], v[30:31], v[64:79]
  s_nop 11
  v_sub_f32 v64, v64, v150
  v_sub_f32 v65, v65, v150
  v_sub_f32 v66, v66, v150
  v_sub_f32 v67, v67, v150
  v_sub_f32 v68, v68, v150
  v_sub_f32 v69, v69, v150
  v_sub_f32 v70, v70, v150
  v_sub_f32 v71, v71, v150
  v_sub_f32 v72, v72, v150
  v_sub_f32 v73, v73, v150
  v_sub_f32 v74, v74, v150
  v_sub_f32 v75, v75, v150
  v_sub_f32 v76, v76, v150
  v_sub_f32 v77, v77, v150
  v_sub_f32 v78, v78, v150
  v_sub_f32 v79, v79, v150
  v_exp_f32 v64, v64
  v_exp_f32 v65, v65
  v_exp_f32 v66, v66
  v_exp_f32 v67, v67
  v_exp_f32 v68, v68
  v_exp_f32 v69, v69
  v_exp_f32 v70, v70
  v_exp_f32 v71, v71
  v_exp_f32 v72, v72
  v_exp_f32 v73, v73
  v_exp_f32 v74, v74
  v_exp_f32 v75, v75
  v_exp_f32 v76, v76
  v_exp_f32 v77, v77
  v_exp_f32 v78, v78
  v_exp_f32 v79, v79
  v_cvt_pk_bf16_f32 v96, v64, v65
  v_cvt_pk_bf16_f32 v97, v66, v67
  v_cvt_pk_bf16_f32 v98, v68, v69
  v_cvt_pk_bf16_f32 v99, v70, v71
  v_cvt_pk_bf16_f32 v100, v72, v73
  v_cvt_pk_bf16_f32 v101, v74, v75
  v_cvt_pk_bf16_f32 v102, v76, v77
  v_cvt_pk_bf16_f32 v103, v78, v79
  v_mfma_f32_32x32x16_bf16 v[128:143], a[58:61], v[96:99], v[128:143]
  s_nop 0
  v_mfma_f32_32x32x16_bf16 v[128:143], a[62:65], v[100:103], v[128:143]
L_fbd_91:
  s_branch L_maxd_39
.section .rodata,"a"
.p2align 6
.amdhsa_kernel sequential_preLN__sliding_block__dense_activation_silu__prompt_kernel
  .amdhsa_next_free_vgpr 512
  .amdhsa_next_free_sgpr 102
  .amdhsa_accum_offset 256
  .amdhsa_group_segment_fixed_size 0
  .amdhsa_kernarg_size 72
  .amdhsa_user_sgpr_count 2
  .amdhsa_user_sgpr_kernarg_segment_ptr 1
  .amdhsa_system_sgpr_workgroup_id_x 1
.end_amdhsa_kernel
```
